```python
import torch

def _softmax(x, axis=-1):
    return torch.softmax(x, dim=axis)
def _gelu(x):
    return torch.nn.functional.gelu(x, approximate="tanh")
def _silu(x):
    return torch.nn.functional.silu(x)
def _sigmoid(x):
    return torch.sigmoid(x)
def _layernorm(x, axis=-1, eps=1e-5):
    m = x.mean(dim=axis, keepdim=True)
    v = x.var(dim=axis, keepdim=True, unbiased=False)
    return (x - m) / torch.sqrt(v + eps)
def _scatter_add(tgt, idx, src, axis=0):
    return tgt.clone().index_add_(axis, idx, src)
def _segment_sum(src, seg, n):
    out = torch.zeros((n,) + src.shape[1:], dtype=src.dtype)
    return out.index_add_(0, seg, src)
def _pad(x, pw):
    flat = tuple(v for pair in reversed(pw) for v in pair)
    return torch.nn.functional.pad(x, flat)

kernel_name = 'sequential_preLN__ssm_conv_s4__mixer_s_mlp__prompt'

def setup_inputs():

    _w = (lambda a: (lambda t: t.to(torch.bfloat16) if t.is_floating_point() else t)(torch.as_tensor(a)))
    def _A_setup():
        B, L, D, N = 1, 2048, 512, 128
        A_re = -(lambda _x: torch.exp(torch.as_tensor(_x)))((lambda *s: torch.randn(*s, dtype=torch.bfloat16) * 3.2)(D, N))
        A_im = torch.pi * (lambda *s: torch.randn(*s, dtype=torch.bfloat16) * 0.05)(D, N)
        B_re = (lambda *s: torch.randn(*s, dtype=torch.bfloat16) * 0.1)(D, N)
        B_im = (lambda *s: torch.randn(*s, dtype=torch.bfloat16) * 0.1)(D, N)
        C_re = (lambda *s: torch.randn(*s, dtype=torch.bfloat16) * 0.1)(D, N)
        C_im = (lambda *s: torch.randn(*s, dtype=torch.bfloat16) * 0.1)(D, N)
        log_dt = (lambda *s: torch.randn(*s, dtype=torch.bfloat16) * 0.05)(D) * 0.5 - 4.0
        Dskip = (lambda *s: torch.randn(*s, dtype=torch.bfloat16) * 0.05)(D)
        return {
            "u": _w((lambda *s: torch.randn(*s, dtype=torch.bfloat16) * 0.05)(B, L, D)),
            "A_re": _w(A_re),
            "A_im": _w(A_im),
            "B_re": _w(B_re),
            "B_im": _w(B_im),
            "C_re": _w(C_re),
            "C_im": _w(C_im),
            "log_dt": _w(log_dt),
            "Dskip": _w(Dskip),
        }
    _A_in = _A_setup()

    def _B_setup():
        B, S, D, F = 1, 2048, 512, 1792
        return {
            "x":  _w((lambda *s: torch.randn(*s, dtype=torch.bfloat16) * 0.05)(B, S, D)),
            "w1": _w((lambda *s: torch.randn(*s, dtype=torch.bfloat16) * 3.2)(D, D) * (D ** -0.5)),
            "w2": _w((lambda *s: torch.randn(*s, dtype=torch.bfloat16) * 3.2)(D, D) * (D ** -0.5)),
            "w3": _w((lambda *s: torch.randn(*s, dtype=torch.bfloat16) * 3.2)(D, F) * (D ** -0.5)),
            "w4": _w((lambda *s: torch.randn(*s, dtype=torch.bfloat16) * 1.6)(F, D) * (F ** -0.5)),
        }
    _B_in = _B_setup()

    return {
        "A_u": _A_in["u"],
        "A_A_re": _A_in["A_re"],
        "A_A_im": _A_in["A_im"],
        "A_B_re": _A_in["B_re"],
        "A_B_im": _A_in["B_im"],
        "A_C_re": _A_in["C_re"],
        "A_C_im": _A_in["C_im"],
        "A_log_dt": _A_in["log_dt"],
        "A_Dskip": _A_in["Dskip"],
        "B_x": _B_in["x"],
        "B_w1": _B_in["w1"],
        "B_w2": _B_in["w2"],
        "B_w3": _B_in["w3"],
        "B_w4": _B_in["w4"],
    }

def reference(A_u, A_A_re, A_A_im, A_B_re, A_B_im, A_C_re, A_C_im, A_log_dt, A_Dskip, B_x, B_w1, B_w2, B_w3, B_w4):
    def _A_ref(u, A_re, A_im, B_re, B_im, C_re, C_im, log_dt, Dskip):
        Bsz, L, D = u.shape
        dt = torch.exp(log_dt)[:, None]
        A = A_re + 1j * A_im
        Bc = B_re + 1j * B_im
        Cc = C_re + 1j * C_im
        logdA = dt * A
        dB = dt * Bc
        l = (lambda x, dt: x.to(dt))(torch.arange(L), A_re.dtype)
        P = torch.exp(logdA[:, :, None] * l[None, None, :])
        K = torch.einsum("dn,dnl,dn->dl", Cc, P, dB).real
        L2 = 2 * L
        Kp = _pad(K, ((0, 0), (0, L)))
        up = (lambda x, *d: x.permute(*d))(u, 0, 2, 1)
        up = _pad(up, ((0, 0), (0, 0), (0, L)))
        Kf = (lambda x, axes=(-2,-1): torch.fft.rfft2(x.float(), dim=axes))(Kp[:, None, :], axes=(-2, -1))
        Uf = (lambda x, axes=(-2,-1): torch.fft.rfft2(x.float(), dim=axes))(up[:, :, None, :], axes=(-2, -1))
        Yf = Uf * Kf[None, :, :, :]
        y = (lambda x, s, axes=(-2,-1): torch.fft.irfft2(x, s=s, dim=axes).to(torch.bfloat16))(Yf, (1, L2), axes=(-2, -1))[:, :, 0, :L]
        y = (lambda x, *d: x.permute(*d))(y, 0, 2, 1) + u * Dskip[None, None, :]
        return y

    def _B_ref(x, w1, w2, w3, w4):
        B, S, D = x.shape
        h = _gelu(_layernorm(x, axis=-1) @ w1)
        c = D // 4
        g0 = _pad(h[:, :, 0*c:1*c], ((0, 0), (1, 0), (0, 0)))[:, :S, :]
        g1 = _pad(h[:, :, 1*c:2*c], ((0, 0), (0, 1), (0, 0)))[:, 1:, :]
        g2 = _pad(h[:, :, 2*c:3*c], ((0, 0), (2, 0), (0, 0)))[:, :S, :]
        g3 = _pad(h[:, :, 3*c:   ], ((0, 0), (0, 2), (0, 0)))[:, 2:, :]
        hs = torch.concatenate([g0, g1, g2, g3], axis=-1) @ w2
        x1 = x + hs
        h2 = _gelu(_layernorm(x1, axis=-1) @ w3) @ w4
        return x1 + h2

    x = A_u
    h = x + _A_ref(_layernorm(x, axis=-1), A_A_re, A_A_im, A_B_re, A_B_im, A_C_re, A_C_im, A_log_dt, A_Dskip)
    h2 = h + _B_ref(_layernorm(h, axis=-1), B_w1, B_w2, B_w3, B_w4)
    return h2
```

```asm
; @launch kernel=k1_kernel grid=(274,1,1) block=(512,1,1) lds=51200
; @launch kernel=k2_kernel grid=(256,1,1) block=(512,1,1) lds=115712
; @launch kernel=k3_kernel grid=(256,1,1) block=(512,1,1) lds=131072
; @launch kernel=k4_kernel grid=(256,1,1) block=(512,1,1) lds=65536
; @launch kernel=k56_kernel grid=(256,1,1) block=(512,1,1) lds=141312
.amdgcn_target "amdgcn-amd-amdhsa--gfx950"
.text
.globl k1_kernel
.p2align 8
.type k1_kernel,@function
k1_kernel:
    s_cmp_ge_u32 s2, 274
    s_cbranch_scc1 K1_exit
    s_load_dwordx2 s[4:5], s[0:1], 128

    s_cmp_lt_u32 s2, 256
    s_cbranch_scc1 K1_kgen

    s_waitcnt lgkmcnt(0)
    s_add_u32 s20, s4, 0x1b00000
    s_addc_u32 s21, s5, 0
    v_lshlrev_b32 v1, 4, v0
    v_mov_b32 v4, 0
    v_mov_b32 v5, 0
    v_mov_b32 v6, 0
    v_mov_b32 v7, 0
    global_store_dwordx4 v1, v[4:7], s[20:21]
    s_sub_u32 s3, s2, 256
    s_load_dwordx2 s[6:7], s[0:1], 80
    s_load_dwordx2 s[8:9], s[0:1], 96
    s_movk_i32 s10, 1024
    s_lshl_b32 s11, s3, 8
    s_cmp_lt_u32 s3, 4
    s_waitcnt lgkmcnt(0)
    s_cbranch_scc1 K1_cs_w1
    s_mov_b32 s6, s8
    s_mov_b32 s7, s9
    s_movk_i32 s10, 3584
    s_sub_u32 s11, s11, 1024

K1_cs_w1:
    v_lshrrev_b32 v1, 4, v0
    v_and_b32 v2, 15, v0
    v_mul_lo_u32 v3, v1, s10
    v_lshl_add_u32 v3, v2, 4, v3
    v_add_u32 v3, s11, v3
    s_lshl_b32 s12, s10, 5

    global_load_dwordx4 v[8:11], v3, s[6:7]
    s_add_u32 s6, s6, s12
    s_addc_u32 s7, s7, 0
    global_load_dwordx4 v[12:15], v3, s[6:7]
    s_add_u32 s6, s6, s12
    s_addc_u32 s7, s7, 0
    global_load_dwordx4 v[16:19], v3, s[6:7]
    s_add_u32 s6, s6, s12
    s_addc_u32 s7, s7, 0
    global_load_dwordx4 v[20:23], v3, s[6:7]
    s_add_u32 s6, s6, s12
    s_addc_u32 s7, s7, 0
    global_load_dwordx4 v[24:27], v3, s[6:7]
    s_add_u32 s6, s6, s12
    s_addc_u32 s7, s7, 0
    global_load_dwordx4 v[28:31], v3, s[6:7]
    s_add_u32 s6, s6, s12
    s_addc_u32 s7, s7, 0
    global_load_dwordx4 v[32:35], v3, s[6:7]
    s_add_u32 s6, s6, s12
    s_addc_u32 s7, s7, 0
    global_load_dwordx4 v[36:39], v3, s[6:7]
    s_add_u32 s6, s6, s12
    s_addc_u32 s7, s7, 0
    global_load_dwordx4 v[40:43], v3, s[6:7]
    s_add_u32 s6, s6, s12
    s_addc_u32 s7, s7, 0
    global_load_dwordx4 v[44:47], v3, s[6:7]
    s_add_u32 s6, s6, s12
    s_addc_u32 s7, s7, 0
    global_load_dwordx4 v[48:51], v3, s[6:7]
    s_add_u32 s6, s6, s12
    s_addc_u32 s7, s7, 0
    global_load_dwordx4 v[52:55], v3, s[6:7]
    s_add_u32 s6, s6, s12
    s_addc_u32 s7, s7, 0
    global_load_dwordx4 v[56:59], v3, s[6:7]
    s_add_u32 s6, s6, s12
    s_addc_u32 s7, s7, 0
    global_load_dwordx4 v[60:63], v3, s[6:7]
    s_add_u32 s6, s6, s12
    s_addc_u32 s7, s7, 0
    global_load_dwordx4 v[64:67], v3, s[6:7]
    s_add_u32 s6, s6, s12
    s_addc_u32 s7, s7, 0
    global_load_dwordx4 v[68:71], v3, s[6:7]
    v_mov_b32 v76, 0
    v_mov_b32 v77, 0
    v_mov_b32 v78, 0
    v_mov_b32 v79, 0
    v_mov_b32 v80, 0
    v_mov_b32 v81, 0
    v_mov_b32 v82, 0
    v_mov_b32 v83, 0
    s_waitcnt vmcnt(15)
    v_lshlrev_b32 v84, 16, v8
    v_and_b32 v85, 0xffff0000, v8
    v_pk_add_f32 v[76:77], v[76:77], v[84:85]
    v_lshlrev_b32 v86, 16, v9
    v_and_b32 v87, 0xffff0000, v9
    v_pk_add_f32 v[78:79], v[78:79], v[86:87]
    v_lshlrev_b32 v84, 16, v10
    v_and_b32 v85, 0xffff0000, v10
    v_pk_add_f32 v[80:81], v[80:81], v[84:85]
    v_lshlrev_b32 v86, 16, v11
    v_and_b32 v87, 0xffff0000, v11
    v_pk_add_f32 v[82:83], v[82:83], v[86:87]
    s_waitcnt vmcnt(14)
    v_lshlrev_b32 v84, 16, v12
    v_and_b32 v85, 0xffff0000, v12
    v_pk_add_f32 v[76:77], v[76:77], v[84:85]
    v_lshlrev_b32 v86, 16, v13
    v_and_b32 v87, 0xffff0000, v13
    v_pk_add_f32 v[78:79], v[78:79], v[86:87]
    v_lshlrev_b32 v84, 16, v14
    v_and_b32 v85, 0xffff0000, v14
    v_pk_add_f32 v[80:81], v[80:81], v[84:85]
    v_lshlrev_b32 v86, 16, v15
    v_and_b32 v87, 0xffff0000, v15
    v_pk_add_f32 v[82:83], v[82:83], v[86:87]
    s_waitcnt vmcnt(13)
    v_lshlrev_b32 v84, 16, v16
    v_and_b32 v85, 0xffff0000, v16
    v_pk_add_f32 v[76:77], v[76:77], v[84:85]
    v_lshlrev_b32 v86, 16, v17
    v_and_b32 v87, 0xffff0000, v17
    v_pk_add_f32 v[78:79], v[78:79], v[86:87]
    v_lshlrev_b32 v84, 16, v18
    v_and_b32 v85, 0xffff0000, v18
    v_pk_add_f32 v[80:81], v[80:81], v[84:85]
    v_lshlrev_b32 v86, 16, v19
    v_and_b32 v87, 0xffff0000, v19
    v_pk_add_f32 v[82:83], v[82:83], v[86:87]
    s_waitcnt vmcnt(12)
    v_lshlrev_b32 v84, 16, v20
    v_and_b32 v85, 0xffff0000, v20
    v_pk_add_f32 v[76:77], v[76:77], v[84:85]
    v_lshlrev_b32 v86, 16, v21
    v_and_b32 v87, 0xffff0000, v21
    v_pk_add_f32 v[78:79], v[78:79], v[86:87]
    v_lshlrev_b32 v84, 16, v22
    v_and_b32 v85, 0xffff0000, v22
    v_pk_add_f32 v[80:81], v[80:81], v[84:85]
    v_lshlrev_b32 v86, 16, v23
    v_and_b32 v87, 0xffff0000, v23
    v_pk_add_f32 v[82:83], v[82:83], v[86:87]
    s_waitcnt vmcnt(11)
    v_lshlrev_b32 v84, 16, v24
    v_and_b32 v85, 0xffff0000, v24
    v_pk_add_f32 v[76:77], v[76:77], v[84:85]
    v_lshlrev_b32 v86, 16, v25
    v_and_b32 v87, 0xffff0000, v25
    v_pk_add_f32 v[78:79], v[78:79], v[86:87]
    v_lshlrev_b32 v84, 16, v26
    v_and_b32 v85, 0xffff0000, v26
    v_pk_add_f32 v[80:81], v[80:81], v[84:85]
    v_lshlrev_b32 v86, 16, v27
    v_and_b32 v87, 0xffff0000, v27
    v_pk_add_f32 v[82:83], v[82:83], v[86:87]
    s_waitcnt vmcnt(10)
    v_lshlrev_b32 v84, 16, v28
    v_and_b32 v85, 0xffff0000, v28
    v_pk_add_f32 v[76:77], v[76:77], v[84:85]
    v_lshlrev_b32 v86, 16, v29
    v_and_b32 v87, 0xffff0000, v29
    v_pk_add_f32 v[78:79], v[78:79], v[86:87]
    v_lshlrev_b32 v84, 16, v30
    v_and_b32 v85, 0xffff0000, v30
    v_pk_add_f32 v[80:81], v[80:81], v[84:85]
    v_lshlrev_b32 v86, 16, v31
    v_and_b32 v87, 0xffff0000, v31
    v_pk_add_f32 v[82:83], v[82:83], v[86:87]
    s_waitcnt vmcnt(9)
    v_lshlrev_b32 v84, 16, v32
    v_and_b32 v85, 0xffff0000, v32
    v_pk_add_f32 v[76:77], v[76:77], v[84:85]
    v_lshlrev_b32 v86, 16, v33
    v_and_b32 v87, 0xffff0000, v33
    v_pk_add_f32 v[78:79], v[78:79], v[86:87]
    v_lshlrev_b32 v84, 16, v34
    v_and_b32 v85, 0xffff0000, v34
    v_pk_add_f32 v[80:81], v[80:81], v[84:85]
    v_lshlrev_b32 v86, 16, v35
    v_and_b32 v87, 0xffff0000, v35
    v_pk_add_f32 v[82:83], v[82:83], v[86:87]
    s_waitcnt vmcnt(8)
    v_lshlrev_b32 v84, 16, v36
    v_and_b32 v85, 0xffff0000, v36
    v_pk_add_f32 v[76:77], v[76:77], v[84:85]
    v_lshlrev_b32 v86, 16, v37
    v_and_b32 v87, 0xffff0000, v37
    v_pk_add_f32 v[78:79], v[78:79], v[86:87]
    v_lshlrev_b32 v84, 16, v38
    v_and_b32 v85, 0xffff0000, v38
    v_pk_add_f32 v[80:81], v[80:81], v[84:85]
    v_lshlrev_b32 v86, 16, v39
    v_and_b32 v87, 0xffff0000, v39
    v_pk_add_f32 v[82:83], v[82:83], v[86:87]
    s_waitcnt vmcnt(7)
    v_lshlrev_b32 v84, 16, v40
    v_and_b32 v85, 0xffff0000, v40
    v_pk_add_f32 v[76:77], v[76:77], v[84:85]
    v_lshlrev_b32 v86, 16, v41
    v_and_b32 v87, 0xffff0000, v41
    v_pk_add_f32 v[78:79], v[78:79], v[86:87]
    v_lshlrev_b32 v84, 16, v42
    v_and_b32 v85, 0xffff0000, v42
    v_pk_add_f32 v[80:81], v[80:81], v[84:85]
    v_lshlrev_b32 v86, 16, v43
    v_and_b32 v87, 0xffff0000, v43
    v_pk_add_f32 v[82:83], v[82:83], v[86:87]
    s_waitcnt vmcnt(6)
    v_lshlrev_b32 v84, 16, v44
    v_and_b32 v85, 0xffff0000, v44
    v_pk_add_f32 v[76:77], v[76:77], v[84:85]
    v_lshlrev_b32 v86, 16, v45
    v_and_b32 v87, 0xffff0000, v45
    v_pk_add_f32 v[78:79], v[78:79], v[86:87]
    v_lshlrev_b32 v84, 16, v46
    v_and_b32 v85, 0xffff0000, v46
    v_pk_add_f32 v[80:81], v[80:81], v[84:85]
    v_lshlrev_b32 v86, 16, v47
    v_and_b32 v87, 0xffff0000, v47
    v_pk_add_f32 v[82:83], v[82:83], v[86:87]
    s_waitcnt vmcnt(5)
    v_lshlrev_b32 v84, 16, v48
    v_and_b32 v85, 0xffff0000, v48
    v_pk_add_f32 v[76:77], v[76:77], v[84:85]
    v_lshlrev_b32 v86, 16, v49
    v_and_b32 v87, 0xffff0000, v49
    v_pk_add_f32 v[78:79], v[78:79], v[86:87]
    v_lshlrev_b32 v84, 16, v50
    v_and_b32 v85, 0xffff0000, v50
    v_pk_add_f32 v[80:81], v[80:81], v[84:85]
    v_lshlrev_b32 v86, 16, v51
    v_and_b32 v87, 0xffff0000, v51
    v_pk_add_f32 v[82:83], v[82:83], v[86:87]
    s_waitcnt vmcnt(4)
    v_lshlrev_b32 v84, 16, v52
    v_and_b32 v85, 0xffff0000, v52
    v_pk_add_f32 v[76:77], v[76:77], v[84:85]
    v_lshlrev_b32 v86, 16, v53
    v_and_b32 v87, 0xffff0000, v53
    v_pk_add_f32 v[78:79], v[78:79], v[86:87]
    v_lshlrev_b32 v84, 16, v54
    v_and_b32 v85, 0xffff0000, v54
    v_pk_add_f32 v[80:81], v[80:81], v[84:85]
    v_lshlrev_b32 v86, 16, v55
    v_and_b32 v87, 0xffff0000, v55
    v_pk_add_f32 v[82:83], v[82:83], v[86:87]
    s_waitcnt vmcnt(3)
    v_lshlrev_b32 v84, 16, v56
    v_and_b32 v85, 0xffff0000, v56
    v_pk_add_f32 v[76:77], v[76:77], v[84:85]
    v_lshlrev_b32 v86, 16, v57
    v_and_b32 v87, 0xffff0000, v57
    v_pk_add_f32 v[78:79], v[78:79], v[86:87]
    v_lshlrev_b32 v84, 16, v58
    v_and_b32 v85, 0xffff0000, v58
    v_pk_add_f32 v[80:81], v[80:81], v[84:85]
    v_lshlrev_b32 v86, 16, v59
    v_and_b32 v87, 0xffff0000, v59
    v_pk_add_f32 v[82:83], v[82:83], v[86:87]
    s_waitcnt vmcnt(2)
    v_lshlrev_b32 v84, 16, v60
    v_and_b32 v85, 0xffff0000, v60
    v_pk_add_f32 v[76:77], v[76:77], v[84:85]
    v_lshlrev_b32 v86, 16, v61
    v_and_b32 v87, 0xffff0000, v61
    v_pk_add_f32 v[78:79], v[78:79], v[86:87]
    v_lshlrev_b32 v84, 16, v62
    v_and_b32 v85, 0xffff0000, v62
    v_pk_add_f32 v[80:81], v[80:81], v[84:85]
    v_lshlrev_b32 v86, 16, v63
    v_and_b32 v87, 0xffff0000, v63
    v_pk_add_f32 v[82:83], v[82:83], v[86:87]
    s_waitcnt vmcnt(1)
    v_lshlrev_b32 v84, 16, v64
    v_and_b32 v85, 0xffff0000, v64
    v_pk_add_f32 v[76:77], v[76:77], v[84:85]
    v_lshlrev_b32 v86, 16, v65
    v_and_b32 v87, 0xffff0000, v65
    v_pk_add_f32 v[78:79], v[78:79], v[86:87]
    v_lshlrev_b32 v84, 16, v66
    v_and_b32 v85, 0xffff0000, v66
    v_pk_add_f32 v[80:81], v[80:81], v[84:85]
    v_lshlrev_b32 v86, 16, v67
    v_and_b32 v87, 0xffff0000, v67
    v_pk_add_f32 v[82:83], v[82:83], v[86:87]
    s_waitcnt vmcnt(0)
    v_lshlrev_b32 v84, 16, v68
    v_and_b32 v85, 0xffff0000, v68
    v_pk_add_f32 v[76:77], v[76:77], v[84:85]
    v_lshlrev_b32 v86, 16, v69
    v_and_b32 v87, 0xffff0000, v69
    v_pk_add_f32 v[78:79], v[78:79], v[86:87]
    v_lshlrev_b32 v84, 16, v70
    v_and_b32 v85, 0xffff0000, v70
    v_pk_add_f32 v[80:81], v[80:81], v[84:85]
    v_lshlrev_b32 v86, 16, v71
    v_and_b32 v87, 0xffff0000, v71
    v_pk_add_f32 v[82:83], v[82:83], v[86:87]
    v_lshlrev_b32 v4, 5, v0
    ds_write_b128 v4, v[76:79]
    ds_write_b128 v4, v[80:83] offset:16
    v_lshlrev_b32 v5, 2, v0
    s_waitcnt lgkmcnt(0)
    s_barrier
    v_cmp_gt_u32 vcc, 128, v0
    s_and_saveexec_b64 s[14:15], vcc
    s_cbranch_execz K1_end

    ds_read_b32 v8, v5 offset:0
    ds_read_b32 v9, v5 offset:512
    ds_read_b32 v10, v5 offset:1024
    ds_read_b32 v11, v5 offset:1536
    ds_read_b32 v12, v5 offset:2048
    ds_read_b32 v13, v5 offset:2560
    ds_read_b32 v14, v5 offset:3072
    ds_read_b32 v15, v5 offset:3584
    ds_read_b32 v16, v5 offset:4096
    ds_read_b32 v17, v5 offset:4608
    ds_read_b32 v18, v5 offset:5120
    ds_read_b32 v19, v5 offset:5632
    ds_read_b32 v20, v5 offset:6144
    ds_read_b32 v21, v5 offset:6656
    ds_read_b32 v22, v5 offset:7168
    ds_read_b32 v23, v5 offset:7680
    ds_read_b32 v24, v5 offset:8192
    ds_read_b32 v25, v5 offset:8704
    ds_read_b32 v26, v5 offset:9216
    ds_read_b32 v27, v5 offset:9728
    ds_read_b32 v28, v5 offset:10240
    ds_read_b32 v29, v5 offset:10752
    ds_read_b32 v30, v5 offset:11264
    ds_read_b32 v31, v5 offset:11776
    ds_read_b32 v32, v5 offset:12288
    ds_read_b32 v33, v5 offset:12800
    ds_read_b32 v34, v5 offset:13312
    ds_read_b32 v35, v5 offset:13824
    ds_read_b32 v36, v5 offset:14336
    ds_read_b32 v37, v5 offset:14848
    ds_read_b32 v38, v5 offset:15360
    ds_read_b32 v39, v5 offset:15872
    s_add_u32 s8, s4, 0x1a00000
    s_addc_u32 s9, s5, 0
    s_lshl_b32 s3, s3, 9
    v_add_u32 v5, s3, v5
    s_waitcnt lgkmcnt(0)
    v_add_f32 v8, v8, v24
    v_add_f32 v9, v9, v25
    v_add_f32 v10, v10, v26
    v_add_f32 v11, v11, v27
    v_add_f32 v12, v12, v28
    v_add_f32 v13, v13, v29
    v_add_f32 v14, v14, v30
    v_add_f32 v15, v15, v31
    v_add_f32 v16, v16, v32
    v_add_f32 v17, v17, v33
    v_add_f32 v18, v18, v34
    v_add_f32 v19, v19, v35
    v_add_f32 v20, v20, v36
    v_add_f32 v21, v21, v37
    v_add_f32 v22, v22, v38
    v_add_f32 v23, v23, v39
    v_add_f32 v8, v8, v16
    v_add_f32 v9, v9, v17
    v_add_f32 v10, v10, v18
    v_add_f32 v11, v11, v19
    v_add_f32 v12, v12, v20
    v_add_f32 v13, v13, v21
    v_add_f32 v14, v14, v22
    v_add_f32 v15, v15, v23
    v_add_f32 v8, v8, v12
    v_add_f32 v9, v9, v13
    v_add_f32 v10, v10, v14
    v_add_f32 v11, v11, v15
    v_add_f32 v8, v8, v10
    v_add_f32 v9, v9, v11
    v_add_f32 v8, v8, v9
    global_store_dword v5, v8, s[8:9]
    s_branch K1_end
K1_kgen:
    s_load_dwordx4 s[8:11], s[0:1], 8
    s_load_dwordx4 s[12:15], s[0:1], 24
    s_load_dwordx4 s[16:19], s[0:1], 40
    s_load_dwordx2 s[20:21], s[0:1], 56
    s_load_dwordx2 s[6:7], s[0:1], 0
    s_lshl_b32 s3, s2, 1
    v_lshrrev_b32 v1, 8, v0
    v_add_u32 v1, s3, v1
    v_lshrrev_b32 v2, 6, v0
    v_and_b32 v3, 31, v0
    v_lshl_add_u32 v3, v2, 5, v3
    s_lshl_b32 s26, s3, 8
    v_lshlrev_b32 v14, 4, v3
    v_lshl_add_u32 v3, v3, 1, s26
    v_lshlrev_b32 v4, 1, v1
    v_and_b32 v5, 15, v0
    v_bfe_u32 v6, v0, 4, 2
    s_lshl_b32 s26, s2, 13
    v_lshl_add_u32 v92, v0, 4, s26
    s_waitcnt lgkmcnt(0)
    global_load_ushort v7, v4, s[20:21]
    global_load_ushort v8, v3, s[8:9]
    global_load_ushort v9, v3, s[10:11]
    global_load_ushort v10, v3, s[12:13]
    global_load_ushort v11, v3, s[14:15]
    global_load_ushort v12, v3, s[16:17]
    global_load_ushort v13, v3, s[18:19]
    global_load_dwordx4 v[76:79], v92, s[6:7]

    s_add_u32 s22, s4, 0x400000
    s_addc_u32 s23, s5, 0
    s_add_u32 s24, s4, 0x600000
    s_addc_u32 s25, s5, 0
    s_load_dwordx4 s[28:31], s[0:1], 80
    s_load_dwordx4 s[32:35], s[0:1], 96
    s_mov_b32 s36, s2
    s_mul_i32 s37, s36, 7168
    v_min_u32 v44, 447, v0
    v_lshl_add_u32 v44, v44, 4, s37
    s_lshl_b32 s37, s36, 11
    v_and_b32 v45, 127, v0
    v_lshl_add_u32 v45, v45, 4, s37
    s_waitcnt lgkmcnt(0)
    global_load_dwordx4 v[72:75], v44, s[34:35]
    global_load_dwordx4 v[72:75], v44, s[32:33]
    global_load_dwordx4 v[72:75], v45, s[30:31]
    global_load_dwordx4 v[72:75], v45, s[28:29]

    s_getpc_b64 s[36:37]
CPF_1:
    s_add_u32 s36, s36, k2_kernel-CPF_1
    s_addc_u32 s37, s37, 0
    s_bfe_u32 s38, s2, 0x50003
    s_lshl_b32 s38, s38, 10
    v_and_b32 v44, 63, v0
    v_lshl_add_u32 v44, v44, 4, s38
    v_min_u32 v44, k4_kernel-k2_kernel-16, v44
    global_load_dwordx4 v[72:75], v44, s[36:37]
    v_lshrrev_b32 v40, 3, v5
    v_lshlrev_b32 v40, 7, v40
    v_and_or_b32 v32, v5, 7, v40
    v_bfe_u32 v40, v5, 2, 1
    v_lshlrev_b32 v40, 7, v40
    v_and_b32 v41, 3, v5
    v_lshl_add_u32 v40, v41, 1, v40
    v_add_u32 v40, 256, v40
    v_bfe_u32 v41, v5, 1, 2
    v_lshlrev_b32 v41, 7, v41
    v_and_b32 v33, 1, v5
    v_lshl_add_u32 v41, v33, 2, v41
    v_add_u32 v41, 512, v41
    v_cmp_gt_u32 vcc, 8, v5
    v_lshlrev_b32 v34, 7, v5
    v_add_u32 v34, 1024, v34
    v_cndmask_b32 v33, v41, v40, vcc
    v_lshlrev_b32 v35, 3, v5
    v_cvt_f32_u32 v32, v32
    v_cvt_f32_u32 v33, v33
    v_cvt_f32_u32 v34, v34
    v_cvt_f32_u32 v35, v35
    v_mul_u32_u24 v42, 3072, v2
    v_add_u32 v42, 4096, v42
    v_lshrrev_b32 v40, 1, v6
    v_lshlrev_b32 v40, 7, v40
    v_and_b32 v41, 1, v6
    v_lshl_add_u32 v40, v41, 2, v40
    v_lshl_add_u32 v40, v5, 3, v40
    v_lshl_add_u32 v36, v40, 2, v42
    v_lshlrev_b32 v40, 6, v6
    v_add_u32 v40, 256, v40
    v_lshl_add_u32 v41, v5, 2, v40
    v_lshl_add_u32 v40, v5, 1, v40
    v_cmp_gt_u32 vcc, 2, v6
    v_mov_b32 v43, 32
    s_nop 0
    v_cndmask_b32 v40, v40, v41, vcc
    v_cndmask_b32 v43, v43, 2, vcc
    v_lshl_add_u32 v37, v40, 2, v42
    v_lshl_add_u32 v38, v43, 2, v37
    v_lshlrev_b32 v40, 6, v6
    v_add_u32 v40, v40, v5
    v_add_u32 v40, 512, v40
    v_lshl_add_u32 v39, v40, 2, v42
    v_lshlrev_b32 v15, 9, v2
    v_lshl_add_u32 v15, v6, 4, v15

    s_waitcnt vmcnt(6)
    v_lshlrev_b32 v7, 16, v7
    v_mul_f32 v40, 0x3fb8aa3b, v7
    s_mov_b32 s26, 0x3fb8aa3b
    v_fma_f32 v41, v7, s26, -v40
    v_mov_b32 v43, 0x32a57060
    v_fmac_f32 v41, v7, v43
    v_exp_f32 v40, v40
    v_mul_f32 v41, 0x3f317218, v41
    v_lshlrev_b32 v8, 16, v8
    v_fmac_f32 v40, v40, v41
    v_cvt_pk_bf16_f32 v40, v40, v40
    v_lshlrev_b32 v7, 16, v40
    v_lshlrev_b32 v9, 16, v9
    v_lshlrev_b32 v10, 16, v10
    v_lshlrev_b32 v11, 16, v11
    v_lshlrev_b32 v12, 16, v12
    v_lshlrev_b32 v13, 16, v13
    v_mul_f32 v16, v7, v8
    v_mul_f32 v17, v7, v9
    v_mul_f32 v16, 0x3fb8aa3b, v16
    v_mul_f32 v17, 0x3e22f983, v17
    v_mul_f32 v10, v7, v10
    v_mul_f32 v11, v7, v11
    v_mul_f32 v18, v12, v10
    v_mul_f32 v19, v12, v11
    v_fma_f32 v18, -v13, v11, v18
    v_fmac_f32 v19, v13, v10
    ds_write_b128 v14, v[16:19]

    v_mov_b32 v60, 0
    v_mov_b32 v61, 0
    v_mov_b32 v62, 0
    v_mov_b32 v63, 0
    v_mov_b32 v64, 0
    v_mov_b32 v65, 0
    v_mov_b32 v66, 0
    v_mov_b32 v67, 0
    v_mov_b32 v68, 0
    v_mov_b32 v69, 0
    v_mov_b32 v70, 0
    v_mov_b32 v71, 0
    s_waitcnt lgkmcnt(0)
    ds_read_b128 v[16:19], v15
    ds_read_b128 v[24:27], v15 offset:64
    s_mov_b32 s27, 0
    s_waitcnt lgkmcnt(1)
    v_pk_mul_f32 v[44:45], v[16:17], v[34:35] op_sel:[0,1] op_sel_hi:[1,1]
    v_pk_mul_f32 v[46:47], v[16:17], v[32:33] op_sel:[0,0] op_sel_hi:[1,0]
    v_pk_mul_f32 v[48:49], v[16:17], v[32:33] op_sel:[0,1] op_sel_hi:[1,1]
    v_pk_mul_f32 v[50:51], v[16:17], v[34:35] op_sel:[0,0] op_sel_hi:[1,0]
    v_fract_f32 v45, v45
    v_fract_f32 v47, v47
    v_fract_f32 v49, v49
    v_fract_f32 v51, v51
    v_exp_f32 v44, v44
    v_cos_f32 v52, v45
    v_sin_f32 v53, v45
    v_exp_f32 v46, v46
    v_cos_f32 v54, v47
    v_sin_f32 v55, v47
    v_pk_mul_f32 v[52:53], v[52:53], v[44:45] op_sel_hi:[1,0]
    v_exp_f32 v48, v48
    v_cos_f32 v56, v49
    v_sin_f32 v57, v49
    v_pk_mul_f32 v[54:55], v[54:55], v[46:47] op_sel_hi:[1,0]
    v_pk_mul_f32 v[20:21], v[18:19], v[52:53] op_sel:[0,0] op_sel_hi:[0,1] neg_hi:[1,0]
    v_exp_f32 v50, v50
    v_cos_f32 v58, v51
    v_sin_f32 v59, v51
    v_pk_fma_f32 v[20:21], v[18:19], v[52:53], v[20:21] op_sel:[1,1,0] op_sel_hi:[1,0,1] neg_lo:[1,0,0] neg_hi:[1,0,0]
    v_pk_mul_f32 v[56:57], v[56:57], v[48:49] op_sel_hi:[1,0]
    v_pk_mul_f32 v[58:59], v[58:59], v[50:51] op_sel_hi:[1,0]
    ds_read_b128 v[16:19], v15 offset:128

    v_cvt_pk_bf16_f32 v96, v54, v55
    v_lshlrev_b32 v44, 16, v96
    v_and_b32 v45, 0xffff0000, v96
    v_pk_add_f32 v[44:45], v[54:55], v[44:45] neg_lo:[0,1] neg_hi:[0,1]
    v_cvt_pk_bf16_f32 v100, v44, v45
    v_cvt_pk_bf16_f32 v120, v20, v21
    v_lshlrev_b32 v46, 16, v120
    v_and_b32 v47, 0xffff0000, v120
    v_pk_add_f32 v[46:47], v[20:21], v[46:47] neg_lo:[0,1] neg_hi:[0,1]
    v_cvt_pk_bf16_f32 v124, v46, v47
    v_cvt_pk_bf16_f32 v104, v56, v57
    v_lshlrev_b32 v48, 16, v104
    v_and_b32 v49, 0xffff0000, v104
    v_pk_add_f32 v[48:49], v[56:57], v[48:49] neg_lo:[0,1] neg_hi:[0,1]
    v_cvt_pk_bf16_f32 v108, v48, v49
    v_cvt_pk_bf16_f32 v112, v58, v59
    v_lshlrev_b32 v50, 16, v112
    v_and_b32 v51, 0xffff0000, v112
    v_pk_add_f32 v[50:51], v[58:59], v[50:51] neg_lo:[0,1] neg_hi:[0,1]
    v_cvt_pk_bf16_f32 v116, v50, v51
    s_waitcnt lgkmcnt(1)
    v_pk_mul_f32 v[44:45], v[24:25], v[34:35] op_sel:[0,1] op_sel_hi:[1,1]
    v_pk_mul_f32 v[46:47], v[24:25], v[32:33] op_sel:[0,0] op_sel_hi:[1,0]
    v_pk_mul_f32 v[48:49], v[24:25], v[32:33] op_sel:[0,1] op_sel_hi:[1,1]
    v_pk_mul_f32 v[50:51], v[24:25], v[34:35] op_sel:[0,0] op_sel_hi:[1,0]
    v_fract_f32 v45, v45
    v_fract_f32 v47, v47
    v_fract_f32 v49, v49
    v_fract_f32 v51, v51
    v_exp_f32 v44, v44
    v_cos_f32 v52, v45
    v_sin_f32 v53, v45
    v_exp_f32 v46, v46
    v_cos_f32 v54, v47
    v_sin_f32 v55, v47
    v_pk_mul_f32 v[52:53], v[52:53], v[44:45] op_sel_hi:[1,0]
    v_exp_f32 v48, v48
    v_cos_f32 v56, v49
    v_sin_f32 v57, v49
    v_pk_mul_f32 v[54:55], v[54:55], v[46:47] op_sel_hi:[1,0]
    v_pk_mul_f32 v[20:21], v[26:27], v[52:53] op_sel:[0,0] op_sel_hi:[0,1] neg_hi:[1,0]
    v_exp_f32 v50, v50
    v_cos_f32 v58, v51
    v_sin_f32 v59, v51
    v_pk_fma_f32 v[20:21], v[26:27], v[52:53], v[20:21] op_sel:[1,1,0] op_sel_hi:[1,0,1] neg_lo:[1,0,0] neg_hi:[1,0,0]
    v_pk_mul_f32 v[56:57], v[56:57], v[48:49] op_sel_hi:[1,0]
    v_pk_mul_f32 v[58:59], v[58:59], v[50:51] op_sel_hi:[1,0]
    ds_read_b128 v[24:27], v15 offset:192

    v_cvt_pk_bf16_f32 v97, v54, v55
    v_lshlrev_b32 v44, 16, v97
    v_and_b32 v45, 0xffff0000, v97
    v_pk_add_f32 v[44:45], v[54:55], v[44:45] neg_lo:[0,1] neg_hi:[0,1]
    v_cvt_pk_bf16_f32 v101, v44, v45
    v_cvt_pk_bf16_f32 v121, v20, v21
    v_lshlrev_b32 v46, 16, v121
    v_and_b32 v47, 0xffff0000, v121
    v_pk_add_f32 v[46:47], v[20:21], v[46:47] neg_lo:[0,1] neg_hi:[0,1]
    v_cvt_pk_bf16_f32 v125, v46, v47
    v_cvt_pk_bf16_f32 v105, v56, v57
    v_lshlrev_b32 v48, 16, v105
    v_and_b32 v49, 0xffff0000, v105
    v_pk_add_f32 v[48:49], v[56:57], v[48:49] neg_lo:[0,1] neg_hi:[0,1]
    v_cvt_pk_bf16_f32 v109, v48, v49
    v_cvt_pk_bf16_f32 v113, v58, v59
    v_lshlrev_b32 v50, 16, v113
    v_and_b32 v51, 0xffff0000, v113
    v_pk_add_f32 v[50:51], v[58:59], v[50:51] neg_lo:[0,1] neg_hi:[0,1]
    v_cvt_pk_bf16_f32 v117, v50, v51
    s_waitcnt lgkmcnt(1)
    v_pk_mul_f32 v[44:45], v[16:17], v[34:35] op_sel:[0,1] op_sel_hi:[1,1]
    v_pk_mul_f32 v[46:47], v[16:17], v[32:33] op_sel:[0,0] op_sel_hi:[1,0]
    v_pk_mul_f32 v[48:49], v[16:17], v[32:33] op_sel:[0,1] op_sel_hi:[1,1]
    v_pk_mul_f32 v[50:51], v[16:17], v[34:35] op_sel:[0,0] op_sel_hi:[1,0]
    v_fract_f32 v45, v45
    v_fract_f32 v47, v47
    v_fract_f32 v49, v49
    v_fract_f32 v51, v51
    v_exp_f32 v44, v44
    v_cos_f32 v52, v45
    v_sin_f32 v53, v45
    v_exp_f32 v46, v46
    v_cos_f32 v54, v47
    v_sin_f32 v55, v47
    v_pk_mul_f32 v[52:53], v[52:53], v[44:45] op_sel_hi:[1,0]
    v_exp_f32 v48, v48
    v_cos_f32 v56, v49
    v_sin_f32 v57, v49
    v_pk_mul_f32 v[54:55], v[54:55], v[46:47] op_sel_hi:[1,0]
    v_pk_mul_f32 v[20:21], v[18:19], v[52:53] op_sel:[0,0] op_sel_hi:[0,1] neg_hi:[1,0]
    v_exp_f32 v50, v50
    v_cos_f32 v58, v51
    v_sin_f32 v59, v51
    v_pk_fma_f32 v[20:21], v[18:19], v[52:53], v[20:21] op_sel:[1,1,0] op_sel_hi:[1,0,1] neg_lo:[1,0,0] neg_hi:[1,0,0]
    v_pk_mul_f32 v[56:57], v[56:57], v[48:49] op_sel_hi:[1,0]
    v_pk_mul_f32 v[58:59], v[58:59], v[50:51] op_sel_hi:[1,0]
    ds_read_b128 v[16:19], v15 offset:256

    v_cvt_pk_bf16_f32 v98, v54, v55
    v_lshlrev_b32 v44, 16, v98
    v_and_b32 v45, 0xffff0000, v98
    v_pk_add_f32 v[44:45], v[54:55], v[44:45] neg_lo:[0,1] neg_hi:[0,1]
    v_cvt_pk_bf16_f32 v102, v44, v45
    v_cvt_pk_bf16_f32 v122, v20, v21
    v_lshlrev_b32 v46, 16, v122
    v_and_b32 v47, 0xffff0000, v122
    v_pk_add_f32 v[46:47], v[20:21], v[46:47] neg_lo:[0,1] neg_hi:[0,1]
    v_cvt_pk_bf16_f32 v126, v46, v47
    v_cvt_pk_bf16_f32 v106, v56, v57
    v_lshlrev_b32 v48, 16, v106
    v_and_b32 v49, 0xffff0000, v106
    v_pk_add_f32 v[48:49], v[56:57], v[48:49] neg_lo:[0,1] neg_hi:[0,1]
    v_cvt_pk_bf16_f32 v110, v48, v49
    v_cvt_pk_bf16_f32 v114, v58, v59
    v_lshlrev_b32 v50, 16, v114
    v_and_b32 v51, 0xffff0000, v114
    v_pk_add_f32 v[50:51], v[58:59], v[50:51] neg_lo:[0,1] neg_hi:[0,1]
    v_cvt_pk_bf16_f32 v118, v50, v51
    s_waitcnt lgkmcnt(1)
    v_pk_mul_f32 v[44:45], v[24:25], v[34:35] op_sel:[0,1] op_sel_hi:[1,1]
    v_pk_mul_f32 v[46:47], v[24:25], v[32:33] op_sel:[0,0] op_sel_hi:[1,0]
    v_pk_mul_f32 v[48:49], v[24:25], v[32:33] op_sel:[0,1] op_sel_hi:[1,1]
    v_pk_mul_f32 v[50:51], v[24:25], v[34:35] op_sel:[0,0] op_sel_hi:[1,0]
    v_fract_f32 v45, v45
    v_fract_f32 v47, v47
    v_fract_f32 v49, v49
    v_fract_f32 v51, v51
    v_exp_f32 v44, v44
    v_cos_f32 v52, v45
    v_sin_f32 v53, v45
    v_exp_f32 v46, v46
    v_cos_f32 v54, v47
    v_sin_f32 v55, v47
    v_pk_mul_f32 v[52:53], v[52:53], v[44:45] op_sel_hi:[1,0]
    v_exp_f32 v48, v48
    v_cos_f32 v56, v49
    v_sin_f32 v57, v49
    v_pk_mul_f32 v[54:55], v[54:55], v[46:47] op_sel_hi:[1,0]
    v_pk_mul_f32 v[20:21], v[26:27], v[52:53] op_sel:[0,0] op_sel_hi:[0,1] neg_hi:[1,0]
    v_exp_f32 v50, v50
    v_cos_f32 v58, v51
    v_sin_f32 v59, v51
    v_pk_fma_f32 v[20:21], v[26:27], v[52:53], v[20:21] op_sel:[1,1,0] op_sel_hi:[1,0,1] neg_lo:[1,0,0] neg_hi:[1,0,0]
    v_pk_mul_f32 v[56:57], v[56:57], v[48:49] op_sel_hi:[1,0]
    v_pk_mul_f32 v[58:59], v[58:59], v[50:51] op_sel_hi:[1,0]
    ds_read_b128 v[24:27], v15 offset:320

    v_cvt_pk_bf16_f32 v99, v54, v55
    v_lshlrev_b32 v44, 16, v99
    v_and_b32 v45, 0xffff0000, v99
    v_pk_add_f32 v[44:45], v[54:55], v[44:45] neg_lo:[0,1] neg_hi:[0,1]
    v_cvt_pk_bf16_f32 v103, v44, v45
    v_cvt_pk_bf16_f32 v123, v20, v21
    v_lshlrev_b32 v46, 16, v123
    v_and_b32 v47, 0xffff0000, v123
    v_pk_add_f32 v[46:47], v[20:21], v[46:47] neg_lo:[0,1] neg_hi:[0,1]
    v_cvt_pk_bf16_f32 v127, v46, v47
    v_cvt_pk_bf16_f32 v107, v56, v57
    v_lshlrev_b32 v48, 16, v107
    v_and_b32 v49, 0xffff0000, v107
    v_pk_add_f32 v[48:49], v[56:57], v[48:49] neg_lo:[0,1] neg_hi:[0,1]
    v_cvt_pk_bf16_f32 v111, v48, v49
    v_cvt_pk_bf16_f32 v115, v58, v59
    v_lshlrev_b32 v50, 16, v115
    v_and_b32 v51, 0xffff0000, v115
    v_pk_add_f32 v[50:51], v[58:59], v[50:51] neg_lo:[0,1] neg_hi:[0,1]
    v_cvt_pk_bf16_f32 v119, v50, v51
    s_nop 1
    v_add_u32 v15, 256, v15
    v_mfma_f32_16x16x32_bf16 v[60:63], v[96:99], v[120:123], v[60:63]
    v_mfma_f32_16x16x32_bf16 v[64:67], v[104:107], v[120:123], v[64:67]
    v_mfma_f32_16x16x32_bf16 v[68:71], v[112:115], v[120:123], v[68:71]
    v_mfma_f32_16x16x32_bf16 v[60:63], v[96:99], v[124:127], v[60:63]
    v_mfma_f32_16x16x32_bf16 v[64:67], v[104:107], v[124:127], v[64:67]
    v_mfma_f32_16x16x32_bf16 v[68:71], v[112:115], v[124:127], v[68:71]
    v_mfma_f32_16x16x32_bf16 v[60:63], v[100:103], v[120:123], v[60:63]
    v_mfma_f32_16x16x32_bf16 v[64:67], v[108:111], v[120:123], v[64:67]
    v_mfma_f32_16x16x32_bf16 v[68:71], v[116:119], v[120:123], v[68:71]
    s_waitcnt vmcnt(5)
    s_waitcnt lgkmcnt(0)
    s_add_u32 s28, s4, 0x0
    s_addc_u32 s29, s5, 0
    s_add_u32 s30, s4, 0x200000
    s_addc_u32 s31, s5, 0
    v_and_b32 v95, 63, v0
    v_mul_u32_u24 v28, 1056, v2
    v_lshl_add_u32 v28, v95, 4, v28
    ds_write_b128 v28, v[76:79] offset:41216

    v_lshlrev_b32 v80, 16, v76
    v_and_b32 v81, 0xffff0000, v76
    v_lshlrev_b32 v82, 16, v77
    v_and_b32 v83, 0xffff0000, v77
    v_lshlrev_b32 v84, 16, v78
    v_and_b32 v85, 0xffff0000, v78
    v_lshlrev_b32 v86, 16, v79
    v_and_b32 v87, 0xffff0000, v79
    v_pk_add_f32 v[88:89], v[80:81], v[82:83]
    v_pk_add_f32 v[90:91], v[84:85], v[86:87]
    v_pk_add_f32 v[88:89], v[88:89], v[90:91]
    v_add_f32 v88, v88, v89

    s_nop 1
    v_add_f32_dpp v88, v88, v88 row_ror:8 row_mask:0xf bank_mask:0xf
    s_nop 1
    v_add_f32_dpp v88, v88, v88 row_ror:4 row_mask:0xf bank_mask:0xf
    s_nop 1
    v_add_f32_dpp v88, v88, v88 row_ror:2 row_mask:0xf bank_mask:0xf
    s_nop 1
    v_add_f32_dpp v88, v88, v88 row_ror:1 row_mask:0xf bank_mask:0xf
    v_mov_b32 v89, v88
    s_nop 1
    v_permlane16_swap_b32 v88, v89
    s_nop 1
    v_add_f32 v88, v88, v89
    v_mov_b32 v89, v88
    s_nop 1
    v_permlane32_swap_b32 v88, v89
    s_nop 1
    v_add_f32 v88, v88, v89
    v_mul_f32 v88, 0x3b000000, v88
    v_mov_b32 v90, 0
    v_mov_b32 v91, 0
    v_pk_add_f32 v[92:93], v[80:81], v[88:89] op_sel_hi:[1,0] neg_lo:[0,1] neg_hi:[0,1]
    v_pk_fma_f32 v[90:91], v[92:93], v[92:93], v[90:91]
    v_pk_add_f32 v[92:93], v[82:83], v[88:89] op_sel_hi:[1,0] neg_lo:[0,1] neg_hi:[0,1]
    v_pk_fma_f32 v[90:91], v[92:93], v[92:93], v[90:91]
    v_pk_add_f32 v[92:93], v[84:85], v[88:89] op_sel_hi:[1,0] neg_lo:[0,1] neg_hi:[0,1]
    v_pk_fma_f32 v[90:91], v[92:93], v[92:93], v[90:91]
    v_pk_add_f32 v[92:93], v[86:87], v[88:89] op_sel_hi:[1,0] neg_lo:[0,1] neg_hi:[0,1]
    v_pk_fma_f32 v[90:91], v[92:93], v[92:93], v[90:91]
    v_add_f32 v90, v90, v91
    s_nop 1
    v_add_f32_dpp v90, v90, v90 row_ror:8 row_mask:0xf bank_mask:0xf
    s_nop 1
    v_add_f32_dpp v90, v90, v90 row_ror:4 row_mask:0xf bank_mask:0xf
    s_nop 1
    v_add_f32_dpp v90, v90, v90 row_ror:2 row_mask:0xf bank_mask:0xf
    s_nop 1
    v_add_f32_dpp v90, v90, v90 row_ror:1 row_mask:0xf bank_mask:0xf
    v_mov_b32 v91, v90
    s_nop 1
    v_permlane16_swap_b32 v90, v91
    s_nop 1
    v_add_f32 v90, v90, v91
    v_mov_b32 v91, v90
    s_nop 1
    v_permlane32_swap_b32 v90, v91
    s_nop 1
    v_add_f32 v90, v90, v91
    v_mul_f32 v90, 0x3b000000, v90
    v_cvt_pk_bf16_f32 v92, v88, v90
    v_lshlrev_b32 v88, 16, v92
    v_and_b32 v90, 0xffff0000, v92
    v_add_f32 v90, 0x3727c5ac, v90
    v_cvt_pk_bf16_f32 v92, v90, v90
    v_lshlrev_b32 v90, 16, v92
    v_sqrt_f32 v90, v90
    s_nop 0
    v_cvt_pk_bf16_f32 v92, v90, v90
    v_lshlrev_b32 v90, 16, v92
    v_rcp_f32 v90, v90
    s_nop 0
    v_pk_add_f32 v[80:81], v[80:81], v[88:89] op_sel_hi:[1,0] neg_lo:[0,1] neg_hi:[0,1]
    v_cvt_pk_bf16_f32 v92, v80, v81
    v_lshlrev_b32 v80, 16, v92
    v_and_b32 v81, 0xffff0000, v92
    v_pk_mul_f32 v[80:81], v[80:81], v[90:91] op_sel_hi:[1,0]
    v_cvt_pk_bf16_f32 v76, v80, v81
    v_lshlrev_b32 v80, 16, v76
    v_and_b32 v81, 0xffff0000, v76
    v_cvt_pk_f16_f32 v76, v80, v81
    v_pk_add_f32 v[82:83], v[82:83], v[88:89] op_sel_hi:[1,0] neg_lo:[0,1] neg_hi:[0,1]
    v_cvt_pk_bf16_f32 v92, v82, v83
    v_lshlrev_b32 v82, 16, v92
    v_and_b32 v83, 0xffff0000, v92
    v_pk_mul_f32 v[82:83], v[82:83], v[90:91] op_sel_hi:[1,0]
    v_cvt_pk_bf16_f32 v77, v82, v83
    v_lshlrev_b32 v82, 16, v77
    v_and_b32 v83, 0xffff0000, v77
    v_cvt_pk_f16_f32 v77, v82, v83
    v_pk_add_f32 v[84:85], v[84:85], v[88:89] op_sel_hi:[1,0] neg_lo:[0,1] neg_hi:[0,1]
    v_cvt_pk_bf16_f32 v92, v84, v85
    v_lshlrev_b32 v84, 16, v92
    v_and_b32 v85, 0xffff0000, v92
    v_pk_mul_f32 v[84:85], v[84:85], v[90:91] op_sel_hi:[1,0]
    v_cvt_pk_bf16_f32 v78, v84, v85
    v_lshlrev_b32 v84, 16, v78
    v_and_b32 v85, 0xffff0000, v78
    v_cvt_pk_f16_f32 v78, v84, v85
    v_pk_add_f32 v[86:87], v[86:87], v[88:89] op_sel_hi:[1,0] neg_lo:[0,1] neg_hi:[0,1]
    v_cvt_pk_bf16_f32 v92, v86, v87
    v_lshlrev_b32 v86, 16, v92
    v_and_b32 v87, 0xffff0000, v92
    v_pk_mul_f32 v[86:87], v[86:87], v[90:91] op_sel_hi:[1,0]
    v_cvt_pk_bf16_f32 v79, v86, v87
    v_lshlrev_b32 v86, 16, v79
    v_and_b32 v87, 0xffff0000, v79
    v_cvt_pk_f16_f32 v79, v86, v87
    ds_write_b128 v28, v[76:79] offset:32768
    v_bfe_u32 v28, v0, 2, 2
    v_mul_u32_u24 v28, 1056, v28
    v_lshrrev_b32 v29, 4, v0
    v_lshlrev_b32 v29, 5, v29
    v_and_b32 v95, 3, v0
    v_lshlrev_b32 v95, 3, v95
    v_add3_u32 v28, v28, v29, v95
    v_lshrrev_b32 v94, 1, v0
    v_lshlrev_b32 v94, 13, v94
    v_and_b32 v95, 1, v0
    v_lshl_add_u32 v94, v95, 4, v94
    s_lshl_b32 s26, s2, 5
    v_add_u32 v94, s26, v94
    s_waitcnt lgkmcnt(0)
    s_barrier
    ds_read_b64_tr_b16 v[76:77], v28 offset:32768
    ds_read_b64_tr_b16 v[78:79], v28 offset:36992
    ds_read_b64_tr_b16 v[80:81], v28 offset:41216
    ds_read_b64_tr_b16 v[82:83], v28 offset:45440
    s_waitcnt lgkmcnt(2)
    global_store_dwordx4 v94, v[76:79], s[28:29] sc1
    s_waitcnt lgkmcnt(0)
    global_store_dwordx4 v94, v[80:83], s[30:31] sc1

    s_waitcnt lgkmcnt(1)
    v_pk_mul_f32 v[44:45], v[16:17], v[34:35] op_sel:[0,1] op_sel_hi:[1,1]
    v_pk_mul_f32 v[46:47], v[16:17], v[32:33] op_sel:[0,0] op_sel_hi:[1,0]
    v_pk_mul_f32 v[48:49], v[16:17], v[32:33] op_sel:[0,1] op_sel_hi:[1,1]
    v_pk_mul_f32 v[50:51], v[16:17], v[34:35] op_sel:[0,0] op_sel_hi:[1,0]
    v_fract_f32 v45, v45
    v_fract_f32 v47, v47
    v_fract_f32 v49, v49
    v_fract_f32 v51, v51
    v_exp_f32 v44, v44
    v_cos_f32 v52, v45
    v_sin_f32 v53, v45
    v_exp_f32 v46, v46
    v_cos_f32 v54, v47
    v_sin_f32 v55, v47
    v_pk_mul_f32 v[52:53], v[52:53], v[44:45] op_sel_hi:[1,0]
    v_exp_f32 v48, v48
    v_cos_f32 v56, v49
    v_sin_f32 v57, v49
    v_pk_mul_f32 v[54:55], v[54:55], v[46:47] op_sel_hi:[1,0]
    v_pk_mul_f32 v[20:21], v[18:19], v[52:53] op_sel:[0,0] op_sel_hi:[0,1] neg_hi:[1,0]
    v_exp_f32 v50, v50
    v_cos_f32 v58, v51
    v_sin_f32 v59, v51
    v_pk_fma_f32 v[20:21], v[18:19], v[52:53], v[20:21] op_sel:[1,1,0] op_sel_hi:[1,0,1] neg_lo:[1,0,0] neg_hi:[1,0,0]
    v_pk_mul_f32 v[56:57], v[56:57], v[48:49] op_sel_hi:[1,0]
    v_pk_mul_f32 v[58:59], v[58:59], v[50:51] op_sel_hi:[1,0]
    ds_read_b128 v[16:19], v15 offset:128

    v_cvt_pk_bf16_f32 v96, v54, v55
    v_lshlrev_b32 v44, 16, v96
    v_and_b32 v45, 0xffff0000, v96
    v_pk_add_f32 v[44:45], v[54:55], v[44:45] neg_lo:[0,1] neg_hi:[0,1]
    v_cvt_pk_bf16_f32 v100, v44, v45
    v_cvt_pk_bf16_f32 v120, v20, v21
    v_lshlrev_b32 v46, 16, v120
    v_and_b32 v47, 0xffff0000, v120
    v_pk_add_f32 v[46:47], v[20:21], v[46:47] neg_lo:[0,1] neg_hi:[0,1]
    v_cvt_pk_bf16_f32 v124, v46, v47
    v_cvt_pk_bf16_f32 v104, v56, v57
    v_lshlrev_b32 v48, 16, v104
    v_and_b32 v49, 0xffff0000, v104
    v_pk_add_f32 v[48:49], v[56:57], v[48:49] neg_lo:[0,1] neg_hi:[0,1]
    v_cvt_pk_bf16_f32 v108, v48, v49
    v_cvt_pk_bf16_f32 v112, v58, v59
    v_lshlrev_b32 v50, 16, v112
    v_and_b32 v51, 0xffff0000, v112
    v_pk_add_f32 v[50:51], v[58:59], v[50:51] neg_lo:[0,1] neg_hi:[0,1]
    v_cvt_pk_bf16_f32 v116, v50, v51
    s_waitcnt lgkmcnt(1)
    v_pk_mul_f32 v[44:45], v[24:25], v[34:35] op_sel:[0,1] op_sel_hi:[1,1]
    v_pk_mul_f32 v[46:47], v[24:25], v[32:33] op_sel:[0,0] op_sel_hi:[1,0]
    v_pk_mul_f32 v[48:49], v[24:25], v[32:33] op_sel:[0,1] op_sel_hi:[1,1]
    v_pk_mul_f32 v[50:51], v[24:25], v[34:35] op_sel:[0,0] op_sel_hi:[1,0]
    v_fract_f32 v45, v45
    v_fract_f32 v47, v47
    v_fract_f32 v49, v49
    v_fract_f32 v51, v51
    v_exp_f32 v44, v44
    v_cos_f32 v52, v45
    v_sin_f32 v53, v45
    v_exp_f32 v46, v46
    v_cos_f32 v54, v47
    v_sin_f32 v55, v47
    v_pk_mul_f32 v[52:53], v[52:53], v[44:45] op_sel_hi:[1,0]
    v_exp_f32 v48, v48
    v_cos_f32 v56, v49
    v_sin_f32 v57, v49
    v_pk_mul_f32 v[54:55], v[54:55], v[46:47] op_sel_hi:[1,0]
    v_pk_mul_f32 v[20:21], v[26:27], v[52:53] op_sel:[0,0] op_sel_hi:[0,1] neg_hi:[1,0]
    v_exp_f32 v50, v50
    v_cos_f32 v58, v51
    v_sin_f32 v59, v51
    v_pk_fma_f32 v[20:21], v[26:27], v[52:53], v[20:21] op_sel:[1,1,0] op_sel_hi:[1,0,1] neg_lo:[1,0,0] neg_hi:[1,0,0]
    v_pk_mul_f32 v[56:57], v[56:57], v[48:49] op_sel_hi:[1,0]
    v_pk_mul_f32 v[58:59], v[58:59], v[50:51] op_sel_hi:[1,0]
    ds_read_b128 v[24:27], v15 offset:192

    v_cvt_pk_bf16_f32 v97, v54, v55
    v_lshlrev_b32 v44, 16, v97
    v_and_b32 v45, 0xffff0000, v97
    v_pk_add_f32 v[44:45], v[54:55], v[44:45] neg_lo:[0,1] neg_hi:[0,1]
    v_cvt_pk_bf16_f32 v101, v44, v45
    v_cvt_pk_bf16_f32 v121, v20, v21
    v_lshlrev_b32 v46, 16, v121
    v_and_b32 v47, 0xffff0000, v121
    v_pk_add_f32 v[46:47], v[20:21], v[46:47] neg_lo:[0,1] neg_hi:[0,1]
    v_cvt_pk_bf16_f32 v125, v46, v47
    v_cvt_pk_bf16_f32 v105, v56, v57
    v_lshlrev_b32 v48, 16, v105
    v_and_b32 v49, 0xffff0000, v105
    v_pk_add_f32 v[48:49], v[56:57], v[48:49] neg_lo:[0,1] neg_hi:[0,1]
    v_cvt_pk_bf16_f32 v109, v48, v49
    v_cvt_pk_bf16_f32 v113, v58, v59
    v_lshlrev_b32 v50, 16, v113
    v_and_b32 v51, 0xffff0000, v113
    v_pk_add_f32 v[50:51], v[58:59], v[50:51] neg_lo:[0,1] neg_hi:[0,1]
    v_cvt_pk_bf16_f32 v117, v50, v51
    s_waitcnt lgkmcnt(1)
    v_pk_mul_f32 v[44:45], v[16:17], v[34:35] op_sel:[0,1] op_sel_hi:[1,1]
    v_pk_mul_f32 v[46:47], v[16:17], v[32:33] op_sel:[0,0] op_sel_hi:[1,0]
    v_pk_mul_f32 v[48:49], v[16:17], v[32:33] op_sel:[0,1] op_sel_hi:[1,1]
    v_pk_mul_f32 v[50:51], v[16:17], v[34:35] op_sel:[0,0] op_sel_hi:[1,0]
    v_fract_f32 v45, v45
    v_fract_f32 v47, v47
    v_fract_f32 v49, v49
    v_fract_f32 v51, v51
    v_exp_f32 v44, v44
    v_cos_f32 v52, v45
    v_sin_f32 v53, v45
    v_exp_f32 v46, v46
    v_cos_f32 v54, v47
    v_sin_f32 v55, v47
    v_pk_mul_f32 v[52:53], v[52:53], v[44:45] op_sel_hi:[1,0]
    v_exp_f32 v48, v48
    v_cos_f32 v56, v49
    v_sin_f32 v57, v49
    v_pk_mul_f32 v[54:55], v[54:55], v[46:47] op_sel_hi:[1,0]
    v_pk_mul_f32 v[20:21], v[18:19], v[52:53] op_sel:[0,0] op_sel_hi:[0,1] neg_hi:[1,0]
    v_exp_f32 v50, v50
    v_cos_f32 v58, v51
    v_sin_f32 v59, v51
    v_pk_fma_f32 v[20:21], v[18:19], v[52:53], v[20:21] op_sel:[1,1,0] op_sel_hi:[1,0,1] neg_lo:[1,0,0] neg_hi:[1,0,0]
    v_pk_mul_f32 v[56:57], v[56:57], v[48:49] op_sel_hi:[1,0]
    v_pk_mul_f32 v[58:59], v[58:59], v[50:51] op_sel_hi:[1,0]
    ds_read_b128 v[16:19], v15 offset:256

    v_cvt_pk_bf16_f32 v98, v54, v55
    v_lshlrev_b32 v44, 16, v98
    v_and_b32 v45, 0xffff0000, v98
    v_pk_add_f32 v[44:45], v[54:55], v[44:45] neg_lo:[0,1] neg_hi:[0,1]
    v_cvt_pk_bf16_f32 v102, v44, v45
    v_cvt_pk_bf16_f32 v122, v20, v21
    v_lshlrev_b32 v46, 16, v122
    v_and_b32 v47, 0xffff0000, v122
    v_pk_add_f32 v[46:47], v[20:21], v[46:47] neg_lo:[0,1] neg_hi:[0,1]
    v_cvt_pk_bf16_f32 v126, v46, v47
    v_cvt_pk_bf16_f32 v106, v56, v57
    v_lshlrev_b32 v48, 16, v106
    v_and_b32 v49, 0xffff0000, v106
    v_pk_add_f32 v[48:49], v[56:57], v[48:49] neg_lo:[0,1] neg_hi:[0,1]
    v_cvt_pk_bf16_f32 v110, v48, v49
    v_cvt_pk_bf16_f32 v114, v58, v59
    v_lshlrev_b32 v50, 16, v114
    v_and_b32 v51, 0xffff0000, v114
    v_pk_add_f32 v[50:51], v[58:59], v[50:51] neg_lo:[0,1] neg_hi:[0,1]
    v_cvt_pk_bf16_f32 v118, v50, v51
    s_waitcnt lgkmcnt(1)
    v_pk_mul_f32 v[44:45], v[24:25], v[34:35] op_sel:[0,1] op_sel_hi:[1,1]
    v_pk_mul_f32 v[46:47], v[24:25], v[32:33] op_sel:[0,0] op_sel_hi:[1,0]
    v_pk_mul_f32 v[48:49], v[24:25], v[32:33] op_sel:[0,1] op_sel_hi:[1,1]
    v_pk_mul_f32 v[50:51], v[24:25], v[34:35] op_sel:[0,0] op_sel_hi:[1,0]
    v_fract_f32 v45, v45
    v_fract_f32 v47, v47
    v_fract_f32 v49, v49
    v_fract_f32 v51, v51
    v_exp_f32 v44, v44
    v_cos_f32 v52, v45
    v_sin_f32 v53, v45
    v_exp_f32 v46, v46
    v_cos_f32 v54, v47
    v_sin_f32 v55, v47
    v_pk_mul_f32 v[52:53], v[52:53], v[44:45] op_sel_hi:[1,0]
    v_exp_f32 v48, v48
    v_cos_f32 v56, v49
    v_sin_f32 v57, v49
    v_pk_mul_f32 v[54:55], v[54:55], v[46:47] op_sel_hi:[1,0]
    v_pk_mul_f32 v[20:21], v[26:27], v[52:53] op_sel:[0,0] op_sel_hi:[0,1] neg_hi:[1,0]
    v_exp_f32 v50, v50
    v_cos_f32 v58, v51
    v_sin_f32 v59, v51
    v_pk_fma_f32 v[20:21], v[26:27], v[52:53], v[20:21] op_sel:[1,1,0] op_sel_hi:[1,0,1] neg_lo:[1,0,0] neg_hi:[1,0,0]
    v_pk_mul_f32 v[56:57], v[56:57], v[48:49] op_sel_hi:[1,0]
    v_pk_mul_f32 v[58:59], v[58:59], v[50:51] op_sel_hi:[1,0]
    ds_read_b128 v[24:27], v15 offset:320

    v_cvt_pk_bf16_f32 v99, v54, v55
    v_lshlrev_b32 v44, 16, v99
    v_and_b32 v45, 0xffff0000, v99
    v_pk_add_f32 v[44:45], v[54:55], v[44:45] neg_lo:[0,1] neg_hi:[0,1]
    v_cvt_pk_bf16_f32 v103, v44, v45
    v_cvt_pk_bf16_f32 v123, v20, v21
    v_lshlrev_b32 v46, 16, v123
    v_and_b32 v47, 0xffff0000, v123
    v_pk_add_f32 v[46:47], v[20:21], v[46:47] neg_lo:[0,1] neg_hi:[0,1]
    v_cvt_pk_bf16_f32 v127, v46, v47
    v_cvt_pk_bf16_f32 v107, v56, v57
    v_lshlrev_b32 v48, 16, v107
    v_and_b32 v49, 0xffff0000, v107
    v_pk_add_f32 v[48:49], v[56:57], v[48:49] neg_lo:[0,1] neg_hi:[0,1]
    v_cvt_pk_bf16_f32 v111, v48, v49
    v_cvt_pk_bf16_f32 v115, v58, v59
    v_lshlrev_b32 v50, 16, v115
    v_and_b32 v51, 0xffff0000, v115
    v_pk_add_f32 v[50:51], v[58:59], v[50:51] neg_lo:[0,1] neg_hi:[0,1]
    v_cvt_pk_bf16_f32 v119, v50, v51
    s_nop 1
    v_add_u32 v15, 256, v15
    v_mfma_f32_16x16x32_bf16 v[60:63], v[96:99], v[120:123], v[60:63]
    v_mfma_f32_16x16x32_bf16 v[64:67], v[104:107], v[120:123], v[64:67]
    v_mfma_f32_16x16x32_bf16 v[68:71], v[112:115], v[120:123], v[68:71]
    v_mfma_f32_16x16x32_bf16 v[60:63], v[96:99], v[124:127], v[60:63]
    v_mfma_f32_16x16x32_bf16 v[64:67], v[104:107], v[124:127], v[64:67]
    v_mfma_f32_16x16x32_bf16 v[68:71], v[112:115], v[124:127], v[68:71]
    v_mfma_f32_16x16x32_bf16 v[60:63], v[100:103], v[120:123], v[60:63]
    v_mfma_f32_16x16x32_bf16 v[64:67], v[108:111], v[120:123], v[64:67]
    v_mfma_f32_16x16x32_bf16 v[68:71], v[116:119], v[120:123], v[68:71]
    s_waitcnt lgkmcnt(0)
    v_and_b32 v8, 63, v0
    v_bfe_u32 v9, v0, 6, 2
    v_lshlrev_b32 v8, 5, v8
    v_lshl_add_u32 v8, v9, 3, v8
    v_cmp_gt_u32 vcc, 256, v8
    v_cvt_f32_u32 v9, v8
    v_lshrrev_b32 v11, 8, v0
    v_mul_u32_u24 v11, 12288, v11
    v_add_u32 v11, 4096, v11
    v_lshl_add_u32 v10, v8, 2, v11
    v_subrev_u32 v11, 68096, v11

    v_add_f32 v12, 0x40e00000, v9
    v_add_f32 v13, 0x40c00000, v9
    v_cvt_pk_bf16_f32 v12, v12, v13
    v_lshrrev_b32 v13, 16, v12
    v_and_b32 v12, 0xffff, v12
    v_lshl_add_u32 v12, v12, 2, v11
    v_lshl_add_u32 v13, v13, 2, v11
    v_add_u32 v14, 28, v10
    v_add_u32 v16, 24, v10
    v_cndmask_b32 v24, v12, v14, vcc
    v_cndmask_b32 v25, v13, v16, vcc
    v_add_f32 v12, 0x40a00000, v9
    v_add_f32 v13, 0x40800000, v9
    v_cvt_pk_bf16_f32 v12, v12, v13
    v_lshrrev_b32 v13, 16, v12
    v_and_b32 v12, 0xffff, v12
    v_lshl_add_u32 v12, v12, 2, v11
    v_lshl_add_u32 v13, v13, 2, v11
    v_add_u32 v14, 20, v10
    v_add_u32 v16, 16, v10
    v_cndmask_b32 v26, v12, v14, vcc
    v_cndmask_b32 v27, v13, v16, vcc
    v_add_f32 v12, 0x40400000, v9
    v_add_f32 v13, 0x40000000, v9
    v_cvt_pk_bf16_f32 v12, v12, v13
    v_lshrrev_b32 v13, 16, v12
    v_and_b32 v12, 0xffff, v12
    v_lshl_add_u32 v12, v12, 2, v11
    v_lshl_add_u32 v13, v13, 2, v11
    v_add_u32 v14, 12, v10
    v_add_u32 v16, 8, v10
    v_cndmask_b32 v28, v12, v14, vcc
    v_cndmask_b32 v29, v13, v16, vcc
    v_add_f32 v12, 0x3f800000, v9
    v_add_f32 v13, 0x0, v9
    v_cvt_pk_bf16_f32 v12, v12, v13
    v_lshrrev_b32 v13, 16, v12
    v_and_b32 v12, 0xffff, v12
    v_lshl_add_u32 v12, v12, 2, v11
    v_lshl_add_u32 v13, v13, 2, v11
    v_add_u32 v14, 4, v10
    v_add_u32 v16, 0, v10
    v_cndmask_b32 v30, v12, v14, vcc
    v_cndmask_b32 v31, v13, v16, vcc
    v_max3_f32 v14, |v60|, |v61|, |v62|
    v_max3_f32 v16, |v63|, |v64|, |v65|
    v_max3_f32 v17, |v66|, |v67|, |v68|
    v_max3_f32 v18, |v69|, |v70|, |v71|
    v_max3_f32 v14, v14, v16, v17
    v_max_f32 v14, v14, v18

    s_nop 1
    v_max_f32_dpp v14, v14, v14 row_ror:8 row_mask:0xf bank_mask:0xf
    s_nop 1
    v_max_f32_dpp v14, v14, v14 row_ror:4 row_mask:0xf bank_mask:0xf
    s_nop 1
    v_max_f32_dpp v14, v14, v14 row_ror:2 row_mask:0xf bank_mask:0xf
    s_nop 1
    v_max_f32_dpp v14, v14, v14 row_ror:1 row_mask:0xf bank_mask:0xf
    v_mov_b32 v16, v14
    s_nop 1
    v_permlane16_swap_b32 v14, v16
    s_nop 1
    v_max_f32 v14, v14, v16
    v_mov_b32 v16, v14
    s_nop 1
    v_permlane32_swap_b32 v14, v16
    s_nop 1
    v_max_f32 v14, v14, v16
    v_lshlrev_b32 v16, 2, v2
    ds_write_b32 v16, v14 offset:28672

    ds_write_b32 v36, v60 offset:0
    ds_write_b32 v36, v61 offset:4
    ds_write_b32 v36, v62 offset:8
    ds_write_b32 v36, v63 offset:12
    ds_write_b32 v37, v64 offset:0
    ds_write_b32 v37, v65 offset:4
    ds_write_b32 v38, v66 offset:0
    ds_write_b32 v38, v67 offset:4
    ds_write_b32 v39, v68 offset:0
    ds_write_b32 v39, v69 offset:64
    ds_write_b32 v39, v70 offset:128
    ds_write_b32 v39, v71 offset:192
    s_lshl_b32 s26, s3, 12
    v_lshl_add_u32 v12, v0, 4, s26
    s_waitcnt lgkmcnt(0)
    s_barrier

    v_lshrrev_b32 v15, 8, v0
    v_lshlrev_b32 v15, 4, v15
    ds_read_b128 v[16:19], v15 offset:28672
    ds_read_b32 v32, v24 offset:0
    ds_read_b32 v33, v24 offset:3072
    ds_read_b32 v34, v24 offset:6144
    ds_read_b32 v35, v24 offset:9216
    ds_read_b32 v36, v25 offset:0
    ds_read_b32 v37, v25 offset:3072
    ds_read_b32 v38, v25 offset:6144
    ds_read_b32 v39, v25 offset:9216
    ds_read_b32 v40, v26 offset:0
    ds_read_b32 v41, v26 offset:3072
    ds_read_b32 v42, v26 offset:6144
    ds_read_b32 v43, v26 offset:9216
    ds_read_b32 v44, v27 offset:0
    ds_read_b32 v45, v27 offset:3072
    ds_read_b32 v46, v27 offset:6144
    ds_read_b32 v47, v27 offset:9216
    ds_read_b32 v48, v28 offset:0
    ds_read_b32 v49, v28 offset:3072
    ds_read_b32 v50, v28 offset:6144
    ds_read_b32 v51, v28 offset:9216
    ds_read_b32 v52, v29 offset:0
    ds_read_b32 v53, v29 offset:3072
    ds_read_b32 v54, v29 offset:6144
    ds_read_b32 v55, v29 offset:9216
    ds_read_b32 v56, v30 offset:0
    ds_read_b32 v57, v30 offset:3072
    ds_read_b32 v58, v30 offset:6144
    ds_read_b32 v59, v30 offset:9216
    ds_read_b32 v60, v31 offset:0
    ds_read_b32 v61, v31 offset:3072
    ds_read_b32 v62, v31 offset:6144
    ds_read_b32 v63, v31 offset:9216
    s_waitcnt lgkmcnt(0)
    v_add_f32 v32, v32, v33
    v_add_f32 v34, v34, v35
    v_add_f32 v36, v36, v37
    v_add_f32 v38, v38, v39
    v_add_f32 v40, v40, v41
    v_add_f32 v42, v42, v43
    v_add_f32 v44, v44, v45
    v_add_f32 v46, v46, v47
    v_add_f32 v48, v48, v49
    v_add_f32 v50, v50, v51
    v_add_f32 v52, v52, v53
    v_add_f32 v54, v54, v55
    v_add_f32 v56, v56, v57
    v_add_f32 v58, v58, v59
    v_add_f32 v60, v60, v61
    v_add_f32 v62, v62, v63
    v_add_f32 v32, v32, v34
    v_add_f32 v36, v36, v38
    v_add_f32 v40, v40, v42
    v_add_f32 v44, v44, v46
    v_add_f32 v48, v48, v50
    v_add_f32 v52, v52, v54
    v_add_f32 v56, v56, v58
    v_add_f32 v60, v60, v62
    v_add_f32 v14, v16, v17
    v_add_f32 v15, v18, v19
    v_add_f32 v14, v14, v15
    v_lshrrev_b32 v14, 23, v14
    v_max_u32 v14, 15, v14
    v_sub_u32 v15, 268, v14
    v_lshlrev_b32 v15, 23, v15
    v_subrev_u32 v14, 14, v14
    v_lshlrev_b32 v14, 23, v14

    v_mul_f32 v32, v32, v15
    v_mul_f32 v36, v36, v15
    v_mul_f32 v40, v40, v15
    v_mul_f32 v44, v44, v15
    v_mul_f32 v48, v48, v15
    v_mul_f32 v52, v52, v15
    v_mul_f32 v56, v56, v15
    v_mul_f32 v60, v60, v15
    v_cvt_pk_f16_f32 v64, v32, v36
    v_cvt_pk_f16_f32 v65, v40, v44
    v_cvt_pk_f16_f32 v66, v48, v52
    v_cvt_pk_f16_f32 v67, v56, v60
    global_store_dwordx4 v12, v[64:67], s[22:23]
    s_add_u32 s24, s4, 0x1a08000
    s_addc_u32 s25, s5, 0
    v_and_b32 v16, 255, v0
    v_cmp_eq_u32 vcc, 0, v16
    v_lshlrev_b32 v16, 2, v1
    s_and_saveexec_b64 s[26:27], vcc
    s_cbranch_execz K1_nosc
    global_store_dword v16, v14, s[24:25]

K1_nosc:
    s_mov_b64 exec, s[26:27]
K1_end:
K1_exit:
    s_endpgm
.text
.globl k2_kernel
.p2align 8
.type k2_kernel,@function
k2_kernel:
    s_cmp_ge_u32 s2, 256
    s_cbranch_scc1 K2_exit
    s_load_dwordx2 s[4:5], s[0:1], 128
    s_load_dwordx2 s[6:7], s[0:1], 64
    s_load_dwordx4 s[40:43], s[0:1], 80
    s_load_dwordx2 s[44:45], s[0:1], 96

    v_lshrrev_b32 v1, 6, v0
    v_and_b32 v2, 63, v0
    v_readfirstlane_b32 s30, v1
    s_and_b32 s3, s30, 3
    s_lshl_b32 s16, s2, 1
    s_lshr_b32 s17, s3, 1
    s_and_b32 s18, s3, 1
    s_add_u32 s19, s16, s17
    s_mul_i32 s20, s17, 45568
    s_lshl_b32 s26, s2, 13
    v_lshrrev_b32 v57, 1, v0
    v_and_b32 v56, 1, v0
    v_lshl_add_u32 v4, v0, 4, s26
    v_mul_u32_u24 v58, 45568, v56
    v_cmp_eq_u32 s[58:59], 0, v57
    v_subrev_u32 v5, 32, v4
    v_lshl_add_u32 v120, v57, 4, v58
    v_cndmask_b32 v5, v5, v4, s[58:59]
    v_add_u32 v120, 64, v120
    s_waitcnt lgkmcnt(0)

    s_add_u32 s8, s4, 0x0
    s_addc_u32 s9, s5, 0
    global_load_dwordx4 v[8:11], v5, s[8:9]
    global_load_dwordx4 v[12:15], v4, s[8:9]
    s_cmp_ge_u32 s30, 4
    s_cbranch_scc1 K2_helper

    s_add_u32 s10, s4, 0x200000
    s_addc_u32 s11, s5, 0
    s_add_u32 s22, s4, 0x800000
    s_addc_u32 s23, s5, 0
    s_add_u32 s32, s4, 0x1a08000
    s_addc_u32 s33, s5, 0
    v_and_b32 v6, 31, v2
    v_lshrrev_b32 v7, 5, v2
    v_lshlrev_b32 v40, 6, v6
    v_lshl_add_u32 v40, v7, 3, v40
    s_lshl_b32 s27, s18, 11
    v_add_u32 v122, s27, v40
    s_lshl_b32 s26, s18, 5
    v_add_u32 v121, s26, v6
    v_lshlrev_b32 v121, 7, v121
    v_lshl_add_u32 v121, v7, 3, v121
    s_lshl_b32 s26, s2, 13
    s_lshl_b32 s27, s17, 4
    s_add_u32 s26, s26, s27
    v_add_u32 v121, s26, v121
    global_load_dwordx2 v[112:113], v121, s[10:11]
    global_load_dwordx2 v[114:115], v121, s[10:11] offset:32
    global_load_dwordx2 v[116:117], v121, s[10:11] offset:64
    global_load_dwordx2 v[118:119], v121, s[10:11] offset:96
    s_lshl_b32 s26, s19, 1
    v_mov_b32 v42, s26
    global_load_ushort v125, v42, s[6:7]
    v_lshlrev_b32 v42, 1, v42
    global_load_dword v110, v42, s[32:33]
    v_and_b32 v45, 7, v6
    v_mul_u32_u24 v45, 4160, v45
    v_lshrrev_b32 v46, 3, v6
    v_lshl_add_u32 v45, v46, 4, v45
    v_lshlrev_b32 v46, 4, v7
    v_sub_u32 v45, v45, v46
    v_add_u32 v45, 32, v45
    v_add_u32 v126, s20, v45
    v_mul_u32_u24 v46, 1536, v7
    v_lshl_add_u32 v46, v6, 4, v46
    v_add_u32 v46, 32784, v46
    v_add_u32 v127, s20, v46
    s_branch K2_copies

K2_helper:
    s_add_u32 s12, s4, 0x400000
    s_addc_u32 s13, s5, 0
    s_mov_b32 s14, 4194304
    s_mov_b32 s15, 0x00020000

    s_lshl_b32 s24, s18, 11
    s_lshl_b32 s25, s19, 12
    s_add_u32 s24, s24, s25
    s_mul_i32 s25, s18, 3072
    s_add_u32 s25, s25, s20
    s_add_u32 s25, s25, 33792
    v_lshlrev_b32 v3, 4, v2

    s_mov_b32 m0, s25
    s_nop 0
    buffer_load_dwordx4 v3, s[12:15], s24 offen lds
    s_add_u32 s24, s24, 1024
    s_add_u32 s25, s25, 1536
    s_mov_b32 m0, s25
    s_nop 0
    buffer_load_dwordx4 v3, s[12:15], s24 offen lds
    v_mov_b32 v48, 0
    v_mov_b32 v49, 0
    v_mov_b32 v50, 0
    v_mov_b32 v51, 0
    v_bfe_u32 v45, v0, 5, 3
    v_mul_u32_u24 v45, 1536, v45
    v_and_b32 v46, 31, v0
    v_lshl_add_u32 v45, v46, 4, v45
    ds_write_b128 v45, v[48:51] offset:33280
    v_add_u32 v45, 45568, v45
    ds_write_b128 v45, v[48:51] offset:33280
    v_bfe_u32 v45, v0, 2, 3
    v_mul_u32_u24 v45, 4160, v45
    v_and_b32 v46, 3, v0
    v_lshl_add_u32 v45, v46, 4, v45
    ds_write_b128 v45, v[48:51]
    ds_write_b128 v45, v[48:51] offset:45568

K2_copies:
    s_waitcnt vmcnt(2)
    v_cndmask_b32 v8, v8, 0, s[58:59]
    v_cndmask_b32 v9, v9, 0, s[58:59]
    v_cndmask_b32 v10, v10, 0, s[58:59]
    v_cndmask_b32 v11, v11, 0, s[58:59]
    v_alignbit_b32 v52, v9, v8, 16
    v_alignbit_b32 v53, v10, v9, 16
    v_alignbit_b32 v54, v11, v10, 16
    v_alignbit_b32 v55, v12, v11, 16
    v_alignbit_b32 v56, v13, v12, 16
    v_alignbit_b32 v57, v14, v13, 16
    v_alignbit_b32 v58, v15, v14, 16
    v_alignbit_b32 v60, v10, v9, 16
    v_alignbit_b32 v61, v11, v10, 16
    v_alignbit_b32 v62, v12, v11, 16
    v_alignbit_b32 v63, v13, v12, 16
    v_alignbit_b32 v64, v14, v13, 16
    v_alignbit_b32 v65, v15, v14, 16
    v_mov_b32 v66, v9
    v_mov_b32 v67, v10
    v_mov_b32 v68, v11
    v_mov_b32 v69, v12
    v_mov_b32 v70, v13
    v_mov_b32 v71, v14
    ds_write_b128 v120, v[52:55] offset:0
    ds_write_b128 v120, v[66:69] offset:4160
    ds_write_b128 v120, v[60:63] offset:8320
    ds_write_b128 v120, v[10:13] offset:12480
    ds_write_b128 v120, v[54:57] offset:16640
    ds_write_b128 v120, v[68:71] offset:20800
    ds_write_b128 v120, v[62:65] offset:24960
    ds_write_b128 v120, v[12:15] offset:29120
    v_mov_b32 v72, 0
    v_mov_b32 v73, 0
    v_mov_b32 v74, 0
    v_mov_b32 v75, 0
    v_mov_b32 v76, 0
    v_mov_b32 v77, 0
    v_mov_b32 v78, 0
    v_mov_b32 v79, 0
    v_mov_b32 v80, 0
    v_mov_b32 v81, 0
    v_mov_b32 v82, 0
    v_mov_b32 v83, 0
    v_mov_b32 v84, 0
    v_mov_b32 v85, 0
    v_mov_b32 v86, 0
    v_mov_b32 v87, 0
    v_mov_b32 v88, 0
    v_mov_b32 v89, 0
    v_mov_b32 v90, 0
    v_mov_b32 v91, 0
    v_mov_b32 v92, 0
    v_mov_b32 v93, 0
    v_mov_b32 v94, 0
    v_mov_b32 v95, 0
    v_mov_b32 v96, 0
    v_mov_b32 v97, 0
    v_mov_b32 v98, 0
    v_mov_b32 v99, 0
    v_mov_b32 v100, 0
    v_mov_b32 v101, 0
    v_mov_b32 v102, 0
    v_mov_b32 v103, 0
    s_waitcnt vmcnt(0) lgkmcnt(0)
    s_barrier
    s_cmp_lt_u32 s30, 4
    s_cbranch_scc1 K2_main
    s_getpc_b64 s[28:29]
CPF_2:
    s_add_u32 s28, s28, k4_kernel-CPF_2
    s_addc_u32 s29, s29, 0
    s_bfe_u32 s30, s2, 0x50003
    s_lshl_b32 s30, s30, 10
    v_and_b32 v60, 63, v0
    v_lshl_add_u32 v60, v60, 4, s30
    v_min_u32 v60, K_code_end-k4_kernel-16, v60
    global_load_dwordx4 v[64:67], v60, s[28:29]
    v_and_b32 v0, 255, v0
    s_add_u32 s46, s4, 0x1c00000
    s_addc_u32 s47, s5, 0
    v_min_u32 v60, 223, v0
    v_mul_u32_u24 v61, 4682, v60
    v_lshrrev_b32 v61, 16, v61
    v_mul_u32_u24 v62, 14, v61
    v_sub_u32 v62, v60, v62
    s_mul_i32 s28, s2, 7168
    v_lshl_add_u32 v60, v60, 4, s28
    global_load_dwordx4 v[64:67], v60, s[44:45]
    global_load_dwordx4 v[68:71], v60, s[44:45] offset:3584
    s_lshl_b32 s28, s2, 1
    s_and_b32 s29, s28, 0x1f3
    s_bfe_u32 s31, s28, 0x10002
    s_lshl_b32 s31, s31, 3
    s_or_b32 s29, s29, s31
    s_bfe_u32 s31, s28, 0x10003
    s_lshl_b32 s31, s31, 2
    s_or_b32 s29, s29, s31
    s_mul_i32 s29, s29, 224
    v_mul_u32_u24 v61, 114688, v61
    v_lshl_add_u32 v61, v62, 4, v61
    v_add_u32 v61, s29, v61

    s_lshr_b32 s28, s2, 3
    s_mul_i32 s28, s28, 16384
    v_lshl_add_u32 v63, v0, 4, s28
    global_load_dwordx4 v[72:75], v63, s[40:41]
    s_add_u32 s40, s40, 4096
    s_addc_u32 s41, s41, 0
    global_load_dwordx4 v[72:75], v63, s[40:41]
    s_add_u32 s40, s40, 4096
    s_addc_u32 s41, s41, 0
    global_load_dwordx4 v[72:75], v63, s[40:41]
    s_add_u32 s40, s40, 4096
    s_addc_u32 s41, s41, 0
    global_load_dwordx4 v[72:75], v63, s[40:41]
    s_lshr_b32 s28, s2, 3
    s_mul_i32 s28, s28, 16384
    v_lshl_add_u32 v63, v0, 4, s28
    global_load_dwordx4 v[72:75], v63, s[42:43]
    s_add_u32 s42, s42, 4096
    s_addc_u32 s43, s43, 0
    global_load_dwordx4 v[72:75], v63, s[42:43]
    s_add_u32 s42, s42, 4096
    s_addc_u32 s43, s43, 0
    global_load_dwordx4 v[72:75], v63, s[42:43]
    s_add_u32 s42, s42, 4096
    s_addc_u32 s43, s43, 0
    global_load_dwordx4 v[72:75], v63, s[42:43]
    s_waitcnt vmcnt(8)
    global_store_dwordx4 v61, v[64:67], s[46:47]
    global_store_dwordx4 v61, v[68:71], s[46:47] offset:224
    s_endpgm
K2_main:
    s_cmp_eq_u32 s18, 1
    s_cbranch_scc1 K2_roleB
    ds_read_b128 v[8:11], v126 offset:32
    ds_read_b128 v[12:15], v127 offset:1008
    ds_read_b128 v[16:19], v127 offset:1520
    ds_read_b128 v[20:23], v126 offset:0
    ds_read_b128 v[24:27], v127 offset:4080
    ds_read_b128 v[28:31], v127 offset:4592
    ds_read_b128 v[32:35], v126 offset:96
    ds_read_b128 v[36:39], v127 offset:992
    ds_read_b128 v[40:43], v127 offset:1504
    ds_read_b128 v[44:47], v126 offset:64
    ds_read_b128 v[48:51], v127 offset:4064
    ds_read_b128 v[52:55], v127 offset:4576
    s_waitcnt lgkmcnt(6)
    v_mfma_f32_32x32x16_f16 v[72:87], v[8:11], v[12:15], v[72:87]
    v_mfma_f32_32x32x16_f16 v[88:103], v[8:11], v[16:19], v[88:103]
    v_mfma_f32_32x32x16_f16 v[72:87], v[20:23], v[24:27], v[72:87]
    v_mfma_f32_32x32x16_f16 v[88:103], v[20:23], v[28:31], v[88:103]
    ds_read_b128 v[8:11], v126 offset:160
    ds_read_b128 v[12:15], v127 offset:976
    ds_read_b128 v[16:19], v127 offset:1488
    ds_read_b128 v[20:23], v126 offset:128
    ds_read_b128 v[24:27], v127 offset:4048
    ds_read_b128 v[28:31], v127 offset:4560
    s_waitcnt lgkmcnt(6)
    v_mfma_f32_32x32x16_f16 v[72:87], v[32:35], v[36:39], v[72:87]
    v_mfma_f32_32x32x16_f16 v[88:103], v[32:35], v[40:43], v[88:103]
    v_mfma_f32_32x32x16_f16 v[72:87], v[44:47], v[48:51], v[72:87]
    v_mfma_f32_32x32x16_f16 v[88:103], v[44:47], v[52:55], v[88:103]
    ds_read_b128 v[32:35], v126 offset:224
    ds_read_b128 v[36:39], v127 offset:960
    ds_read_b128 v[40:43], v127 offset:1472
    ds_read_b128 v[44:47], v126 offset:192
    ds_read_b128 v[48:51], v127 offset:4032
    ds_read_b128 v[52:55], v127 offset:4544
    s_waitcnt lgkmcnt(6)
    v_mfma_f32_32x32x16_f16 v[72:87], v[8:11], v[12:15], v[72:87]
    v_mfma_f32_32x32x16_f16 v[88:103], v[8:11], v[16:19], v[88:103]
    v_mfma_f32_32x32x16_f16 v[72:87], v[20:23], v[24:27], v[72:87]
    v_mfma_f32_32x32x16_f16 v[88:103], v[20:23], v[28:31], v[88:103]
    ds_read_b128 v[8:11], v126 offset:288
    ds_read_b128 v[12:15], v127 offset:944
    ds_read_b128 v[16:19], v127 offset:1456
    ds_read_b128 v[20:23], v126 offset:256
    ds_read_b128 v[24:27], v127 offset:4016
    ds_read_b128 v[28:31], v127 offset:4528
    s_waitcnt lgkmcnt(6)
    v_mfma_f32_32x32x16_f16 v[72:87], v[32:35], v[36:39], v[72:87]
    v_mfma_f32_32x32x16_f16 v[88:103], v[32:35], v[40:43], v[88:103]
    v_mfma_f32_32x32x16_f16 v[72:87], v[44:47], v[48:51], v[72:87]
    v_mfma_f32_32x32x16_f16 v[88:103], v[44:47], v[52:55], v[88:103]
    ds_read_b128 v[32:35], v126 offset:352
    ds_read_b128 v[36:39], v127 offset:928
    ds_read_b128 v[40:43], v127 offset:1440
    ds_read_b128 v[44:47], v126 offset:320
    ds_read_b128 v[48:51], v127 offset:4000
    ds_read_b128 v[52:55], v127 offset:4512
    s_waitcnt lgkmcnt(6)
    v_mfma_f32_32x32x16_f16 v[72:87], v[8:11], v[12:15], v[72:87]
    v_mfma_f32_32x32x16_f16 v[88:103], v[8:11], v[16:19], v[88:103]
    v_mfma_f32_32x32x16_f16 v[72:87], v[20:23], v[24:27], v[72:87]
    v_mfma_f32_32x32x16_f16 v[88:103], v[20:23], v[28:31], v[88:103]
    ds_read_b128 v[8:11], v126 offset:416
    ds_read_b128 v[12:15], v127 offset:912
    ds_read_b128 v[16:19], v127 offset:1424
    ds_read_b128 v[20:23], v126 offset:384
    ds_read_b128 v[24:27], v127 offset:3984
    ds_read_b128 v[28:31], v127 offset:4496
    s_waitcnt lgkmcnt(6)
    v_mfma_f32_32x32x16_f16 v[72:87], v[32:35], v[36:39], v[72:87]
    v_mfma_f32_32x32x16_f16 v[88:103], v[32:35], v[40:43], v[88:103]
    v_mfma_f32_32x32x16_f16 v[72:87], v[44:47], v[48:51], v[72:87]
    v_mfma_f32_32x32x16_f16 v[88:103], v[44:47], v[52:55], v[88:103]
    ds_read_b128 v[32:35], v126 offset:480
    ds_read_b128 v[36:39], v127 offset:896
    ds_read_b128 v[40:43], v127 offset:1408
    ds_read_b128 v[44:47], v126 offset:448
    ds_read_b128 v[48:51], v127 offset:3968
    ds_read_b128 v[52:55], v127 offset:4480
    s_waitcnt lgkmcnt(6)
    v_mfma_f32_32x32x16_f16 v[72:87], v[8:11], v[12:15], v[72:87]
    v_mfma_f32_32x32x16_f16 v[88:103], v[8:11], v[16:19], v[88:103]
    v_mfma_f32_32x32x16_f16 v[72:87], v[20:23], v[24:27], v[72:87]
    v_mfma_f32_32x32x16_f16 v[88:103], v[20:23], v[28:31], v[88:103]
    ds_read_b128 v[8:11], v126 offset:544
    ds_read_b128 v[12:15], v127 offset:880
    ds_read_b128 v[16:19], v127 offset:1392
    ds_read_b128 v[20:23], v126 offset:512
    ds_read_b128 v[24:27], v127 offset:3952
    ds_read_b128 v[28:31], v127 offset:4464
    s_waitcnt lgkmcnt(6)
    v_mfma_f32_32x32x16_f16 v[72:87], v[32:35], v[36:39], v[72:87]
    v_mfma_f32_32x32x16_f16 v[88:103], v[32:35], v[40:43], v[88:103]
    v_mfma_f32_32x32x16_f16 v[72:87], v[44:47], v[48:51], v[72:87]
    v_mfma_f32_32x32x16_f16 v[88:103], v[44:47], v[52:55], v[88:103]
    ds_read_b128 v[32:35], v126 offset:608
    ds_read_b128 v[36:39], v127 offset:864
    ds_read_b128 v[40:43], v127 offset:1376
    ds_read_b128 v[44:47], v126 offset:576
    ds_read_b128 v[48:51], v127 offset:3936
    ds_read_b128 v[52:55], v127 offset:4448
    s_waitcnt lgkmcnt(6)
    v_mfma_f32_32x32x16_f16 v[72:87], v[8:11], v[12:15], v[72:87]
    v_mfma_f32_32x32x16_f16 v[88:103], v[8:11], v[16:19], v[88:103]
    v_mfma_f32_32x32x16_f16 v[72:87], v[20:23], v[24:27], v[72:87]
    v_mfma_f32_32x32x16_f16 v[88:103], v[20:23], v[28:31], v[88:103]
    ds_read_b128 v[8:11], v126 offset:672
    ds_read_b128 v[12:15], v127 offset:848
    ds_read_b128 v[16:19], v127 offset:1360
    ds_read_b128 v[20:23], v126 offset:640
    ds_read_b128 v[24:27], v127 offset:3920
    ds_read_b128 v[28:31], v127 offset:4432
    s_waitcnt lgkmcnt(6)
    v_mfma_f32_32x32x16_f16 v[72:87], v[32:35], v[36:39], v[72:87]
    v_mfma_f32_32x32x16_f16 v[88:103], v[32:35], v[40:43], v[88:103]
    v_mfma_f32_32x32x16_f16 v[72:87], v[44:47], v[48:51], v[72:87]
    v_mfma_f32_32x32x16_f16 v[88:103], v[44:47], v[52:55], v[88:103]
    ds_read_b128 v[32:35], v126 offset:736
    ds_read_b128 v[36:39], v127 offset:832
    ds_read_b128 v[40:43], v127 offset:1344
    ds_read_b128 v[44:47], v126 offset:704
    ds_read_b128 v[48:51], v127 offset:3904
    ds_read_b128 v[52:55], v127 offset:4416
    s_waitcnt lgkmcnt(6)
    v_mfma_f32_32x32x16_f16 v[72:87], v[8:11], v[12:15], v[72:87]
    v_mfma_f32_32x32x16_f16 v[88:103], v[8:11], v[16:19], v[88:103]
    v_mfma_f32_32x32x16_f16 v[72:87], v[20:23], v[24:27], v[72:87]
    v_mfma_f32_32x32x16_f16 v[88:103], v[20:23], v[28:31], v[88:103]
    ds_read_b128 v[8:11], v126 offset:800
    ds_read_b128 v[12:15], v127 offset:816
    ds_read_b128 v[16:19], v127 offset:1328
    ds_read_b128 v[20:23], v126 offset:768
    ds_read_b128 v[24:27], v127 offset:3888
    ds_read_b128 v[28:31], v127 offset:4400
    s_waitcnt lgkmcnt(6)
    v_mfma_f32_32x32x16_f16 v[72:87], v[32:35], v[36:39], v[72:87]
    v_mfma_f32_32x32x16_f16 v[88:103], v[32:35], v[40:43], v[88:103]
    v_mfma_f32_32x32x16_f16 v[72:87], v[44:47], v[48:51], v[72:87]
    v_mfma_f32_32x32x16_f16 v[88:103], v[44:47], v[52:55], v[88:103]
    ds_read_b128 v[32:35], v126 offset:864
    ds_read_b128 v[36:39], v127 offset:800
    ds_read_b128 v[40:43], v127 offset:1312
    ds_read_b128 v[44:47], v126 offset:832
    ds_read_b128 v[48:51], v127 offset:3872
    ds_read_b128 v[52:55], v127 offset:4384
    s_waitcnt lgkmcnt(6)
    v_mfma_f32_32x32x16_f16 v[72:87], v[8:11], v[12:15], v[72:87]
    v_mfma_f32_32x32x16_f16 v[88:103], v[8:11], v[16:19], v[88:103]
    v_mfma_f32_32x32x16_f16 v[72:87], v[20:23], v[24:27], v[72:87]
    v_mfma_f32_32x32x16_f16 v[88:103], v[20:23], v[28:31], v[88:103]
    ds_read_b128 v[8:11], v126 offset:928
    ds_read_b128 v[12:15], v127 offset:784
    ds_read_b128 v[16:19], v127 offset:1296
    ds_read_b128 v[20:23], v126 offset:896
    ds_read_b128 v[24:27], v127 offset:3856
    ds_read_b128 v[28:31], v127 offset:4368
    s_waitcnt lgkmcnt(6)
    v_mfma_f32_32x32x16_f16 v[72:87], v[32:35], v[36:39], v[72:87]
    v_mfma_f32_32x32x16_f16 v[88:103], v[32:35], v[40:43], v[88:103]
    v_mfma_f32_32x32x16_f16 v[72:87], v[44:47], v[48:51], v[72:87]
    v_mfma_f32_32x32x16_f16 v[88:103], v[44:47], v[52:55], v[88:103]
    ds_read_b128 v[32:35], v126 offset:992
    ds_read_b128 v[36:39], v127 offset:768
    ds_read_b128 v[40:43], v127 offset:1280
    ds_read_b128 v[44:47], v126 offset:960
    ds_read_b128 v[48:51], v127 offset:3840
    ds_read_b128 v[52:55], v127 offset:4352
    s_waitcnt lgkmcnt(6)
    v_mfma_f32_32x32x16_f16 v[72:87], v[8:11], v[12:15], v[72:87]
    v_mfma_f32_32x32x16_f16 v[88:103], v[8:11], v[16:19], v[88:103]
    v_mfma_f32_32x32x16_f16 v[72:87], v[20:23], v[24:27], v[72:87]
    v_mfma_f32_32x32x16_f16 v[88:103], v[20:23], v[28:31], v[88:103]
    ds_read_b128 v[8:11], v126 offset:1056
    ds_read_b128 v[12:15], v127 offset:752
    ds_read_b128 v[16:19], v127 offset:1264
    ds_read_b128 v[20:23], v126 offset:1024
    ds_read_b128 v[24:27], v127 offset:3824
    ds_read_b128 v[28:31], v127 offset:4336
    s_waitcnt lgkmcnt(6)
    v_mfma_f32_32x32x16_f16 v[72:87], v[32:35], v[36:39], v[72:87]
    v_mfma_f32_32x32x16_f16 v[88:103], v[32:35], v[40:43], v[88:103]
    v_mfma_f32_32x32x16_f16 v[72:87], v[44:47], v[48:51], v[72:87]
    v_mfma_f32_32x32x16_f16 v[88:103], v[44:47], v[52:55], v[88:103]
    ds_read_b128 v[32:35], v126 offset:1120
    ds_read_b128 v[36:39], v127 offset:736
    ds_read_b128 v[40:43], v127 offset:1248
    ds_read_b128 v[44:47], v126 offset:1088
    ds_read_b128 v[48:51], v127 offset:3808
    ds_read_b128 v[52:55], v127 offset:4320
    s_waitcnt lgkmcnt(6)
    v_mfma_f32_32x32x16_f16 v[72:87], v[8:11], v[12:15], v[72:87]
    v_mfma_f32_32x32x16_f16 v[88:103], v[8:11], v[16:19], v[88:103]
    v_mfma_f32_32x32x16_f16 v[72:87], v[20:23], v[24:27], v[72:87]
    v_mfma_f32_32x32x16_f16 v[88:103], v[20:23], v[28:31], v[88:103]
    ds_read_b128 v[8:11], v126 offset:1184
    ds_read_b128 v[12:15], v127 offset:720
    ds_read_b128 v[16:19], v127 offset:1232
    ds_read_b128 v[20:23], v126 offset:1152
    ds_read_b128 v[24:27], v127 offset:3792
    ds_read_b128 v[28:31], v127 offset:4304
    s_waitcnt lgkmcnt(6)
    v_mfma_f32_32x32x16_f16 v[72:87], v[32:35], v[36:39], v[72:87]
    v_mfma_f32_32x32x16_f16 v[88:103], v[32:35], v[40:43], v[88:103]
    v_mfma_f32_32x32x16_f16 v[72:87], v[44:47], v[48:51], v[72:87]
    v_mfma_f32_32x32x16_f16 v[88:103], v[44:47], v[52:55], v[88:103]
    ds_read_b128 v[32:35], v126 offset:1248
    ds_read_b128 v[36:39], v127 offset:704
    ds_read_b128 v[40:43], v127 offset:1216
    ds_read_b128 v[44:47], v126 offset:1216
    ds_read_b128 v[48:51], v127 offset:3776
    ds_read_b128 v[52:55], v127 offset:4288
    s_waitcnt lgkmcnt(6)
    v_mfma_f32_32x32x16_f16 v[72:87], v[8:11], v[12:15], v[72:87]
    v_mfma_f32_32x32x16_f16 v[88:103], v[8:11], v[16:19], v[88:103]
    v_mfma_f32_32x32x16_f16 v[72:87], v[20:23], v[24:27], v[72:87]
    v_mfma_f32_32x32x16_f16 v[88:103], v[20:23], v[28:31], v[88:103]
    ds_read_b128 v[8:11], v126 offset:1312
    ds_read_b128 v[12:15], v127 offset:688
    ds_read_b128 v[16:19], v127 offset:1200
    ds_read_b128 v[20:23], v126 offset:1280
    ds_read_b128 v[24:27], v127 offset:3760
    ds_read_b128 v[28:31], v127 offset:4272
    s_waitcnt lgkmcnt(6)
    v_mfma_f32_32x32x16_f16 v[72:87], v[32:35], v[36:39], v[72:87]
    v_mfma_f32_32x32x16_f16 v[88:103], v[32:35], v[40:43], v[88:103]
    v_mfma_f32_32x32x16_f16 v[72:87], v[44:47], v[48:51], v[72:87]
    v_mfma_f32_32x32x16_f16 v[88:103], v[44:47], v[52:55], v[88:103]
    ds_read_b128 v[32:35], v126 offset:1376
    ds_read_b128 v[36:39], v127 offset:672
    ds_read_b128 v[40:43], v127 offset:1184
    ds_read_b128 v[44:47], v126 offset:1344
    ds_read_b128 v[48:51], v127 offset:3744
    ds_read_b128 v[52:55], v127 offset:4256
    s_waitcnt lgkmcnt(6)
    v_mfma_f32_32x32x16_f16 v[72:87], v[8:11], v[12:15], v[72:87]
    v_mfma_f32_32x32x16_f16 v[88:103], v[8:11], v[16:19], v[88:103]
    v_mfma_f32_32x32x16_f16 v[72:87], v[20:23], v[24:27], v[72:87]
    v_mfma_f32_32x32x16_f16 v[88:103], v[20:23], v[28:31], v[88:103]
    ds_read_b128 v[8:11], v126 offset:1440
    ds_read_b128 v[12:15], v127 offset:656
    ds_read_b128 v[16:19], v127 offset:1168
    ds_read_b128 v[20:23], v126 offset:1408
    ds_read_b128 v[24:27], v127 offset:3728
    ds_read_b128 v[28:31], v127 offset:4240
    s_waitcnt lgkmcnt(6)
    v_mfma_f32_32x32x16_f16 v[72:87], v[32:35], v[36:39], v[72:87]
    v_mfma_f32_32x32x16_f16 v[88:103], v[32:35], v[40:43], v[88:103]
    v_mfma_f32_32x32x16_f16 v[72:87], v[44:47], v[48:51], v[72:87]
    v_mfma_f32_32x32x16_f16 v[88:103], v[44:47], v[52:55], v[88:103]
    ds_read_b128 v[32:35], v126 offset:1504
    ds_read_b128 v[36:39], v127 offset:640
    ds_read_b128 v[40:43], v127 offset:1152
    ds_read_b128 v[44:47], v126 offset:1472
    ds_read_b128 v[48:51], v127 offset:3712
    ds_read_b128 v[52:55], v127 offset:4224
    s_waitcnt lgkmcnt(6)
    v_mfma_f32_32x32x16_f16 v[72:87], v[8:11], v[12:15], v[72:87]
    v_mfma_f32_32x32x16_f16 v[88:103], v[8:11], v[16:19], v[88:103]
    v_mfma_f32_32x32x16_f16 v[72:87], v[20:23], v[24:27], v[72:87]
    v_mfma_f32_32x32x16_f16 v[88:103], v[20:23], v[28:31], v[88:103]
    s_waitcnt lgkmcnt(0)
    v_mfma_f32_32x32x16_f16 v[72:87], v[32:35], v[36:39], v[72:87]
    v_mfma_f32_32x32x16_f16 v[88:103], v[32:35], v[40:43], v[88:103]
    v_mfma_f32_32x32x16_f16 v[72:87], v[44:47], v[48:51], v[72:87]
    v_mfma_f32_32x32x16_f16 v[88:103], v[44:47], v[52:55], v[88:103]
    s_nop 15
    s_nop 3
    v_lshlrev_b32 v123, 4, v0
    v_add_u32 v123, 91136, v123
    ds_write_b128 v123, v[88:91] offset:0
    ds_write_b128 v123, v[92:95] offset:4096
    ds_write_b128 v123, v[96:99] offset:8192
    ds_write_b128 v123, v[100:103] offset:12288
    s_waitcnt lgkmcnt(0)
    s_barrier
    ds_read_b128 v[8:11], v123 offset:1024
    ds_read_b128 v[12:15], v123 offset:5120
    ds_read_b128 v[16:19], v123 offset:9216
    ds_read_b128 v[20:23], v123 offset:13312
    s_branch K2_fin
K2_roleB:
    ds_read_b128 v[8:11], v126 offset:1568
    ds_read_b128 v[12:15], v127 offset:624
    ds_read_b128 v[16:19], v127 offset:1136
    ds_read_b128 v[20:23], v126 offset:1536
    ds_read_b128 v[24:27], v127 offset:3696
    ds_read_b128 v[28:31], v127 offset:4208
    ds_read_b128 v[32:35], v126 offset:1632
    ds_read_b128 v[36:39], v127 offset:608
    ds_read_b128 v[40:43], v127 offset:1120
    ds_read_b128 v[44:47], v126 offset:1600
    ds_read_b128 v[48:51], v127 offset:3680
    ds_read_b128 v[52:55], v127 offset:4192
    s_waitcnt lgkmcnt(6)
    v_mfma_f32_32x32x16_f16 v[72:87], v[8:11], v[12:15], v[72:87]
    v_mfma_f32_32x32x16_f16 v[88:103], v[8:11], v[16:19], v[88:103]
    v_mfma_f32_32x32x16_f16 v[72:87], v[20:23], v[24:27], v[72:87]
    v_mfma_f32_32x32x16_f16 v[88:103], v[20:23], v[28:31], v[88:103]
    ds_read_b128 v[8:11], v126 offset:1696
    ds_read_b128 v[12:15], v127 offset:592
    ds_read_b128 v[16:19], v127 offset:1104
    ds_read_b128 v[20:23], v126 offset:1664
    ds_read_b128 v[24:27], v127 offset:3664
    ds_read_b128 v[28:31], v127 offset:4176
    s_waitcnt lgkmcnt(6)
    v_mfma_f32_32x32x16_f16 v[72:87], v[32:35], v[36:39], v[72:87]
    v_mfma_f32_32x32x16_f16 v[88:103], v[32:35], v[40:43], v[88:103]
    v_mfma_f32_32x32x16_f16 v[72:87], v[44:47], v[48:51], v[72:87]
    v_mfma_f32_32x32x16_f16 v[88:103], v[44:47], v[52:55], v[88:103]
    ds_read_b128 v[32:35], v126 offset:1760
    ds_read_b128 v[36:39], v127 offset:576
    ds_read_b128 v[40:43], v127 offset:1088
    ds_read_b128 v[44:47], v126 offset:1728
    ds_read_b128 v[48:51], v127 offset:3648
    ds_read_b128 v[52:55], v127 offset:4160
    s_waitcnt lgkmcnt(6)
    v_mfma_f32_32x32x16_f16 v[72:87], v[8:11], v[12:15], v[72:87]
    v_mfma_f32_32x32x16_f16 v[88:103], v[8:11], v[16:19], v[88:103]
    v_mfma_f32_32x32x16_f16 v[72:87], v[20:23], v[24:27], v[72:87]
    v_mfma_f32_32x32x16_f16 v[88:103], v[20:23], v[28:31], v[88:103]
    ds_read_b128 v[8:11], v126 offset:1824
    ds_read_b128 v[12:15], v127 offset:560
    ds_read_b128 v[16:19], v127 offset:1072
    ds_read_b128 v[20:23], v126 offset:1792
    ds_read_b128 v[24:27], v127 offset:3632
    ds_read_b128 v[28:31], v127 offset:4144
    s_waitcnt lgkmcnt(6)
    v_mfma_f32_32x32x16_f16 v[72:87], v[32:35], v[36:39], v[72:87]
    v_mfma_f32_32x32x16_f16 v[88:103], v[32:35], v[40:43], v[88:103]
    v_mfma_f32_32x32x16_f16 v[72:87], v[44:47], v[48:51], v[72:87]
    v_mfma_f32_32x32x16_f16 v[88:103], v[44:47], v[52:55], v[88:103]
    ds_read_b128 v[32:35], v126 offset:1888
    ds_read_b128 v[36:39], v127 offset:544
    ds_read_b128 v[40:43], v127 offset:1056
    ds_read_b128 v[44:47], v126 offset:1856
    ds_read_b128 v[48:51], v127 offset:3616
    ds_read_b128 v[52:55], v127 offset:4128
    s_waitcnt lgkmcnt(6)
    v_mfma_f32_32x32x16_f16 v[72:87], v[8:11], v[12:15], v[72:87]
    v_mfma_f32_32x32x16_f16 v[88:103], v[8:11], v[16:19], v[88:103]
    v_mfma_f32_32x32x16_f16 v[72:87], v[20:23], v[24:27], v[72:87]
    v_mfma_f32_32x32x16_f16 v[88:103], v[20:23], v[28:31], v[88:103]
    ds_read_b128 v[8:11], v126 offset:1952
    ds_read_b128 v[12:15], v127 offset:528
    ds_read_b128 v[16:19], v127 offset:1040
    ds_read_b128 v[20:23], v126 offset:1920
    ds_read_b128 v[24:27], v127 offset:3600
    ds_read_b128 v[28:31], v127 offset:4112
    s_waitcnt lgkmcnt(6)
    v_mfma_f32_32x32x16_f16 v[72:87], v[32:35], v[36:39], v[72:87]
    v_mfma_f32_32x32x16_f16 v[88:103], v[32:35], v[40:43], v[88:103]
    v_mfma_f32_32x32x16_f16 v[72:87], v[44:47], v[48:51], v[72:87]
    v_mfma_f32_32x32x16_f16 v[88:103], v[44:47], v[52:55], v[88:103]
    ds_read_b128 v[32:35], v126 offset:2016
    ds_read_b128 v[36:39], v127 offset:512
    ds_read_b128 v[40:43], v127 offset:1024
    ds_read_b128 v[44:47], v126 offset:1984
    ds_read_b128 v[48:51], v127 offset:3584
    ds_read_b128 v[52:55], v127 offset:4096
    s_waitcnt lgkmcnt(6)
    v_mfma_f32_32x32x16_f16 v[72:87], v[8:11], v[12:15], v[72:87]
    v_mfma_f32_32x32x16_f16 v[88:103], v[8:11], v[16:19], v[88:103]
    v_mfma_f32_32x32x16_f16 v[72:87], v[20:23], v[24:27], v[72:87]
    v_mfma_f32_32x32x16_f16 v[88:103], v[20:23], v[28:31], v[88:103]
    ds_read_b128 v[8:11], v126 offset:2080
    ds_read_b128 v[12:15], v127 offset:1008
    ds_read_b128 v[16:19], v126 offset:2048
    ds_read_b128 v[20:23], v127 offset:4080
    s_waitcnt lgkmcnt(4)
    v_mfma_f32_32x32x16_f16 v[72:87], v[32:35], v[36:39], v[72:87]
    v_mfma_f32_32x32x16_f16 v[88:103], v[32:35], v[40:43], v[88:103]
    v_mfma_f32_32x32x16_f16 v[72:87], v[44:47], v[48:51], v[72:87]
    v_mfma_f32_32x32x16_f16 v[88:103], v[44:47], v[52:55], v[88:103]
    ds_read_b128 v[32:35], v126 offset:2144
    ds_read_b128 v[36:39], v127 offset:992
    ds_read_b128 v[40:43], v126 offset:2112
    ds_read_b128 v[44:47], v127 offset:4064
    s_waitcnt lgkmcnt(4)
    v_mfma_f32_32x32x16_f16 v[88:103], v[8:11], v[12:15], v[88:103]
    v_mfma_f32_32x32x16_f16 v[88:103], v[16:19], v[20:23], v[88:103]
    ds_read_b128 v[8:11], v126 offset:2208
    ds_read_b128 v[12:15], v127 offset:976
    ds_read_b128 v[16:19], v126 offset:2176
    ds_read_b128 v[20:23], v127 offset:4048
    s_waitcnt lgkmcnt(4)
    v_mfma_f32_32x32x16_f16 v[88:103], v[32:35], v[36:39], v[88:103]
    v_mfma_f32_32x32x16_f16 v[88:103], v[40:43], v[44:47], v[88:103]
    ds_read_b128 v[32:35], v126 offset:2272
    ds_read_b128 v[36:39], v127 offset:960
    ds_read_b128 v[40:43], v126 offset:2240
    ds_read_b128 v[44:47], v127 offset:4032
    s_waitcnt lgkmcnt(4)
    v_mfma_f32_32x32x16_f16 v[88:103], v[8:11], v[12:15], v[88:103]
    v_mfma_f32_32x32x16_f16 v[88:103], v[16:19], v[20:23], v[88:103]
    ds_read_b128 v[8:11], v126 offset:2336
    ds_read_b128 v[12:15], v127 offset:944
    ds_read_b128 v[16:19], v126 offset:2304
    ds_read_b128 v[20:23], v127 offset:4016
    s_waitcnt lgkmcnt(4)
    v_mfma_f32_32x32x16_f16 v[88:103], v[32:35], v[36:39], v[88:103]
    v_mfma_f32_32x32x16_f16 v[88:103], v[40:43], v[44:47], v[88:103]
    ds_read_b128 v[32:35], v126 offset:2400
    ds_read_b128 v[36:39], v127 offset:928
    ds_read_b128 v[40:43], v126 offset:2368
    ds_read_b128 v[44:47], v127 offset:4000
    s_waitcnt lgkmcnt(4)
    v_mfma_f32_32x32x16_f16 v[88:103], v[8:11], v[12:15], v[88:103]
    v_mfma_f32_32x32x16_f16 v[88:103], v[16:19], v[20:23], v[88:103]
    ds_read_b128 v[8:11], v126 offset:2464
    ds_read_b128 v[12:15], v127 offset:912
    ds_read_b128 v[16:19], v126 offset:2432
    ds_read_b128 v[20:23], v127 offset:3984
    s_waitcnt lgkmcnt(4)
    v_mfma_f32_32x32x16_f16 v[88:103], v[32:35], v[36:39], v[88:103]
    v_mfma_f32_32x32x16_f16 v[88:103], v[40:43], v[44:47], v[88:103]
    ds_read_b128 v[32:35], v126 offset:2528
    ds_read_b128 v[36:39], v127 offset:896
    ds_read_b128 v[40:43], v126 offset:2496
    ds_read_b128 v[44:47], v127 offset:3968
    s_waitcnt lgkmcnt(4)
    v_mfma_f32_32x32x16_f16 v[88:103], v[8:11], v[12:15], v[88:103]
    v_mfma_f32_32x32x16_f16 v[88:103], v[16:19], v[20:23], v[88:103]
    ds_read_b128 v[8:11], v126 offset:2592
    ds_read_b128 v[12:15], v127 offset:880
    ds_read_b128 v[16:19], v126 offset:2560
    ds_read_b128 v[20:23], v127 offset:3952
    s_waitcnt lgkmcnt(4)
    v_mfma_f32_32x32x16_f16 v[88:103], v[32:35], v[36:39], v[88:103]
    v_mfma_f32_32x32x16_f16 v[88:103], v[40:43], v[44:47], v[88:103]
    ds_read_b128 v[32:35], v126 offset:2656
    ds_read_b128 v[36:39], v127 offset:864
    ds_read_b128 v[40:43], v126 offset:2624
    ds_read_b128 v[44:47], v127 offset:3936
    s_waitcnt lgkmcnt(4)
    v_mfma_f32_32x32x16_f16 v[88:103], v[8:11], v[12:15], v[88:103]
    v_mfma_f32_32x32x16_f16 v[88:103], v[16:19], v[20:23], v[88:103]
    ds_read_b128 v[8:11], v126 offset:2720
    ds_read_b128 v[12:15], v127 offset:848
    ds_read_b128 v[16:19], v126 offset:2688
    ds_read_b128 v[20:23], v127 offset:3920
    s_waitcnt lgkmcnt(4)
    v_mfma_f32_32x32x16_f16 v[88:103], v[32:35], v[36:39], v[88:103]
    v_mfma_f32_32x32x16_f16 v[88:103], v[40:43], v[44:47], v[88:103]
    ds_read_b128 v[32:35], v126 offset:2784
    ds_read_b128 v[36:39], v127 offset:832
    ds_read_b128 v[40:43], v126 offset:2752
    ds_read_b128 v[44:47], v127 offset:3904
    s_waitcnt lgkmcnt(4)
    v_mfma_f32_32x32x16_f16 v[88:103], v[8:11], v[12:15], v[88:103]
    v_mfma_f32_32x32x16_f16 v[88:103], v[16:19], v[20:23], v[88:103]
    ds_read_b128 v[8:11], v126 offset:2848
    ds_read_b128 v[12:15], v127 offset:816
    ds_read_b128 v[16:19], v126 offset:2816
    ds_read_b128 v[20:23], v127 offset:3888
    s_waitcnt lgkmcnt(4)
    v_mfma_f32_32x32x16_f16 v[88:103], v[32:35], v[36:39], v[88:103]
    v_mfma_f32_32x32x16_f16 v[88:103], v[40:43], v[44:47], v[88:103]
    ds_read_b128 v[32:35], v126 offset:2912
    ds_read_b128 v[36:39], v127 offset:800
    ds_read_b128 v[40:43], v126 offset:2880
    ds_read_b128 v[44:47], v127 offset:3872
    s_waitcnt lgkmcnt(4)
    v_mfma_f32_32x32x16_f16 v[88:103], v[8:11], v[12:15], v[88:103]
    v_mfma_f32_32x32x16_f16 v[88:103], v[16:19], v[20:23], v[88:103]
    ds_read_b128 v[8:11], v126 offset:2976
    ds_read_b128 v[12:15], v127 offset:784
    ds_read_b128 v[16:19], v126 offset:2944
    ds_read_b128 v[20:23], v127 offset:3856
    s_waitcnt lgkmcnt(4)
    v_mfma_f32_32x32x16_f16 v[88:103], v[32:35], v[36:39], v[88:103]
    v_mfma_f32_32x32x16_f16 v[88:103], v[40:43], v[44:47], v[88:103]
    ds_read_b128 v[32:35], v126 offset:3040
    ds_read_b128 v[36:39], v127 offset:768
    ds_read_b128 v[40:43], v126 offset:3008
    ds_read_b128 v[44:47], v127 offset:3840
    s_waitcnt lgkmcnt(4)
    v_mfma_f32_32x32x16_f16 v[88:103], v[8:11], v[12:15], v[88:103]
    v_mfma_f32_32x32x16_f16 v[88:103], v[16:19], v[20:23], v[88:103]
    ds_read_b128 v[8:11], v126 offset:3104
    ds_read_b128 v[12:15], v127 offset:752
    ds_read_b128 v[16:19], v126 offset:3072
    ds_read_b128 v[20:23], v127 offset:3824
    s_waitcnt lgkmcnt(4)
    v_mfma_f32_32x32x16_f16 v[88:103], v[32:35], v[36:39], v[88:103]
    v_mfma_f32_32x32x16_f16 v[88:103], v[40:43], v[44:47], v[88:103]
    ds_read_b128 v[32:35], v126 offset:3168
    ds_read_b128 v[36:39], v127 offset:736
    ds_read_b128 v[40:43], v126 offset:3136
    ds_read_b128 v[44:47], v127 offset:3808
    s_waitcnt lgkmcnt(4)
    v_mfma_f32_32x32x16_f16 v[88:103], v[8:11], v[12:15], v[88:103]
    v_mfma_f32_32x32x16_f16 v[88:103], v[16:19], v[20:23], v[88:103]
    ds_read_b128 v[8:11], v126 offset:3232
    ds_read_b128 v[12:15], v127 offset:720
    ds_read_b128 v[16:19], v126 offset:3200
    ds_read_b128 v[20:23], v127 offset:3792
    s_waitcnt lgkmcnt(4)
    v_mfma_f32_32x32x16_f16 v[88:103], v[32:35], v[36:39], v[88:103]
    v_mfma_f32_32x32x16_f16 v[88:103], v[40:43], v[44:47], v[88:103]
    ds_read_b128 v[32:35], v126 offset:3296
    ds_read_b128 v[36:39], v127 offset:704
    ds_read_b128 v[40:43], v126 offset:3264
    ds_read_b128 v[44:47], v127 offset:3776
    s_waitcnt lgkmcnt(4)
    v_mfma_f32_32x32x16_f16 v[88:103], v[8:11], v[12:15], v[88:103]
    v_mfma_f32_32x32x16_f16 v[88:103], v[16:19], v[20:23], v[88:103]
    ds_read_b128 v[8:11], v126 offset:3360
    ds_read_b128 v[12:15], v127 offset:688
    ds_read_b128 v[16:19], v126 offset:3328
    ds_read_b128 v[20:23], v127 offset:3760
    s_waitcnt lgkmcnt(4)
    v_mfma_f32_32x32x16_f16 v[88:103], v[32:35], v[36:39], v[88:103]
    v_mfma_f32_32x32x16_f16 v[88:103], v[40:43], v[44:47], v[88:103]
    ds_read_b128 v[32:35], v126 offset:3424
    ds_read_b128 v[36:39], v127 offset:672
    ds_read_b128 v[40:43], v126 offset:3392
    ds_read_b128 v[44:47], v127 offset:3744
    s_waitcnt lgkmcnt(4)
    v_mfma_f32_32x32x16_f16 v[88:103], v[8:11], v[12:15], v[88:103]
    v_mfma_f32_32x32x16_f16 v[88:103], v[16:19], v[20:23], v[88:103]
    ds_read_b128 v[8:11], v126 offset:3488
    ds_read_b128 v[12:15], v127 offset:656
    ds_read_b128 v[16:19], v126 offset:3456
    ds_read_b128 v[20:23], v127 offset:3728
    s_waitcnt lgkmcnt(4)
    v_mfma_f32_32x32x16_f16 v[88:103], v[32:35], v[36:39], v[88:103]
    v_mfma_f32_32x32x16_f16 v[88:103], v[40:43], v[44:47], v[88:103]
    ds_read_b128 v[32:35], v126 offset:3552
    ds_read_b128 v[36:39], v127 offset:640
    ds_read_b128 v[40:43], v126 offset:3520
    ds_read_b128 v[44:47], v127 offset:3712
    s_waitcnt lgkmcnt(4)
    v_mfma_f32_32x32x16_f16 v[88:103], v[8:11], v[12:15], v[88:103]
    v_mfma_f32_32x32x16_f16 v[88:103], v[16:19], v[20:23], v[88:103]
    ds_read_b128 v[8:11], v126 offset:3616
    ds_read_b128 v[12:15], v127 offset:624
    ds_read_b128 v[16:19], v126 offset:3584
    ds_read_b128 v[20:23], v127 offset:3696
    s_waitcnt lgkmcnt(4)
    v_mfma_f32_32x32x16_f16 v[88:103], v[32:35], v[36:39], v[88:103]
    v_mfma_f32_32x32x16_f16 v[88:103], v[40:43], v[44:47], v[88:103]
    ds_read_b128 v[32:35], v126 offset:3680
    ds_read_b128 v[36:39], v127 offset:608
    ds_read_b128 v[40:43], v126 offset:3648
    ds_read_b128 v[44:47], v127 offset:3680
    s_waitcnt lgkmcnt(4)
    v_mfma_f32_32x32x16_f16 v[88:103], v[8:11], v[12:15], v[88:103]
    v_mfma_f32_32x32x16_f16 v[88:103], v[16:19], v[20:23], v[88:103]
    ds_read_b128 v[8:11], v126 offset:3744
    ds_read_b128 v[12:15], v127 offset:592
    ds_read_b128 v[16:19], v126 offset:3712
    ds_read_b128 v[20:23], v127 offset:3664
    s_waitcnt lgkmcnt(4)
    v_mfma_f32_32x32x16_f16 v[88:103], v[32:35], v[36:39], v[88:103]
    v_mfma_f32_32x32x16_f16 v[88:103], v[40:43], v[44:47], v[88:103]
    ds_read_b128 v[32:35], v126 offset:3808
    ds_read_b128 v[36:39], v127 offset:576
    ds_read_b128 v[40:43], v126 offset:3776
    ds_read_b128 v[44:47], v127 offset:3648
    s_waitcnt lgkmcnt(4)
    v_mfma_f32_32x32x16_f16 v[88:103], v[8:11], v[12:15], v[88:103]
    v_mfma_f32_32x32x16_f16 v[88:103], v[16:19], v[20:23], v[88:103]
    ds_read_b128 v[8:11], v126 offset:3872
    ds_read_b128 v[12:15], v127 offset:560
    ds_read_b128 v[16:19], v126 offset:3840
    ds_read_b128 v[20:23], v127 offset:3632
    s_waitcnt lgkmcnt(4)
    v_mfma_f32_32x32x16_f16 v[88:103], v[32:35], v[36:39], v[88:103]
    v_mfma_f32_32x32x16_f16 v[88:103], v[40:43], v[44:47], v[88:103]
    ds_read_b128 v[32:35], v126 offset:3936
    ds_read_b128 v[36:39], v127 offset:544
    ds_read_b128 v[40:43], v126 offset:3904
    ds_read_b128 v[44:47], v127 offset:3616
    s_waitcnt lgkmcnt(4)
    v_mfma_f32_32x32x16_f16 v[88:103], v[8:11], v[12:15], v[88:103]
    v_mfma_f32_32x32x16_f16 v[88:103], v[16:19], v[20:23], v[88:103]
    ds_read_b128 v[8:11], v126 offset:4000
    ds_read_b128 v[12:15], v127 offset:528
    ds_read_b128 v[16:19], v126 offset:3968
    ds_read_b128 v[20:23], v127 offset:3600
    s_waitcnt lgkmcnt(4)
    v_mfma_f32_32x32x16_f16 v[88:103], v[32:35], v[36:39], v[88:103]
    v_mfma_f32_32x32x16_f16 v[88:103], v[40:43], v[44:47], v[88:103]
    ds_read_b128 v[32:35], v126 offset:4064
    ds_read_b128 v[36:39], v127 offset:512
    ds_read_b128 v[40:43], v126 offset:4032
    ds_read_b128 v[44:47], v127 offset:3584
    s_waitcnt lgkmcnt(4)
    v_mfma_f32_32x32x16_f16 v[88:103], v[8:11], v[12:15], v[88:103]
    v_mfma_f32_32x32x16_f16 v[88:103], v[16:19], v[20:23], v[88:103]
    s_waitcnt lgkmcnt(0)
    v_mfma_f32_32x32x16_f16 v[88:103], v[32:35], v[36:39], v[88:103]
    v_mfma_f32_32x32x16_f16 v[88:103], v[40:43], v[44:47], v[88:103]
    s_nop 15
    s_nop 3
    v_lshlrev_b32 v123, 4, v0
    v_add_u32 v123, 91136, v123
    ds_write_b128 v123, v[72:75] offset:0
    ds_write_b128 v123, v[76:79] offset:4096
    ds_write_b128 v123, v[80:83] offset:8192
    ds_write_b128 v123, v[84:87] offset:12288
    s_waitcnt lgkmcnt(0)
    s_barrier
    v_subrev_u32 v123, 1024, v123
    ds_read_b128 v[8:11], v123 offset:0
    ds_read_b128 v[12:15], v123 offset:4096
    ds_read_b128 v[16:19], v123 offset:8192
    ds_read_b128 v[20:23], v123 offset:12288
    v_mov_b32 v72, v88
    v_mov_b32 v73, v89
    v_mov_b32 v74, v90
    v_mov_b32 v75, v91
    v_mov_b32 v76, v92
    v_mov_b32 v77, v93
    v_mov_b32 v78, v94
    v_mov_b32 v79, v95
    v_mov_b32 v80, v96
    v_mov_b32 v81, v97
    v_mov_b32 v82, v98
    v_mov_b32 v83, v99
    v_mov_b32 v84, v100
    v_mov_b32 v85, v101
    v_mov_b32 v86, v102
    v_mov_b32 v87, v103
K2_fin:
    v_add_u32 v122, s20, v122
    ds_read_b64 v[24:25], v122 offset:29184
    ds_read_b64 v[26:27], v122 offset:29200
    ds_read_b64 v[28:29], v122 offset:29216
    ds_read_b64 v[30:31], v122 offset:29232
    v_lshlrev_b32 v124, 16, v125
    s_waitcnt lgkmcnt(0)
    v_pk_add_f32 v[72:73], v[72:73], v[8:9]
    v_pk_add_f32 v[74:75], v[74:75], v[10:11]
    v_pk_add_f32 v[76:77], v[76:77], v[12:13]
    v_pk_add_f32 v[78:79], v[78:79], v[14:15]
    v_pk_add_f32 v[80:81], v[80:81], v[16:17]
    v_pk_add_f32 v[82:83], v[82:83], v[18:19]
    v_pk_add_f32 v[84:85], v[84:85], v[20:21]
    v_pk_add_f32 v[86:87], v[86:87], v[22:23]
    v_pk_mul_f32 v[72:73], v[72:73], v[110:111] op_sel_hi:[1,0]
    v_pk_mul_f32 v[74:75], v[74:75], v[110:111] op_sel_hi:[1,0]
    v_pk_mul_f32 v[76:77], v[76:77], v[110:111] op_sel_hi:[1,0]
    v_pk_mul_f32 v[78:79], v[78:79], v[110:111] op_sel_hi:[1,0]
    v_pk_mul_f32 v[80:81], v[80:81], v[110:111] op_sel_hi:[1,0]
    v_pk_mul_f32 v[82:83], v[82:83], v[110:111] op_sel_hi:[1,0]
    v_pk_mul_f32 v[84:85], v[84:85], v[110:111] op_sel_hi:[1,0]
    v_pk_mul_f32 v[86:87], v[86:87], v[110:111] op_sel_hi:[1,0]
    v_cvt_pk_bf16_f32 v32, v72, v73
    v_cvt_pk_bf16_f32 v33, v74, v75
    v_cvt_pk_bf16_f32 v34, v76, v77
    v_cvt_pk_bf16_f32 v35, v78, v79
    v_lshlrev_b32 v72, 16, v32
    v_and_b32 v73, 0xffff0000, v32
    v_lshlrev_b32 v74, 16, v33
    v_and_b32 v75, 0xffff0000, v33
    v_lshlrev_b32 v76, 16, v34
    v_and_b32 v77, 0xffff0000, v34
    v_lshlrev_b32 v78, 16, v35
    v_and_b32 v79, 0xffff0000, v35
    v_cvt_f32_f16 v36, v24
    v_cvt_f32_f16_sdwa v37, v24 dst_sel:DWORD dst_unused:UNUSED_PAD src0_sel:WORD_1
    v_cvt_f32_f16 v38, v25
    v_cvt_f32_f16_sdwa v39, v25 dst_sel:DWORD dst_unused:UNUSED_PAD src0_sel:WORD_1
    v_cvt_f32_f16 v40, v26
    v_cvt_f32_f16_sdwa v41, v26 dst_sel:DWORD dst_unused:UNUSED_PAD src0_sel:WORD_1
    v_cvt_f32_f16 v42, v27
    v_cvt_f32_f16_sdwa v43, v27 dst_sel:DWORD dst_unused:UNUSED_PAD src0_sel:WORD_1
    v_pk_mul_f32 v[36:37], v[36:37], v[124:125] op_sel_hi:[1,0]
    v_pk_mul_f32 v[38:39], v[38:39], v[124:125] op_sel_hi:[1,0]
    v_pk_mul_f32 v[40:41], v[40:41], v[124:125] op_sel_hi:[1,0]
    v_pk_mul_f32 v[42:43], v[42:43], v[124:125] op_sel_hi:[1,0]
    v_cvt_pk_bf16_f32 v32, v36, v37
    v_cvt_pk_bf16_f32 v33, v38, v39
    v_cvt_pk_bf16_f32 v34, v40, v41
    v_cvt_pk_bf16_f32 v35, v42, v43
    v_lshlrev_b32 v36, 16, v32
    v_and_b32 v37, 0xffff0000, v32
    v_lshlrev_b32 v38, 16, v33
    v_and_b32 v39, 0xffff0000, v33
    v_lshlrev_b32 v40, 16, v34
    v_and_b32 v41, 0xffff0000, v34
    v_lshlrev_b32 v42, 16, v35
    v_and_b32 v43, 0xffff0000, v35
    v_pk_add_f32 v[72:73], v[72:73], v[36:37]
    v_pk_add_f32 v[74:75], v[74:75], v[38:39]
    v_pk_add_f32 v[76:77], v[76:77], v[40:41]
    v_pk_add_f32 v[78:79], v[78:79], v[42:43]
    v_cvt_pk_bf16_f32 v32, v72, v73
    v_cvt_pk_bf16_f32 v33, v74, v75
    v_cvt_pk_bf16_f32 v34, v76, v77
    v_cvt_pk_bf16_f32 v35, v78, v79
    v_lshlrev_b32 v72, 16, v32
    v_and_b32 v73, 0xffff0000, v32
    v_lshlrev_b32 v74, 16, v33
    v_and_b32 v75, 0xffff0000, v33
    v_lshlrev_b32 v76, 16, v34
    v_and_b32 v77, 0xffff0000, v34
    v_lshlrev_b32 v78, 16, v35
    v_and_b32 v79, 0xffff0000, v35
    v_lshlrev_b32 v36, 16, v112
    v_and_b32 v37, 0xffff0000, v112
    v_lshlrev_b32 v38, 16, v113
    v_and_b32 v39, 0xffff0000, v113
    v_lshlrev_b32 v40, 16, v114
    v_and_b32 v41, 0xffff0000, v114
    v_lshlrev_b32 v42, 16, v115
    v_and_b32 v43, 0xffff0000, v115
    v_pk_add_f32 v[72:73], v[72:73], v[36:37]
    v_pk_add_f32 v[74:75], v[74:75], v[38:39]
    v_pk_add_f32 v[76:77], v[76:77], v[40:41]
    v_pk_add_f32 v[78:79], v[78:79], v[42:43]
    v_cvt_pk_bf16_f32 v104, v72, v73
    v_cvt_pk_bf16_f32 v105, v74, v75
    v_cvt_pk_bf16_f32 v106, v76, v77
    v_cvt_pk_bf16_f32 v107, v78, v79
    v_cvt_pk_bf16_f32 v32, v80, v81
    v_cvt_pk_bf16_f32 v33, v82, v83
    v_cvt_pk_bf16_f32 v34, v84, v85
    v_cvt_pk_bf16_f32 v35, v86, v87
    v_lshlrev_b32 v80, 16, v32
    v_and_b32 v81, 0xffff0000, v32
    v_lshlrev_b32 v82, 16, v33
    v_and_b32 v83, 0xffff0000, v33
    v_lshlrev_b32 v84, 16, v34
    v_and_b32 v85, 0xffff0000, v34
    v_lshlrev_b32 v86, 16, v35
    v_and_b32 v87, 0xffff0000, v35
    v_cvt_f32_f16 v36, v28
    v_cvt_f32_f16_sdwa v37, v28 dst_sel:DWORD dst_unused:UNUSED_PAD src0_sel:WORD_1
    v_cvt_f32_f16 v38, v29
    v_cvt_f32_f16_sdwa v39, v29 dst_sel:DWORD dst_unused:UNUSED_PAD src0_sel:WORD_1
    v_cvt_f32_f16 v40, v30
    v_cvt_f32_f16_sdwa v41, v30 dst_sel:DWORD dst_unused:UNUSED_PAD src0_sel:WORD_1
    v_cvt_f32_f16 v42, v31
    v_cvt_f32_f16_sdwa v43, v31 dst_sel:DWORD dst_unused:UNUSED_PAD src0_sel:WORD_1
    v_pk_mul_f32 v[36:37], v[36:37], v[124:125] op_sel_hi:[1,0]
    v_pk_mul_f32 v[38:39], v[38:39], v[124:125] op_sel_hi:[1,0]
    v_pk_mul_f32 v[40:41], v[40:41], v[124:125] op_sel_hi:[1,0]
    v_pk_mul_f32 v[42:43], v[42:43], v[124:125] op_sel_hi:[1,0]
    v_cvt_pk_bf16_f32 v32, v36, v37
    v_cvt_pk_bf16_f32 v33, v38, v39
    v_cvt_pk_bf16_f32 v34, v40, v41
    v_cvt_pk_bf16_f32 v35, v42, v43
    v_lshlrev_b32 v36, 16, v32
    v_and_b32 v37, 0xffff0000, v32
    v_lshlrev_b32 v38, 16, v33
    v_and_b32 v39, 0xffff0000, v33
    v_lshlrev_b32 v40, 16, v34
    v_and_b32 v41, 0xffff0000, v34
    v_lshlrev_b32 v42, 16, v35
    v_and_b32 v43, 0xffff0000, v35
    v_pk_add_f32 v[80:81], v[80:81], v[36:37]
    v_pk_add_f32 v[82:83], v[82:83], v[38:39]
    v_pk_add_f32 v[84:85], v[84:85], v[40:41]
    v_pk_add_f32 v[86:87], v[86:87], v[42:43]
    v_cvt_pk_bf16_f32 v32, v80, v81
    v_cvt_pk_bf16_f32 v33, v82, v83
    v_cvt_pk_bf16_f32 v34, v84, v85
    v_cvt_pk_bf16_f32 v35, v86, v87
    v_lshlrev_b32 v80, 16, v32
    v_and_b32 v81, 0xffff0000, v32
    v_lshlrev_b32 v82, 16, v33
    v_and_b32 v83, 0xffff0000, v33
    v_lshlrev_b32 v84, 16, v34
    v_and_b32 v85, 0xffff0000, v34
    v_lshlrev_b32 v86, 16, v35
    v_and_b32 v87, 0xffff0000, v35
    v_lshlrev_b32 v36, 16, v116
    v_and_b32 v37, 0xffff0000, v116
    v_lshlrev_b32 v38, 16, v117
    v_and_b32 v39, 0xffff0000, v117
    v_lshlrev_b32 v40, 16, v118
    v_and_b32 v41, 0xffff0000, v118
    v_lshlrev_b32 v42, 16, v119
    v_and_b32 v43, 0xffff0000, v119
    v_pk_add_f32 v[80:81], v[80:81], v[36:37]
    v_pk_add_f32 v[82:83], v[82:83], v[38:39]
    v_pk_add_f32 v[84:85], v[84:85], v[40:41]
    v_pk_add_f32 v[86:87], v[86:87], v[42:43]
    v_cvt_pk_bf16_f32 v108, v80, v81
    v_cvt_pk_bf16_f32 v109, v82, v83
    v_cvt_pk_bf16_f32 v110, v84, v85
    v_cvt_pk_bf16_f32 v111, v86, v87
    s_lshl_b32 s26, s3, 11
    s_add_u32 s26, s26, 107520
    v_lshlrev_b32 v120, 6, v6
    v_lshl_add_u32 v120, v7, 3, v120
    v_add_u32 v120, s26, v120
    v_lshl_add_u32 v123, v2, 4, s26
    s_lshl_b32 s26, s19, 12
    s_lshl_b32 s27, s18, 11
    s_add_u32 s26, s26, s27
    v_lshl_add_u32 v121, v2, 4, s26

    ds_write_b64 v120, v[104:105] offset:0
    ds_write_b64 v120, v[106:107] offset:16
    ds_write_b64 v120, v[108:109] offset:32
    ds_write_b64 v120, v[110:111] offset:48
    s_waitcnt lgkmcnt(0)
    ds_read_b128 v[8:11], v123
    ds_read_b128 v[12:15], v123 offset:1024
    s_waitcnt lgkmcnt(0)
    global_store_dwordx4 v121, v[8:11], s[22:23]
    global_store_dwordx4 v121, v[12:15], s[22:23] offset:1024
K2_exit:
    s_endpgm
.text
.globl k3_kernel
.p2align 8
.type k3_kernel,@function
k3_kernel:
    s_cmp_ge_u32 s2, 256
    s_cbranch_scc1 K3_exit
    s_load_dwordx2 s[4:5], s[0:1], 128
    s_load_dwordx2 s[6:7], s[0:1], 80

    v_lshrrev_b32 v1, 6, v0
    v_and_b32 v2, 63, v0
    v_readfirstlane_b32 s36, v1
    s_and_b32 s3, s36, 3
    s_bfe_u32 s16, s2, 0x30003
    s_and_b32 s17, s2, 7
    s_lshl_b32 s17, s17, 2
    s_lshr_b32 s19, s2, 6
    s_add_u32 s17, s17, s19
    s_cmp_lt_u32 s36, 4
    s_cbranch_scc1 K3_comp
    s_lshr_b32 s18, s3, 1
    s_lshl_b32 s18, s18, 4
    s_and_b32 s19, s3, 1
    s_lshl_b32 s19, s19, 2
    s_add_u32 s18, s18, s19

    v_lshrrev_b32 v5, 5, v2
    v_lshlrev_b32 v5, 3, v5
    v_bfe_u32 v6, v2, 3, 2
    v_add_u32 v5, v5, v6
    v_mul_u32_u24 v3, 4096, v5
    v_bfe_u32 v5, v2, 1, 2
    v_bfe_u32 v6, v2, 4, 2
    v_xor_b32 v5, v5, v6
    v_lshl_add_u32 v3, v5, 5, v3
    v_and_b32 v5, 1, v2
    v_lshl_add_u32 v3, v5, 4, v3
    v_lshrrev_b32 v5, 5, v2
    v_lshlrev_b32 v5, 3, v5
    v_bfe_u32 v6, v2, 3, 2
    v_add_u32 v5, v5, v6
    v_mul_u32_u24 v4, 1024, v5
    v_bfe_u32 v5, v2, 1, 2
    v_bfe_u32 v6, v2, 4, 2
    v_xor_b32 v5, v5, v6
    v_lshl_add_u32 v4, v5, 5, v4
    v_and_b32 v5, 1, v2
    v_lshl_add_u32 v4, v5, 4, v4
    s_waitcnt lgkmcnt(0)
    s_add_u32 s8, s4, 0x800000
    s_addc_u32 s9, s5, 0
    s_mov_b32 s10, 2097152
    s_mov_b32 s11, 0x00020000

    s_mov_b32 s12, s6
    s_mov_b32 s13, s7
    s_mov_b32 s14, 524288
    s_mov_b32 s15, 0x00020000
    s_lshl_b32 s20, s18, 12
    s_lshl_b32 s21, s17, 7
    s_add_u32 s20, s20, s21
    s_lshl_b32 s22, s3, 10
    s_lshl_b32 s38, s18, 10
    s_lshl_b32 s21, s16, 7
    s_add_u32 s38, s38, s21
    s_add_u32 s39, s22, 0x10000

    s_mov_b32 m0, s22
    s_add_u32 s22, s22, 4096
    buffer_load_dwordx4 v3, s[8:11], s20 offen lds
    s_add_u32 s20, s20, 131072
    s_mov_b32 m0, s22
    s_add_u32 s22, s22, 4096
    buffer_load_dwordx4 v3, s[8:11], s20 offen lds
    s_add_u32 s20, s20, 131072
    s_mov_b32 m0, s22
    s_add_u32 s22, s22, 4096
    buffer_load_dwordx4 v3, s[8:11], s20 offen lds
    s_add_u32 s20, s20, 131072
    s_mov_b32 m0, s22
    s_add_u32 s22, s22, 4096
    buffer_load_dwordx4 v3, s[8:11], s20 offen lds
    s_add_u32 s20, s20, 131072
    s_mov_b32 m0, s39
    s_add_u32 s39, s39, 4096
    buffer_load_dwordx4 v4, s[12:15], s38 offen lds
    s_add_u32 s38, s38, 32768
    s_mov_b32 m0, s39
    s_add_u32 s39, s39, 4096
    buffer_load_dwordx4 v4, s[12:15], s38 offen lds
    s_add_u32 s38, s38, 32768
    s_mov_b32 m0, s39
    s_add_u32 s39, s39, 4096
    buffer_load_dwordx4 v4, s[12:15], s38 offen lds
    s_add_u32 s38, s38, 32768
    s_mov_b32 m0, s39
    s_add_u32 s39, s39, 4096
    buffer_load_dwordx4 v4, s[12:15], s38 offen lds
    s_add_u32 s38, s38, 32768
    s_mov_b32 m0, s22
    s_add_u32 s22, s22, 4096
    buffer_load_dwordx4 v3, s[8:11], s20 offen lds
    s_add_u32 s20, s20, 131072
    s_mov_b32 m0, s22
    s_add_u32 s22, s22, 4096
    buffer_load_dwordx4 v3, s[8:11], s20 offen lds
    s_add_u32 s20, s20, 131072
    s_mov_b32 m0, s22
    s_add_u32 s22, s22, 4096
    buffer_load_dwordx4 v3, s[8:11], s20 offen lds
    s_add_u32 s20, s20, 131072
    s_mov_b32 m0, s22
    s_add_u32 s22, s22, 4096
    buffer_load_dwordx4 v3, s[8:11], s20 offen lds
    s_add_u32 s20, s20, 131072
    s_mov_b32 m0, s39
    s_add_u32 s39, s39, 4096
    buffer_load_dwordx4 v4, s[12:15], s38 offen lds
    s_add_u32 s38, s38, 32768
    s_mov_b32 m0, s39
    s_add_u32 s39, s39, 4096
    buffer_load_dwordx4 v4, s[12:15], s38 offen lds
    s_add_u32 s38, s38, 32768
    s_mov_b32 m0, s39
    s_add_u32 s39, s39, 4096
    buffer_load_dwordx4 v4, s[12:15], s38 offen lds
    s_add_u32 s38, s38, 32768
    s_mov_b32 m0, s39
    s_add_u32 s39, s39, 4096
    buffer_load_dwordx4 v4, s[12:15], s38 offen lds
    s_add_u32 s38, s38, 32768
    s_waitcnt vmcnt(8)
    s_barrier
    s_mov_b32 m0, s22
    s_add_u32 s22, s22, 4096
    buffer_load_dwordx4 v3, s[8:11], s20 offen lds
    s_add_u32 s20, s20, 131072
    s_mov_b32 m0, s22
    s_add_u32 s22, s22, 4096
    buffer_load_dwordx4 v3, s[8:11], s20 offen lds
    s_add_u32 s20, s20, 131072
    s_mov_b32 m0, s22
    s_add_u32 s22, s22, 4096
    buffer_load_dwordx4 v3, s[8:11], s20 offen lds
    s_add_u32 s20, s20, 131072
    s_mov_b32 m0, s22
    s_add_u32 s22, s22, 4096
    buffer_load_dwordx4 v3, s[8:11], s20 offen lds
    s_add_u32 s20, s20, 131072
    s_mov_b32 m0, s39
    s_add_u32 s39, s39, 4096
    buffer_load_dwordx4 v4, s[12:15], s38 offen lds
    s_add_u32 s38, s38, 32768
    s_mov_b32 m0, s39
    s_add_u32 s39, s39, 4096
    buffer_load_dwordx4 v4, s[12:15], s38 offen lds
    s_add_u32 s38, s38, 32768
    s_mov_b32 m0, s39
    s_add_u32 s39, s39, 4096
    buffer_load_dwordx4 v4, s[12:15], s38 offen lds
    s_add_u32 s38, s38, 32768
    s_mov_b32 m0, s39
    s_add_u32 s39, s39, 4096
    buffer_load_dwordx4 v4, s[12:15], s38 offen lds
    s_add_u32 s38, s38, 32768
    s_waitcnt vmcnt(8)
    s_barrier
    s_mov_b32 m0, s22
    s_add_u32 s22, s22, 4096
    buffer_load_dwordx4 v3, s[8:11], s20 offen lds
    s_add_u32 s20, s20, 131072
    s_mov_b32 m0, s22
    s_add_u32 s22, s22, 4096
    buffer_load_dwordx4 v3, s[8:11], s20 offen lds
    s_add_u32 s20, s20, 131072
    s_mov_b32 m0, s22
    s_add_u32 s22, s22, 4096
    buffer_load_dwordx4 v3, s[8:11], s20 offen lds
    s_add_u32 s20, s20, 131072
    s_mov_b32 m0, s22
    s_add_u32 s22, s22, 4096
    buffer_load_dwordx4 v3, s[8:11], s20 offen lds
    s_add_u32 s20, s20, 131072
    s_mov_b32 m0, s39
    s_add_u32 s39, s39, 4096
    buffer_load_dwordx4 v4, s[12:15], s38 offen lds
    s_add_u32 s38, s38, 32768
    s_mov_b32 m0, s39
    s_add_u32 s39, s39, 4096
    buffer_load_dwordx4 v4, s[12:15], s38 offen lds
    s_add_u32 s38, s38, 32768
    s_mov_b32 m0, s39
    s_add_u32 s39, s39, 4096
    buffer_load_dwordx4 v4, s[12:15], s38 offen lds
    s_add_u32 s38, s38, 32768
    s_mov_b32 m0, s39
    s_add_u32 s39, s39, 4096
    buffer_load_dwordx4 v4, s[12:15], s38 offen lds
    s_add_u32 s38, s38, 32768
    s_waitcnt vmcnt(8)
    s_barrier
    s_waitcnt vmcnt(0)
    s_barrier
    s_endpgm
K3_comp:
    v_lshrrev_b32 v7, 5, v2
    v_lshlrev_b32 v7, 4, v7
    v_bfe_u32 v8, v2, 2, 3
    v_add_u32 v7, v7, v8
    v_lshlrev_b32 v5, 7, v7
    v_and_b32 v7, 3, v2
    v_lshl_add_u32 v5, v7, 3, v5
    v_lshrrev_b32 v6, 1, v8
    v_xor_b32 v7, s3, v6
    v_lshl_add_u32 v9, v7, 5, v5
    v_xor_b32 v7, 0, v6
    v_lshl_add_u32 v10, v7, 5, v5
    v_add_u32 v10, 0x10000, v10
    v_xor_b32 v7, 1, v6
    v_lshl_add_u32 v11, v7, 5, v5
    v_add_u32 v11, 0x10000, v11
    v_xor_b32 v7, 2, v6
    v_lshl_add_u32 v12, v7, 5, v5
    v_add_u32 v12, 0x10000, v12
    v_xor_b32 v7, 3, v6
    v_lshl_add_u32 v13, v7, 5, v5
    v_add_u32 v13, 0x10000, v13
    v_and_b32 v14, 15, v2
    v_lshrrev_b32 v15, 4, v2
    s_lshl_b32 s21, s17, 6
    s_lshl_b32 s23, s3, 4
    s_add_u32 s21, s21, s23
    v_add_u32 v14, s21, v14
    v_lshlrev_b32 v16, 3, v14
    v_lshlrev_b32 v14, 10, v14
    s_lshl_b32 s23, s21, 10
    v_lshl_add_u32 v17, v2, 4, s23
    s_lshl_b32 s21, s16, 8
    v_lshl_add_u32 v18, v15, 4, s21
    s_waitcnt lgkmcnt(0)

    s_add_u32 s24, s4, 0xa00000
    s_addc_u32 s25, s5, 0
    s_add_u32 s26, s4, 0xe00000
    s_addc_u32 s27, s5, 0
    s_add_u32 s28, s4, 0x1a00000
    s_addc_u32 s29, s5, 0
    s_add_u32 s30, s4, 0x1a10000
    s_addc_u32 s31, s5, 0
    global_load_dwordx4 v[20:23], v18, s[28:29] offset:0
    global_load_dwordx4 v[24:27], v18, s[28:29] offset:64
    global_load_dwordx4 v[28:31], v18, s[28:29] offset:128
    global_load_dwordx4 v[32:35], v18, s[28:29] offset:192
    v_mov_b32 v36, 0
    v_mov_b32 v37, 0
    v_mov_b32 v38, 0
    v_mov_b32 v39, 0
    v_mov_b32 v40, 0
    v_mov_b32 v41, 0
    v_mov_b32 v42, 0
    v_mov_b32 v43, 0
    v_mov_b32 v44, 0
    v_mov_b32 v45, 0
    v_mov_b32 v46, 0
    v_mov_b32 v47, 0
    v_mov_b32 v48, 0
    v_mov_b32 v49, 0
    v_mov_b32 v50, 0
    v_mov_b32 v51, 0
    v_mov_b32 v52, 0
    v_mov_b32 v53, 0
    v_mov_b32 v54, 0
    v_mov_b32 v55, 0
    v_mov_b32 v56, 0
    v_mov_b32 v57, 0
    v_mov_b32 v58, 0
    v_mov_b32 v59, 0
    v_mov_b32 v60, 0x3f803f80
    v_mov_b32 v61, 0x3f803f80
    v_mov_b32 v62, 0x3f803f80
    v_mov_b32 v63, 0x3f803f80
    s_barrier
    ds_read_b64_tr_b16 v[64:65], v9 offset:0
    ds_read_b64_tr_b16 v[66:67], v9 offset:1024
    ds_read_b64_tr_b16 v[128:129], v10 offset:0
    ds_read_b64_tr_b16 v[130:131], v10 offset:1024
    ds_read_b64_tr_b16 v[132:133], v11 offset:0
    ds_read_b64_tr_b16 v[134:135], v11 offset:1024
    ds_read_b64_tr_b16 v[136:137], v12 offset:0
    ds_read_b64_tr_b16 v[138:139], v12 offset:1024
    ds_read_b64_tr_b16 v[140:141], v13 offset:0
    ds_read_b64_tr_b16 v[142:143], v13 offset:1024
    ds_read_b64_tr_b16 v[68:69], v9 offset:4096
    ds_read_b64_tr_b16 v[70:71], v9 offset:5120
    ds_read_b64_tr_b16 v[144:145], v10 offset:4096
    ds_read_b64_tr_b16 v[146:147], v10 offset:5120
    ds_read_b64_tr_b16 v[148:149], v11 offset:4096
    ds_read_b64_tr_b16 v[150:151], v11 offset:5120
    ds_read_b64_tr_b16 v[152:153], v12 offset:4096
    ds_read_b64_tr_b16 v[154:155], v12 offset:5120
    ds_read_b64_tr_b16 v[156:157], v13 offset:4096
    ds_read_b64_tr_b16 v[158:159], v13 offset:5120
    s_waitcnt lgkmcnt(10)
    v_mfma_f32_16x16x32_bf16 v[36:39], v[128:131], v[64:67], v[36:39]
    ds_read_b64_tr_b16 v[72:73], v9 offset:8192
    ds_read_b64_tr_b16 v[74:75], v9 offset:9216
    v_mfma_f32_16x16x32_bf16 v[40:43], v[132:135], v[64:67], v[40:43]
    ds_read_b64_tr_b16 v[128:129], v10 offset:8192
    ds_read_b64_tr_b16 v[130:131], v10 offset:9216
    v_mfma_f32_16x16x32_bf16 v[44:47], v[136:139], v[64:67], v[44:47]
    ds_read_b64_tr_b16 v[132:133], v11 offset:8192
    ds_read_b64_tr_b16 v[134:135], v11 offset:9216
    v_mfma_f32_16x16x32_bf16 v[48:51], v[140:143], v[64:67], v[48:51]
    ds_read_b64_tr_b16 v[136:137], v12 offset:8192
    ds_read_b64_tr_b16 v[138:139], v12 offset:9216
    v_mfma_f32_16x16x32_bf16 v[52:55], v[64:67], v[64:67], v[52:55]
    ds_read_b64_tr_b16 v[140:141], v13 offset:8192
    ds_read_b64_tr_b16 v[142:143], v13 offset:9216
    v_mfma_f32_16x16x32_bf16 v[56:59], v[60:63], v[64:67], v[56:59]
    s_waitcnt lgkmcnt(10)
    v_mfma_f32_16x16x32_bf16 v[36:39], v[144:147], v[68:71], v[36:39]
    ds_read_b64_tr_b16 v[76:77], v9 offset:12288
    ds_read_b64_tr_b16 v[78:79], v9 offset:13312
    v_mfma_f32_16x16x32_bf16 v[40:43], v[148:151], v[68:71], v[40:43]
    ds_read_b64_tr_b16 v[144:145], v10 offset:12288
    ds_read_b64_tr_b16 v[146:147], v10 offset:13312
    v_mfma_f32_16x16x32_bf16 v[44:47], v[152:155], v[68:71], v[44:47]
    ds_read_b64_tr_b16 v[148:149], v11 offset:12288
    ds_read_b64_tr_b16 v[150:151], v11 offset:13312
    v_mfma_f32_16x16x32_bf16 v[48:51], v[156:159], v[68:71], v[48:51]
    ds_read_b64_tr_b16 v[152:153], v12 offset:12288
    ds_read_b64_tr_b16 v[154:155], v12 offset:13312
    v_mfma_f32_16x16x32_bf16 v[52:55], v[68:71], v[68:71], v[52:55]
    ds_read_b64_tr_b16 v[156:157], v13 offset:12288
    ds_read_b64_tr_b16 v[158:159], v13 offset:13312
    v_mfma_f32_16x16x32_bf16 v[56:59], v[60:63], v[68:71], v[56:59]
    s_waitcnt lgkmcnt(10)
    s_barrier
    v_mfma_f32_16x16x32_bf16 v[36:39], v[128:131], v[72:75], v[36:39]
    ds_read_b64_tr_b16 v[80:81], v9 offset:16384
    ds_read_b64_tr_b16 v[82:83], v9 offset:17408
    v_mfma_f32_16x16x32_bf16 v[40:43], v[132:135], v[72:75], v[40:43]
    ds_read_b64_tr_b16 v[128:129], v10 offset:16384
    ds_read_b64_tr_b16 v[130:131], v10 offset:17408
    v_mfma_f32_16x16x32_bf16 v[44:47], v[136:139], v[72:75], v[44:47]
    ds_read_b64_tr_b16 v[132:133], v11 offset:16384
    ds_read_b64_tr_b16 v[134:135], v11 offset:17408
    v_mfma_f32_16x16x32_bf16 v[48:51], v[140:143], v[72:75], v[48:51]
    ds_read_b64_tr_b16 v[136:137], v12 offset:16384
    ds_read_b64_tr_b16 v[138:139], v12 offset:17408
    v_mfma_f32_16x16x32_bf16 v[52:55], v[72:75], v[72:75], v[52:55]
    ds_read_b64_tr_b16 v[140:141], v13 offset:16384
    ds_read_b64_tr_b16 v[142:143], v13 offset:17408
    v_mfma_f32_16x16x32_bf16 v[56:59], v[60:63], v[72:75], v[56:59]
    s_waitcnt lgkmcnt(10)
    v_mfma_f32_16x16x32_bf16 v[36:39], v[144:147], v[76:79], v[36:39]
    ds_read_b64_tr_b16 v[84:85], v9 offset:20480
    ds_read_b64_tr_b16 v[86:87], v9 offset:21504
    v_mfma_f32_16x16x32_bf16 v[40:43], v[148:151], v[76:79], v[40:43]
    ds_read_b64_tr_b16 v[144:145], v10 offset:20480
    ds_read_b64_tr_b16 v[146:147], v10 offset:21504
    v_mfma_f32_16x16x32_bf16 v[44:47], v[152:155], v[76:79], v[44:47]
    ds_read_b64_tr_b16 v[148:149], v11 offset:20480
    ds_read_b64_tr_b16 v[150:151], v11 offset:21504
    v_mfma_f32_16x16x32_bf16 v[48:51], v[156:159], v[76:79], v[48:51]
    ds_read_b64_tr_b16 v[152:153], v12 offset:20480
    ds_read_b64_tr_b16 v[154:155], v12 offset:21504
    v_mfma_f32_16x16x32_bf16 v[52:55], v[76:79], v[76:79], v[52:55]
    ds_read_b64_tr_b16 v[156:157], v13 offset:20480
    ds_read_b64_tr_b16 v[158:159], v13 offset:21504
    v_mfma_f32_16x16x32_bf16 v[56:59], v[60:63], v[76:79], v[56:59]
    s_waitcnt lgkmcnt(10)
    v_mfma_f32_16x16x32_bf16 v[36:39], v[128:131], v[80:83], v[36:39]
    ds_read_b64_tr_b16 v[88:89], v9 offset:24576
    ds_read_b64_tr_b16 v[90:91], v9 offset:25600
    v_mfma_f32_16x16x32_bf16 v[40:43], v[132:135], v[80:83], v[40:43]
    ds_read_b64_tr_b16 v[128:129], v10 offset:24576
    ds_read_b64_tr_b16 v[130:131], v10 offset:25600
    v_mfma_f32_16x16x32_bf16 v[44:47], v[136:139], v[80:83], v[44:47]
    ds_read_b64_tr_b16 v[132:133], v11 offset:24576
    ds_read_b64_tr_b16 v[134:135], v11 offset:25600
    v_mfma_f32_16x16x32_bf16 v[48:51], v[140:143], v[80:83], v[48:51]
    ds_read_b64_tr_b16 v[136:137], v12 offset:24576
    ds_read_b64_tr_b16 v[138:139], v12 offset:25600
    v_mfma_f32_16x16x32_bf16 v[52:55], v[80:83], v[80:83], v[52:55]
    ds_read_b64_tr_b16 v[140:141], v13 offset:24576
    ds_read_b64_tr_b16 v[142:143], v13 offset:25600
    v_mfma_f32_16x16x32_bf16 v[56:59], v[60:63], v[80:83], v[56:59]
    s_waitcnt lgkmcnt(10)
    v_mfma_f32_16x16x32_bf16 v[36:39], v[144:147], v[84:87], v[36:39]
    ds_read_b64_tr_b16 v[92:93], v9 offset:28672
    ds_read_b64_tr_b16 v[94:95], v9 offset:29696
    v_mfma_f32_16x16x32_bf16 v[40:43], v[148:151], v[84:87], v[40:43]
    ds_read_b64_tr_b16 v[144:145], v10 offset:28672
    ds_read_b64_tr_b16 v[146:147], v10 offset:29696
    v_mfma_f32_16x16x32_bf16 v[44:47], v[152:155], v[84:87], v[44:47]
    ds_read_b64_tr_b16 v[148:149], v11 offset:28672
    ds_read_b64_tr_b16 v[150:151], v11 offset:29696
    v_mfma_f32_16x16x32_bf16 v[48:51], v[156:159], v[84:87], v[48:51]
    ds_read_b64_tr_b16 v[152:153], v12 offset:28672
    ds_read_b64_tr_b16 v[154:155], v12 offset:29696
    v_mfma_f32_16x16x32_bf16 v[52:55], v[84:87], v[84:87], v[52:55]
    ds_read_b64_tr_b16 v[156:157], v13 offset:28672
    ds_read_b64_tr_b16 v[158:159], v13 offset:29696
    v_mfma_f32_16x16x32_bf16 v[56:59], v[60:63], v[84:87], v[56:59]
    s_waitcnt lgkmcnt(10)
    s_barrier
    v_mfma_f32_16x16x32_bf16 v[36:39], v[128:131], v[88:91], v[36:39]
    ds_read_b64_tr_b16 v[96:97], v9 offset:32768
    ds_read_b64_tr_b16 v[98:99], v9 offset:33792
    v_mfma_f32_16x16x32_bf16 v[40:43], v[132:135], v[88:91], v[40:43]
    ds_read_b64_tr_b16 v[128:129], v10 offset:32768
    ds_read_b64_tr_b16 v[130:131], v10 offset:33792
    v_mfma_f32_16x16x32_bf16 v[44:47], v[136:139], v[88:91], v[44:47]
    ds_read_b64_tr_b16 v[132:133], v11 offset:32768
    ds_read_b64_tr_b16 v[134:135], v11 offset:33792
    v_mfma_f32_16x16x32_bf16 v[48:51], v[140:143], v[88:91], v[48:51]
    ds_read_b64_tr_b16 v[136:137], v12 offset:32768
    ds_read_b64_tr_b16 v[138:139], v12 offset:33792
    v_mfma_f32_16x16x32_bf16 v[52:55], v[88:91], v[88:91], v[52:55]
    ds_read_b64_tr_b16 v[140:141], v13 offset:32768
    ds_read_b64_tr_b16 v[142:143], v13 offset:33792
    v_mfma_f32_16x16x32_bf16 v[56:59], v[60:63], v[88:91], v[56:59]
    s_waitcnt lgkmcnt(10)
    v_mfma_f32_16x16x32_bf16 v[36:39], v[144:147], v[92:95], v[36:39]
    ds_read_b64_tr_b16 v[100:101], v9 offset:36864
    ds_read_b64_tr_b16 v[102:103], v9 offset:37888
    v_mfma_f32_16x16x32_bf16 v[40:43], v[148:151], v[92:95], v[40:43]
    ds_read_b64_tr_b16 v[144:145], v10 offset:36864
    ds_read_b64_tr_b16 v[146:147], v10 offset:37888
    v_mfma_f32_16x16x32_bf16 v[44:47], v[152:155], v[92:95], v[44:47]
    ds_read_b64_tr_b16 v[148:149], v11 offset:36864
    ds_read_b64_tr_b16 v[150:151], v11 offset:37888
    v_mfma_f32_16x16x32_bf16 v[48:51], v[156:159], v[92:95], v[48:51]
    ds_read_b64_tr_b16 v[152:153], v12 offset:36864
    ds_read_b64_tr_b16 v[154:155], v12 offset:37888
    v_mfma_f32_16x16x32_bf16 v[52:55], v[92:95], v[92:95], v[52:55]
    ds_read_b64_tr_b16 v[156:157], v13 offset:36864
    ds_read_b64_tr_b16 v[158:159], v13 offset:37888
    v_mfma_f32_16x16x32_bf16 v[56:59], v[60:63], v[92:95], v[56:59]
    s_waitcnt lgkmcnt(10)
    v_mfma_f32_16x16x32_bf16 v[36:39], v[128:131], v[96:99], v[36:39]
    ds_read_b64_tr_b16 v[104:105], v9 offset:40960
    ds_read_b64_tr_b16 v[106:107], v9 offset:41984
    v_mfma_f32_16x16x32_bf16 v[40:43], v[132:135], v[96:99], v[40:43]
    ds_read_b64_tr_b16 v[128:129], v10 offset:40960
    ds_read_b64_tr_b16 v[130:131], v10 offset:41984
    v_mfma_f32_16x16x32_bf16 v[44:47], v[136:139], v[96:99], v[44:47]
    ds_read_b64_tr_b16 v[132:133], v11 offset:40960
    ds_read_b64_tr_b16 v[134:135], v11 offset:41984
    v_mfma_f32_16x16x32_bf16 v[48:51], v[140:143], v[96:99], v[48:51]
    ds_read_b64_tr_b16 v[136:137], v12 offset:40960
    ds_read_b64_tr_b16 v[138:139], v12 offset:41984
    v_mfma_f32_16x16x32_bf16 v[52:55], v[96:99], v[96:99], v[52:55]
    ds_read_b64_tr_b16 v[140:141], v13 offset:40960
    ds_read_b64_tr_b16 v[142:143], v13 offset:41984
    v_mfma_f32_16x16x32_bf16 v[56:59], v[60:63], v[96:99], v[56:59]
    s_waitcnt lgkmcnt(10)
    v_mfma_f32_16x16x32_bf16 v[36:39], v[144:147], v[100:103], v[36:39]
    ds_read_b64_tr_b16 v[108:109], v9 offset:45056
    ds_read_b64_tr_b16 v[110:111], v9 offset:46080
    v_mfma_f32_16x16x32_bf16 v[40:43], v[148:151], v[100:103], v[40:43]
    ds_read_b64_tr_b16 v[144:145], v10 offset:45056
    ds_read_b64_tr_b16 v[146:147], v10 offset:46080
    v_mfma_f32_16x16x32_bf16 v[44:47], v[152:155], v[100:103], v[44:47]
    ds_read_b64_tr_b16 v[148:149], v11 offset:45056
    ds_read_b64_tr_b16 v[150:151], v11 offset:46080
    v_mfma_f32_16x16x32_bf16 v[48:51], v[156:159], v[100:103], v[48:51]
    ds_read_b64_tr_b16 v[152:153], v12 offset:45056
    ds_read_b64_tr_b16 v[154:155], v12 offset:46080
    v_mfma_f32_16x16x32_bf16 v[52:55], v[100:103], v[100:103], v[52:55]
    ds_read_b64_tr_b16 v[156:157], v13 offset:45056
    ds_read_b64_tr_b16 v[158:159], v13 offset:46080
    v_mfma_f32_16x16x32_bf16 v[56:59], v[60:63], v[100:103], v[56:59]
    s_waitcnt lgkmcnt(10)
    s_barrier
    v_mfma_f32_16x16x32_bf16 v[36:39], v[128:131], v[104:107], v[36:39]
    ds_read_b64_tr_b16 v[112:113], v9 offset:49152
    ds_read_b64_tr_b16 v[114:115], v9 offset:50176
    v_mfma_f32_16x16x32_bf16 v[40:43], v[132:135], v[104:107], v[40:43]
    ds_read_b64_tr_b16 v[128:129], v10 offset:49152
    ds_read_b64_tr_b16 v[130:131], v10 offset:50176
    v_mfma_f32_16x16x32_bf16 v[44:47], v[136:139], v[104:107], v[44:47]
    ds_read_b64_tr_b16 v[132:133], v11 offset:49152
    ds_read_b64_tr_b16 v[134:135], v11 offset:50176
    v_mfma_f32_16x16x32_bf16 v[48:51], v[140:143], v[104:107], v[48:51]
    ds_read_b64_tr_b16 v[136:137], v12 offset:49152
    ds_read_b64_tr_b16 v[138:139], v12 offset:50176
    v_mfma_f32_16x16x32_bf16 v[52:55], v[104:107], v[104:107], v[52:55]
    ds_read_b64_tr_b16 v[140:141], v13 offset:49152
    ds_read_b64_tr_b16 v[142:143], v13 offset:50176
    v_mfma_f32_16x16x32_bf16 v[56:59], v[60:63], v[104:107], v[56:59]
    s_waitcnt lgkmcnt(10)
    v_mfma_f32_16x16x32_bf16 v[36:39], v[144:147], v[108:111], v[36:39]
    ds_read_b64_tr_b16 v[116:117], v9 offset:53248
    ds_read_b64_tr_b16 v[118:119], v9 offset:54272
    v_mfma_f32_16x16x32_bf16 v[40:43], v[148:151], v[108:111], v[40:43]
    ds_read_b64_tr_b16 v[144:145], v10 offset:53248
    ds_read_b64_tr_b16 v[146:147], v10 offset:54272
    v_mfma_f32_16x16x32_bf16 v[44:47], v[152:155], v[108:111], v[44:47]
    ds_read_b64_tr_b16 v[148:149], v11 offset:53248
    ds_read_b64_tr_b16 v[150:151], v11 offset:54272
    v_mfma_f32_16x16x32_bf16 v[48:51], v[156:159], v[108:111], v[48:51]
    ds_read_b64_tr_b16 v[152:153], v12 offset:53248
    ds_read_b64_tr_b16 v[154:155], v12 offset:54272
    v_mfma_f32_16x16x32_bf16 v[52:55], v[108:111], v[108:111], v[52:55]
    ds_read_b64_tr_b16 v[156:157], v13 offset:53248
    ds_read_b64_tr_b16 v[158:159], v13 offset:54272
    v_mfma_f32_16x16x32_bf16 v[56:59], v[60:63], v[108:111], v[56:59]
    s_waitcnt lgkmcnt(10)
    v_mfma_f32_16x16x32_bf16 v[36:39], v[128:131], v[112:115], v[36:39]
    ds_read_b64_tr_b16 v[120:121], v9 offset:57344
    ds_read_b64_tr_b16 v[122:123], v9 offset:58368
    v_mfma_f32_16x16x32_bf16 v[40:43], v[132:135], v[112:115], v[40:43]
    ds_read_b64_tr_b16 v[128:129], v10 offset:57344
    ds_read_b64_tr_b16 v[130:131], v10 offset:58368
    v_mfma_f32_16x16x32_bf16 v[44:47], v[136:139], v[112:115], v[44:47]
    ds_read_b64_tr_b16 v[132:133], v11 offset:57344
    ds_read_b64_tr_b16 v[134:135], v11 offset:58368
    v_mfma_f32_16x16x32_bf16 v[48:51], v[140:143], v[112:115], v[48:51]
    ds_read_b64_tr_b16 v[136:137], v12 offset:57344
    ds_read_b64_tr_b16 v[138:139], v12 offset:58368
    v_mfma_f32_16x16x32_bf16 v[52:55], v[112:115], v[112:115], v[52:55]
    ds_read_b64_tr_b16 v[140:141], v13 offset:57344
    ds_read_b64_tr_b16 v[142:143], v13 offset:58368
    v_mfma_f32_16x16x32_bf16 v[56:59], v[60:63], v[112:115], v[56:59]
    s_waitcnt lgkmcnt(10)
    v_mfma_f32_16x16x32_bf16 v[36:39], v[144:147], v[116:119], v[36:39]
    ds_read_b64_tr_b16 v[124:125], v9 offset:61440
    ds_read_b64_tr_b16 v[126:127], v9 offset:62464
    v_mfma_f32_16x16x32_bf16 v[40:43], v[148:151], v[116:119], v[40:43]
    ds_read_b64_tr_b16 v[144:145], v10 offset:61440
    ds_read_b64_tr_b16 v[146:147], v10 offset:62464
    v_mfma_f32_16x16x32_bf16 v[44:47], v[152:155], v[116:119], v[44:47]
    ds_read_b64_tr_b16 v[148:149], v11 offset:61440
    ds_read_b64_tr_b16 v[150:151], v11 offset:62464
    v_mfma_f32_16x16x32_bf16 v[48:51], v[156:159], v[116:119], v[48:51]
    ds_read_b64_tr_b16 v[152:153], v12 offset:61440
    ds_read_b64_tr_b16 v[154:155], v12 offset:62464
    v_mfma_f32_16x16x32_bf16 v[52:55], v[116:119], v[116:119], v[52:55]
    ds_read_b64_tr_b16 v[156:157], v13 offset:61440
    ds_read_b64_tr_b16 v[158:159], v13 offset:62464
    v_mfma_f32_16x16x32_bf16 v[56:59], v[60:63], v[116:119], v[56:59]
    s_waitcnt lgkmcnt(10)
    v_mfma_f32_16x16x32_bf16 v[36:39], v[128:131], v[120:123], v[36:39]
    v_mfma_f32_16x16x32_bf16 v[40:43], v[132:135], v[120:123], v[40:43]
    v_mfma_f32_16x16x32_bf16 v[44:47], v[136:139], v[120:123], v[44:47]
    v_mfma_f32_16x16x32_bf16 v[48:51], v[140:143], v[120:123], v[48:51]
    v_mfma_f32_16x16x32_bf16 v[52:55], v[120:123], v[120:123], v[52:55]
    v_mfma_f32_16x16x32_bf16 v[56:59], v[60:63], v[120:123], v[56:59]
    s_waitcnt lgkmcnt(0)
    v_mfma_f32_16x16x32_bf16 v[36:39], v[144:147], v[124:127], v[36:39]
    v_mfma_f32_16x16x32_bf16 v[40:43], v[148:151], v[124:127], v[40:43]
    v_mfma_f32_16x16x32_bf16 v[44:47], v[152:155], v[124:127], v[44:47]
    v_mfma_f32_16x16x32_bf16 v[48:51], v[156:159], v[124:127], v[48:51]
    v_mfma_f32_16x16x32_bf16 v[52:55], v[124:127], v[124:127], v[52:55]
    v_mfma_f32_16x16x32_bf16 v[56:59], v[60:63], v[124:127], v[56:59]
    s_cmp_lg_u32 s16, 0
    s_cbranch_scc1 K3_hr_3
    v_add_u32 v17, 0, v17
    global_store_dwordx4 v17, v[64:67], s[24:25] offset:0
    global_store_dwordx4 v17, v[68:71], s[24:25] offset:1024
K3_hr_3:
    s_cmp_lg_u32 s16, 1
    s_cbranch_scc1 K3_hr_4
    v_add_u32 v17, 2048, v17
    global_store_dwordx4 v17, v[72:75], s[24:25] offset:0
    global_store_dwordx4 v17, v[76:79], s[24:25] offset:1024
K3_hr_4:
    s_cmp_lg_u32 s16, 2
    s_cbranch_scc1 K3_hr_5
    v_add_u32 v17, 4096, v17
    global_store_dwordx4 v17, v[80:83], s[24:25] offset:0
    global_store_dwordx4 v17, v[84:87], s[24:25] offset:1024
K3_hr_5:
    s_cmp_lg_u32 s16, 3
    s_cbranch_scc1 K3_hr_6
    v_add_u32 v17, 6144, v17
    global_store_dwordx4 v17, v[88:91], s[24:25] offset:0
    global_store_dwordx4 v17, v[92:95], s[24:25] offset:1024
K3_hr_6:
    s_cmp_lg_u32 s16, 4
    s_cbranch_scc1 K3_hr_7
    v_add_u32 v17, 8192, v17
    global_store_dwordx4 v17, v[96:99], s[24:25] offset:0
    global_store_dwordx4 v17, v[100:103], s[24:25] offset:1024
K3_hr_7:
    s_cmp_lg_u32 s16, 5
    s_cbranch_scc1 K3_hr_8
    v_add_u32 v17, 10240, v17
    global_store_dwordx4 v17, v[104:107], s[24:25] offset:0
    global_store_dwordx4 v17, v[108:111], s[24:25] offset:1024
K3_hr_8:
    s_cmp_lg_u32 s16, 6
    s_cbranch_scc1 K3_hr_9
    v_add_u32 v17, 12288, v17
    global_store_dwordx4 v17, v[112:115], s[24:25] offset:0
    global_store_dwordx4 v17, v[116:119], s[24:25] offset:1024
K3_hr_9:
    s_cmp_lg_u32 s16, 7
    s_cbranch_scc1 K3_hr_10
    v_add_u32 v17, 14336, v17
    global_store_dwordx4 v17, v[120:123], s[24:25] offset:0
    global_store_dwordx4 v17, v[124:127], s[24:25] offset:1024
K3_hr_10:
    s_waitcnt vmcnt(2)
    v_and_b32 v7, 3, v2
    v_cmp_eq_u32 vcc, 1, v7
    v_cmp_eq_u32 s[32:33], 2, v7
    v_cmp_eq_u32 s[34:35], 3, v7
    v_and_b32 v8, 15, v2
    v_lshrrev_b32 v7, 2, v8
    v_cndmask_b32 v52, v52, v53, vcc
    v_cndmask_b32 v52, v52, v54, s[32:33]
    v_cndmask_b32 v52, v52, v55, s[34:35]
    v_lshl_add_u32 v7, v7, 4, v8
    v_lshlrev_b32 v7, 2, v7
    ds_bpermute_b32 v52, v7, v52
    v_mul_f32 v56, 0x3b000000, v56
    s_waitcnt lgkmcnt(0)
    v_mul_f32 v52, 0x3b000000, v52
    v_fma_f32 v52, -v56, v56, v52
    v_max_f32 v52, 0, v52
    v_mov_b32 v57, v56
    v_mov_b32 v53, v52

    v_cvt_pk_bf16_f32 v7, v56, v52
    v_lshlrev_b32 v56, 16, v7
    v_and_b32 v52, 0xffff0000, v7
    v_add_f32 v52, 0x3727c5ac, v52
    v_cvt_pk_bf16_f32 v7, v52, v52
    v_lshlrev_b32 v52, 16, v7
    v_sqrt_f32 v52, v52
    s_nop 0
    v_cvt_pk_bf16_f32 v7, v52, v52
    v_lshlrev_b32 v52, 16, v7
    v_rcp_f32 v52, v52
    s_nop 0
    v_sub_f32 v57, v57, v56
    v_mul_f32 v57, v57, v52
    v_mul_f32 v53, v53, v52
    v_mul_f32 v53, v53, v52

    v_cvt_pk_bf16_f32 v7, v57, v53
    v_lshlrev_b32 v57, 16, v7
    v_and_b32 v53, 0xffff0000, v7
    v_add_f32 v53, 0x3727c5ac, v53
    v_cvt_pk_bf16_f32 v7, v53, v53
    v_lshlrev_b32 v53, 16, v7
    v_sqrt_f32 v53, v53
    s_nop 0
    v_cvt_pk_bf16_f32 v7, v53, v53
    v_lshlrev_b32 v53, 16, v7
    v_rcp_f32 v53, v53
    s_nop 0
    v_mul_f32 v60, v52, v53
    v_fma_f32 v61, v52, v56, v57
    v_mul_f32 v61, v61, v53
    v_mov_b32 v58, v56
    v_mov_b32 v59, v52
    v_mov_b32 v128, 0x40135761
    v_mov_b32 v129, 0x3dd2d3e8
    v_mov_b32 v130, 1.0
    v_mov_b32 v131, 1.0
    s_cmp_lg_u32 s16, 0
    s_cbranch_scc1 K3_nost
    v_cmp_gt_u32 vcc, 16, v2
    s_and_saveexec_b64 s[32:33], vcc
    global_store_dwordx2 v16, v[58:59], s[30:31]
    s_mov_b64 exec, s[32:33]

K3_nost:
    v_pk_mul_f32 v[144:145], v[20:21], v[60:61] op_sel:[0,1] op_sel_hi:[1,1]
    v_pk_mul_f32 v[146:147], v[22:23], v[60:61] op_sel:[0,1] op_sel_hi:[1,1]
    v_pk_mul_f32 v[148:149], v[24:25], v[60:61] op_sel:[0,1] op_sel_hi:[1,1]
    v_pk_mul_f32 v[150:151], v[26:27], v[60:61] op_sel:[0,1] op_sel_hi:[1,1]
    v_pk_fma_f32 v[36:37], v[36:37], v[60:61], v[144:145] op_sel_hi:[1,0,1] neg_lo:[0,0,1] neg_hi:[0,0,1]
    v_pk_fma_f32 v[38:39], v[38:39], v[60:61], v[146:147] op_sel_hi:[1,0,1] neg_lo:[0,0,1] neg_hi:[0,0,1]
    v_pk_fma_f32 v[40:41], v[40:41], v[60:61], v[148:149] op_sel_hi:[1,0,1] neg_lo:[0,0,1] neg_hi:[0,0,1]
    v_pk_fma_f32 v[42:43], v[42:43], v[60:61], v[150:151] op_sel_hi:[1,0,1] neg_lo:[0,0,1] neg_hi:[0,0,1]
    v_cvt_pk_bf16_f32 v144, v36, v37
    v_cvt_pk_bf16_f32 v146, v38, v39
    v_cvt_pk_bf16_f32 v148, v40, v41
    v_cvt_pk_bf16_f32 v150, v42, v43
    v_lshlrev_b32 v36, 16, v144
    v_and_b32 v37, 0xffff0000, v144
    v_lshlrev_b32 v38, 16, v146
    v_and_b32 v39, 0xffff0000, v146
    v_lshlrev_b32 v40, 16, v148
    v_and_b32 v41, 0xffff0000, v148
    v_lshlrev_b32 v42, 16, v150
    v_and_b32 v43, 0xffff0000, v150
    v_pk_mul_f32 v[144:145], v[28:29], v[60:61] op_sel:[0,1] op_sel_hi:[1,1]
    v_pk_mul_f32 v[146:147], v[30:31], v[60:61] op_sel:[0,1] op_sel_hi:[1,1]
    v_pk_mul_f32 v[148:149], v[32:33], v[60:61] op_sel:[0,1] op_sel_hi:[1,1]
    v_pk_mul_f32 v[150:151], v[34:35], v[60:61] op_sel:[0,1] op_sel_hi:[1,1]
    v_pk_fma_f32 v[44:45], v[44:45], v[60:61], v[144:145] op_sel_hi:[1,0,1] neg_lo:[0,0,1] neg_hi:[0,0,1]
    v_pk_fma_f32 v[46:47], v[46:47], v[60:61], v[146:147] op_sel_hi:[1,0,1] neg_lo:[0,0,1] neg_hi:[0,0,1]
    v_pk_fma_f32 v[48:49], v[48:49], v[60:61], v[148:149] op_sel_hi:[1,0,1] neg_lo:[0,0,1] neg_hi:[0,0,1]
    v_pk_fma_f32 v[50:51], v[50:51], v[60:61], v[150:151] op_sel_hi:[1,0,1] neg_lo:[0,0,1] neg_hi:[0,0,1]
    v_cvt_pk_bf16_f32 v144, v44, v45
    v_cvt_pk_bf16_f32 v146, v46, v47
    v_cvt_pk_bf16_f32 v148, v48, v49
    v_cvt_pk_bf16_f32 v150, v50, v51
    v_lshlrev_b32 v44, 16, v144
    v_and_b32 v45, 0xffff0000, v144
    v_lshlrev_b32 v46, 16, v146
    v_and_b32 v47, 0xffff0000, v146
    v_lshlrev_b32 v48, 16, v148
    v_and_b32 v49, 0xffff0000, v148
    v_lshlrev_b32 v50, 16, v150
    v_and_b32 v51, 0xffff0000, v150
    v_pk_mul_f32 v[144:145], v[36:37], v[36:37]
    v_pk_mul_f32 v[146:147], v[38:39], v[38:39]
    v_pk_mul_f32 v[148:149], v[40:41], v[40:41]
    v_pk_mul_f32 v[150:151], v[42:43], v[42:43]
    v_pk_fma_f32 v[144:145], v[144:145], v[128:129], v[128:129] op_sel:[0,1,0] op_sel_hi:[1,1,0]
    v_pk_fma_f32 v[146:147], v[146:147], v[128:129], v[128:129] op_sel:[0,1,0] op_sel_hi:[1,1,0]
    v_pk_fma_f32 v[148:149], v[148:149], v[128:129], v[128:129] op_sel:[0,1,0] op_sel_hi:[1,1,0]
    v_pk_fma_f32 v[150:151], v[150:151], v[128:129], v[128:129] op_sel:[0,1,0] op_sel_hi:[1,1,0]
    v_pk_mul_f32 v[144:145], v[144:145], v[36:37]
    v_pk_mul_f32 v[146:147], v[146:147], v[38:39]
    v_pk_mul_f32 v[148:149], v[148:149], v[40:41]
    v_pk_mul_f32 v[150:151], v[150:151], v[42:43]
    v_exp_f32 v144, -v144
    v_exp_f32 v145, -v145
    v_exp_f32 v146, -v146
    v_exp_f32 v147, -v147
    v_exp_f32 v148, -v148
    v_exp_f32 v149, -v149
    v_exp_f32 v150, -v150
    v_exp_f32 v151, -v151
    v_pk_add_f32 v[144:145], v[144:145], v[130:131]
    v_pk_add_f32 v[146:147], v[146:147], v[130:131]
    v_pk_add_f32 v[148:149], v[148:149], v[130:131]
    v_pk_add_f32 v[150:151], v[150:151], v[130:131]
    v_rcp_f32 v144, v144
    v_rcp_f32 v145, v145
    v_rcp_f32 v146, v146
    v_rcp_f32 v147, v147
    v_rcp_f32 v148, v148
    v_rcp_f32 v149, v149
    v_rcp_f32 v150, v150
    v_rcp_f32 v151, v151
    v_pk_mul_f32 v[36:37], v[36:37], v[144:145]
    v_pk_mul_f32 v[38:39], v[38:39], v[146:147]
    v_pk_mul_f32 v[40:41], v[40:41], v[148:149]
    v_pk_mul_f32 v[42:43], v[42:43], v[150:151]
    v_pk_mul_f32 v[144:145], v[44:45], v[44:45]
    v_pk_mul_f32 v[146:147], v[46:47], v[46:47]
    v_pk_mul_f32 v[148:149], v[48:49], v[48:49]
    v_pk_mul_f32 v[150:151], v[50:51], v[50:51]
    v_pk_fma_f32 v[144:145], v[144:145], v[128:129], v[128:129] op_sel:[0,1,0] op_sel_hi:[1,1,0]
    v_pk_fma_f32 v[146:147], v[146:147], v[128:129], v[128:129] op_sel:[0,1,0] op_sel_hi:[1,1,0]
    v_pk_fma_f32 v[148:149], v[148:149], v[128:129], v[128:129] op_sel:[0,1,0] op_sel_hi:[1,1,0]
    v_pk_fma_f32 v[150:151], v[150:151], v[128:129], v[128:129] op_sel:[0,1,0] op_sel_hi:[1,1,0]
    v_pk_mul_f32 v[144:145], v[144:145], v[44:45]
    v_pk_mul_f32 v[146:147], v[146:147], v[46:47]
    v_pk_mul_f32 v[148:149], v[148:149], v[48:49]
    v_pk_mul_f32 v[150:151], v[150:151], v[50:51]
    v_exp_f32 v144, -v144
    v_exp_f32 v145, -v145
    v_exp_f32 v146, -v146
    v_exp_f32 v147, -v147
    v_exp_f32 v148, -v148
    v_exp_f32 v149, -v149
    v_exp_f32 v150, -v150
    v_exp_f32 v151, -v151
    v_pk_add_f32 v[144:145], v[144:145], v[130:131]
    v_pk_add_f32 v[146:147], v[146:147], v[130:131]
    v_pk_add_f32 v[148:149], v[148:149], v[130:131]
    v_pk_add_f32 v[150:151], v[150:151], v[130:131]
    v_rcp_f32 v144, v144
    v_rcp_f32 v145, v145
    v_rcp_f32 v146, v146
    v_rcp_f32 v147, v147
    v_rcp_f32 v148, v148
    v_rcp_f32 v149, v149
    v_rcp_f32 v150, v150
    v_rcp_f32 v151, v151
    v_pk_mul_f32 v[44:45], v[44:45], v[144:145]
    v_pk_mul_f32 v[46:47], v[46:47], v[146:147]
    v_pk_mul_f32 v[48:49], v[48:49], v[148:149]
    v_pk_mul_f32 v[50:51], v[50:51], v[150:151]
    v_cvt_pk_bf16_f32 v136, v36, v37
    v_cvt_pk_bf16_f32 v137, v38, v39
    v_cvt_pk_bf16_f32 v138, v40, v41
    v_cvt_pk_bf16_f32 v139, v42, v43
    v_cvt_pk_bf16_f32 v140, v44, v45
    v_cvt_pk_bf16_f32 v141, v46, v47
    v_cvt_pk_bf16_f32 v142, v48, v49
    v_cvt_pk_bf16_f32 v143, v50, v51
    v_and_b32 v7, 1, v15
    v_lshrrev_b32 v8, 1, v15
    v_lshl_add_u32 v7, v7, 1, v8
    v_and_b32 v8, 15, v2
    v_lshl_add_u32 v7, v7, 4, v8
    s_lshl_b32 s21, s16, 11
    s_add_u32 s21, s21, s23
    v_lshl_add_u32 v7, v7, 4, s21

    v_permlane16_swap_b32 v136, v138
    v_permlane16_swap_b32 v137, v139
    v_permlane16_swap_b32 v140, v142
    v_permlane16_swap_b32 v141, v143
    s_nop 1
    global_store_dwordx4 v7, v[136:139], s[26:27] offset:0
    global_store_dwordx4 v7, v[140:143], s[26:27] offset:1024
K3_exit:
    s_endpgm
.text
.globl k4_kernel
.p2align 8
.type k4_kernel,@function
k4_kernel:
    s_cmp_ge_u32 s2, 256
    s_cbranch_scc1 K4_exit
    s_load_dwordx2 s[4:5], s[0:1], 128
    s_load_dwordx2 s[6:7], s[0:1], 88
    s_load_dwordx2 s[44:45], s[0:1], 96

    v_lshrrev_b32 v1, 6, v0
    v_and_b32 v2, 63, v0
    v_readfirstlane_b32 s24, v1
    s_and_b32 s3, s24, 3

    s_bfe_u32 s16, s2, 0x30003
    s_and_b32 s17, s2, 7
    s_lshl_b32 s17, s17, 2
    s_lshr_b32 s19, s2, 6
    s_add_u32 s17, s17, s19

    s_lshr_b32 s18, s3, 1
    s_lshl_b32 s18, s18, 4
    s_and_b32 s19, s3, 1
    s_lshl_b32 s19, s19, 2
    s_add_u32 s18, s18, s19

    s_lshl_b32 s39, s17, 6
    s_lshl_b32 s23, s3, 4
    s_add_u32 s39, s39, s23
    s_lshl_b32 s38, s39, 10
    s_lshl_b32 s20, s18, 10
    s_lshl_b32 s37, s16, 7
    s_add_u32 s20, s20, s37
    s_cmp_ge_u32 s24, 4
    s_cbranch_scc1 K4_loader
    v_and_b32 v14, 15, v2
    v_lshrrev_b32 v15, 4, v2
    v_add_u32 v14, s39, v14
    v_lshlrev_b32 v16, 3, v14
    v_lshlrev_b32 v19, 6, v14

    v_add_u32 v5, -1, v14
    v_ashrrev_i32 v6, 4, v5
    v_lshlrev_b32 v6, 14, v6
    v_and_b32 v5, 15, v5
    v_lshl_add_u32 v6, v5, 4, v6
    v_lshl_add_u32 v6, v15, 8, v6
    v_add_u32 v52, 0, v6
    v_add_u32 v5, 1, v14
    v_ashrrev_i32 v6, 4, v5
    v_lshlrev_b32 v6, 14, v6
    v_and_b32 v5, 15, v5
    v_lshl_add_u32 v6, v5, 4, v6
    v_lshl_add_u32 v6, v15, 8, v6
    v_add_u32 v53, 4096, v6
    v_add_u32 v5, -2, v14
    v_ashrrev_i32 v6, 4, v5
    v_lshlrev_b32 v6, 14, v6
    v_and_b32 v5, 15, v5
    v_lshl_add_u32 v6, v5, 4, v6
    v_lshl_add_u32 v6, v15, 8, v6
    v_add_u32 v54, 8192, v6
    v_add_u32 v5, 2, v14
    v_ashrrev_i32 v6, 4, v5
    v_lshlrev_b32 v6, 14, v6
    v_and_b32 v5, 15, v5
    v_lshl_add_u32 v6, v5, 4, v6
    v_lshl_add_u32 v6, v15, 8, v6
    v_add_u32 v55, 12288, v6
    v_lshrrev_b32 v18, 1, v15
    v_lshlrev_b32 v18, 8, v18
    v_and_b32 v5, 15, v2
    v_lshl_add_u32 v18, v5, 4, v18
    v_and_b32 v5, 1, v15
    v_lshl_add_u32 v18, v5, 3, v18
    s_lshl_b32 s21, s16, 11
    s_add_u32 s21, s21, s38
    v_add_u32 v18, s21, v18
    s_waitcnt lgkmcnt(0)
    s_add_u32 s8, s4, 0xe00000
    s_addc_u32 s9, s5, 0
    s_mov_b32 s10, 2097152
    s_mov_b32 s11, 0x00020000
    s_add_u32 s24, s4, 0xa00000
    s_addc_u32 s25, s5, 0
    s_add_u32 s26, s4, 0x1000000
    s_addc_u32 s27, s5, 0
    s_add_u32 s28, s4, 0x1a20000
    s_addc_u32 s29, s5, 0
    s_add_u32 s30, s4, 0x1a10000
    s_addc_u32 s31, s5, 0
    global_load_dwordx2 v[20:21], v18, s[24:25] offset:0
    global_load_dwordx2 v[22:23], v18, s[24:25] offset:512
    global_load_dwordx2 v[24:25], v18, s[24:25] offset:1024
    global_load_dwordx2 v[26:27], v18, s[24:25] offset:1536
    global_load_dwordx2 v[28:29], v16, s[30:31]
    buffer_load_dwordx4 v[96:99], v52, s[8:11], 0 offen offset:0
    buffer_load_dwordx4 v[100:103], v52, s[8:11], 0 offen offset:1024
    buffer_load_dwordx4 v[104:107], v52, s[8:11], 0 offen offset:2048
    buffer_load_dwordx4 v[108:111], v52, s[8:11], 0 offen offset:3072
    buffer_load_dwordx4 v[112:115], v53, s[8:11], 0 offen offset:0
    buffer_load_dwordx4 v[116:119], v53, s[8:11], 0 offen offset:1024
    buffer_load_dwordx4 v[120:123], v53, s[8:11], 0 offen offset:2048
    buffer_load_dwordx4 v[124:127], v53, s[8:11], 0 offen offset:3072
    buffer_load_dwordx4 v[128:131], v54, s[8:11], 0 offen offset:0
    buffer_load_dwordx4 v[132:135], v54, s[8:11], 0 offen offset:1024
    buffer_load_dwordx4 v[136:139], v54, s[8:11], 0 offen offset:2048
    buffer_load_dwordx4 v[140:143], v54, s[8:11], 0 offen offset:3072
    buffer_load_dwordx4 v[144:147], v55, s[8:11], 0 offen offset:0
    buffer_load_dwordx4 v[148:151], v55, s[8:11], 0 offen offset:1024
    buffer_load_dwordx4 v[152:155], v55, s[8:11], 0 offen offset:2048
    buffer_load_dwordx4 v[156:159], v55, s[8:11], 0 offen offset:3072
    v_lshrrev_b32 v7, 5, v2
    v_lshlrev_b32 v7, 4, v7
    v_bfe_u32 v10, v2, 2, 3
    v_add_u32 v7, v7, v10
    v_lshlrev_b32 v5, 7, v7
    v_and_b32 v7, 3, v2
    v_lshl_add_u32 v5, v7, 3, v5
    v_lshrrev_b32 v6, 1, v10
    v_xor_b32 v7, 0, v6
    v_lshl_add_u32 v10, v7, 5, v5
    v_xor_b32 v7, 1, v6
    v_lshl_add_u32 v11, v7, 5, v5
    v_xor_b32 v7, 2, v6
    v_lshl_add_u32 v12, v7, 5, v5
    v_xor_b32 v7, 3, v6
    v_lshl_add_u32 v13, v7, 5, v5
    v_mov_b32 v36, 0
    v_mov_b32 v37, 0
    v_mov_b32 v38, 0
    v_mov_b32 v39, 0
    v_mov_b32 v40, 0
    v_mov_b32 v41, 0
    v_mov_b32 v42, 0
    v_mov_b32 v43, 0
    v_mov_b32 v44, 0
    v_mov_b32 v45, 0
    v_mov_b32 v46, 0
    v_mov_b32 v47, 0
    v_mov_b32 v48, 0
    v_mov_b32 v49, 0
    v_mov_b32 v50, 0
    v_mov_b32 v51, 0
    s_barrier
    ds_read_b64_tr_b16 v[64:65], v10 offset:0
    ds_read_b64_tr_b16 v[66:67], v10 offset:1024
    ds_read_b64_tr_b16 v[68:69], v11 offset:0
    ds_read_b64_tr_b16 v[70:71], v11 offset:1024
    ds_read_b64_tr_b16 v[72:73], v12 offset:0
    ds_read_b64_tr_b16 v[74:75], v12 offset:1024
    ds_read_b64_tr_b16 v[76:77], v13 offset:0
    ds_read_b64_tr_b16 v[78:79], v13 offset:1024
    ds_read_b64_tr_b16 v[80:81], v10 offset:4096
    ds_read_b64_tr_b16 v[82:83], v10 offset:5120
    ds_read_b64_tr_b16 v[84:85], v11 offset:4096
    ds_read_b64_tr_b16 v[86:87], v11 offset:5120
    ds_read_b64_tr_b16 v[88:89], v12 offset:4096
    ds_read_b64_tr_b16 v[90:91], v12 offset:5120
    ds_read_b64_tr_b16 v[92:93], v13 offset:4096
    ds_read_b64_tr_b16 v[94:95], v13 offset:5120
    s_waitcnt vmcnt(15) lgkmcnt(8)
    v_mfma_f32_16x16x32_bf16 v[36:39], v[64:67], v[96:99], v[36:39]
    v_mfma_f32_16x16x32_bf16 v[40:43], v[68:71], v[96:99], v[40:43]
    ds_read_b64_tr_b16 v[64:65], v10 offset:8192
    ds_read_b64_tr_b16 v[66:67], v10 offset:9216
    v_mfma_f32_16x16x32_bf16 v[44:47], v[72:75], v[96:99], v[44:47]
    ds_read_b64_tr_b16 v[68:69], v11 offset:8192
    ds_read_b64_tr_b16 v[70:71], v11 offset:9216
    v_mfma_f32_16x16x32_bf16 v[48:51], v[76:79], v[96:99], v[48:51]
    ds_read_b64_tr_b16 v[72:73], v12 offset:8192
    ds_read_b64_tr_b16 v[74:75], v12 offset:9216
    ds_read_b64_tr_b16 v[76:77], v13 offset:8192
    ds_read_b64_tr_b16 v[78:79], v13 offset:9216
    s_waitcnt vmcnt(14) lgkmcnt(8)
    v_mfma_f32_16x16x32_bf16 v[36:39], v[80:83], v[100:103], v[36:39]
    v_mfma_f32_16x16x32_bf16 v[40:43], v[84:87], v[100:103], v[40:43]
    ds_read_b64_tr_b16 v[80:81], v10 offset:12288
    ds_read_b64_tr_b16 v[82:83], v10 offset:13312
    v_mfma_f32_16x16x32_bf16 v[44:47], v[88:91], v[100:103], v[44:47]
    ds_read_b64_tr_b16 v[84:85], v11 offset:12288
    ds_read_b64_tr_b16 v[86:87], v11 offset:13312
    v_mfma_f32_16x16x32_bf16 v[48:51], v[92:95], v[100:103], v[48:51]
    ds_read_b64_tr_b16 v[88:89], v12 offset:12288
    ds_read_b64_tr_b16 v[90:91], v12 offset:13312
    ds_read_b64_tr_b16 v[92:93], v13 offset:12288
    ds_read_b64_tr_b16 v[94:95], v13 offset:13312
    s_waitcnt vmcnt(13) lgkmcnt(8)
    s_barrier
    v_mfma_f32_16x16x32_bf16 v[36:39], v[64:67], v[104:107], v[36:39]
    v_mfma_f32_16x16x32_bf16 v[40:43], v[68:71], v[104:107], v[40:43]
    ds_read_b64_tr_b16 v[64:65], v10 offset:16384
    ds_read_b64_tr_b16 v[66:67], v10 offset:17408
    v_mfma_f32_16x16x32_bf16 v[44:47], v[72:75], v[104:107], v[44:47]
    ds_read_b64_tr_b16 v[68:69], v11 offset:16384
    ds_read_b64_tr_b16 v[70:71], v11 offset:17408
    v_mfma_f32_16x16x32_bf16 v[48:51], v[76:79], v[104:107], v[48:51]
    ds_read_b64_tr_b16 v[72:73], v12 offset:16384
    ds_read_b64_tr_b16 v[74:75], v12 offset:17408
    ds_read_b64_tr_b16 v[76:77], v13 offset:16384
    ds_read_b64_tr_b16 v[78:79], v13 offset:17408
    s_waitcnt vmcnt(12) lgkmcnt(8)
    v_mfma_f32_16x16x32_bf16 v[36:39], v[80:83], v[108:111], v[36:39]
    v_mfma_f32_16x16x32_bf16 v[40:43], v[84:87], v[108:111], v[40:43]
    ds_read_b64_tr_b16 v[80:81], v10 offset:20480
    ds_read_b64_tr_b16 v[82:83], v10 offset:21504
    v_mfma_f32_16x16x32_bf16 v[44:47], v[88:91], v[108:111], v[44:47]
    ds_read_b64_tr_b16 v[84:85], v11 offset:20480
    ds_read_b64_tr_b16 v[86:87], v11 offset:21504
    v_mfma_f32_16x16x32_bf16 v[48:51], v[92:95], v[108:111], v[48:51]
    ds_read_b64_tr_b16 v[88:89], v12 offset:20480
    ds_read_b64_tr_b16 v[90:91], v12 offset:21504
    ds_read_b64_tr_b16 v[92:93], v13 offset:20480
    ds_read_b64_tr_b16 v[94:95], v13 offset:21504
    s_waitcnt vmcnt(11) lgkmcnt(8)
    v_mfma_f32_16x16x32_bf16 v[36:39], v[64:67], v[112:115], v[36:39]
    v_mfma_f32_16x16x32_bf16 v[40:43], v[68:71], v[112:115], v[40:43]
    ds_read_b64_tr_b16 v[64:65], v10 offset:24576
    ds_read_b64_tr_b16 v[66:67], v10 offset:25600
    v_mfma_f32_16x16x32_bf16 v[44:47], v[72:75], v[112:115], v[44:47]
    ds_read_b64_tr_b16 v[68:69], v11 offset:24576
    ds_read_b64_tr_b16 v[70:71], v11 offset:25600
    v_mfma_f32_16x16x32_bf16 v[48:51], v[76:79], v[112:115], v[48:51]
    ds_read_b64_tr_b16 v[72:73], v12 offset:24576
    ds_read_b64_tr_b16 v[74:75], v12 offset:25600
    ds_read_b64_tr_b16 v[76:77], v13 offset:24576
    ds_read_b64_tr_b16 v[78:79], v13 offset:25600
    s_waitcnt vmcnt(10) lgkmcnt(8)
    v_mfma_f32_16x16x32_bf16 v[36:39], v[80:83], v[116:119], v[36:39]
    v_mfma_f32_16x16x32_bf16 v[40:43], v[84:87], v[116:119], v[40:43]
    ds_read_b64_tr_b16 v[80:81], v10 offset:28672
    ds_read_b64_tr_b16 v[82:83], v10 offset:29696
    v_mfma_f32_16x16x32_bf16 v[44:47], v[88:91], v[116:119], v[44:47]
    ds_read_b64_tr_b16 v[84:85], v11 offset:28672
    ds_read_b64_tr_b16 v[86:87], v11 offset:29696
    v_mfma_f32_16x16x32_bf16 v[48:51], v[92:95], v[116:119], v[48:51]
    ds_read_b64_tr_b16 v[88:89], v12 offset:28672
    ds_read_b64_tr_b16 v[90:91], v12 offset:29696
    ds_read_b64_tr_b16 v[92:93], v13 offset:28672
    ds_read_b64_tr_b16 v[94:95], v13 offset:29696
    s_waitcnt vmcnt(9) lgkmcnt(8)
    s_barrier
    v_add_u32 v10, 32768, v10
    v_add_u32 v11, 32768, v11
    v_add_u32 v12, 32768, v12
    v_add_u32 v13, 32768, v13
    v_mfma_f32_16x16x32_bf16 v[36:39], v[64:67], v[120:123], v[36:39]
    v_mfma_f32_16x16x32_bf16 v[40:43], v[68:71], v[120:123], v[40:43]
    ds_read_b64_tr_b16 v[64:65], v10 offset:0
    ds_read_b64_tr_b16 v[66:67], v10 offset:1024
    v_mfma_f32_16x16x32_bf16 v[44:47], v[72:75], v[120:123], v[44:47]
    ds_read_b64_tr_b16 v[68:69], v11 offset:0
    ds_read_b64_tr_b16 v[70:71], v11 offset:1024
    v_mfma_f32_16x16x32_bf16 v[48:51], v[76:79], v[120:123], v[48:51]
    ds_read_b64_tr_b16 v[72:73], v12 offset:0
    ds_read_b64_tr_b16 v[74:75], v12 offset:1024
    ds_read_b64_tr_b16 v[76:77], v13 offset:0
    ds_read_b64_tr_b16 v[78:79], v13 offset:1024
    s_waitcnt vmcnt(8) lgkmcnt(8)
    v_mfma_f32_16x16x32_bf16 v[36:39], v[80:83], v[124:127], v[36:39]
    v_mfma_f32_16x16x32_bf16 v[40:43], v[84:87], v[124:127], v[40:43]
    ds_read_b64_tr_b16 v[80:81], v10 offset:4096
    ds_read_b64_tr_b16 v[82:83], v10 offset:5120
    v_mfma_f32_16x16x32_bf16 v[44:47], v[88:91], v[124:127], v[44:47]
    ds_read_b64_tr_b16 v[84:85], v11 offset:4096
    ds_read_b64_tr_b16 v[86:87], v11 offset:5120
    v_mfma_f32_16x16x32_bf16 v[48:51], v[92:95], v[124:127], v[48:51]
    ds_read_b64_tr_b16 v[88:89], v12 offset:4096
    ds_read_b64_tr_b16 v[90:91], v12 offset:5120
    ds_read_b64_tr_b16 v[92:93], v13 offset:4096
    ds_read_b64_tr_b16 v[94:95], v13 offset:5120
    s_waitcnt vmcnt(7) lgkmcnt(8)
    v_mfma_f32_16x16x32_bf16 v[36:39], v[64:67], v[128:131], v[36:39]
    v_mfma_f32_16x16x32_bf16 v[40:43], v[68:71], v[128:131], v[40:43]
    ds_read_b64_tr_b16 v[64:65], v10 offset:8192
    ds_read_b64_tr_b16 v[66:67], v10 offset:9216
    v_mfma_f32_16x16x32_bf16 v[44:47], v[72:75], v[128:131], v[44:47]
    ds_read_b64_tr_b16 v[68:69], v11 offset:8192
    ds_read_b64_tr_b16 v[70:71], v11 offset:9216
    v_mfma_f32_16x16x32_bf16 v[48:51], v[76:79], v[128:131], v[48:51]
    ds_read_b64_tr_b16 v[72:73], v12 offset:8192
    ds_read_b64_tr_b16 v[74:75], v12 offset:9216
    ds_read_b64_tr_b16 v[76:77], v13 offset:8192
    ds_read_b64_tr_b16 v[78:79], v13 offset:9216
    s_waitcnt vmcnt(6) lgkmcnt(8)
    v_mfma_f32_16x16x32_bf16 v[36:39], v[80:83], v[132:135], v[36:39]
    v_mfma_f32_16x16x32_bf16 v[40:43], v[84:87], v[132:135], v[40:43]
    ds_read_b64_tr_b16 v[80:81], v10 offset:12288
    ds_read_b64_tr_b16 v[82:83], v10 offset:13312
    v_mfma_f32_16x16x32_bf16 v[44:47], v[88:91], v[132:135], v[44:47]
    ds_read_b64_tr_b16 v[84:85], v11 offset:12288
    ds_read_b64_tr_b16 v[86:87], v11 offset:13312
    v_mfma_f32_16x16x32_bf16 v[48:51], v[92:95], v[132:135], v[48:51]
    ds_read_b64_tr_b16 v[88:89], v12 offset:12288
    ds_read_b64_tr_b16 v[90:91], v12 offset:13312
    ds_read_b64_tr_b16 v[92:93], v13 offset:12288
    ds_read_b64_tr_b16 v[94:95], v13 offset:13312
    s_waitcnt vmcnt(5) lgkmcnt(8)
    s_barrier
    v_mfma_f32_16x16x32_bf16 v[36:39], v[64:67], v[136:139], v[36:39]
    v_mfma_f32_16x16x32_bf16 v[40:43], v[68:71], v[136:139], v[40:43]
    ds_read_b64_tr_b16 v[64:65], v10 offset:16384
    ds_read_b64_tr_b16 v[66:67], v10 offset:17408
    v_mfma_f32_16x16x32_bf16 v[44:47], v[72:75], v[136:139], v[44:47]
    ds_read_b64_tr_b16 v[68:69], v11 offset:16384
    ds_read_b64_tr_b16 v[70:71], v11 offset:17408
    v_mfma_f32_16x16x32_bf16 v[48:51], v[76:79], v[136:139], v[48:51]
    ds_read_b64_tr_b16 v[72:73], v12 offset:16384
    ds_read_b64_tr_b16 v[74:75], v12 offset:17408
    ds_read_b64_tr_b16 v[76:77], v13 offset:16384
    ds_read_b64_tr_b16 v[78:79], v13 offset:17408
    s_waitcnt vmcnt(4) lgkmcnt(8)
    v_mfma_f32_16x16x32_bf16 v[36:39], v[80:83], v[140:143], v[36:39]
    v_mfma_f32_16x16x32_bf16 v[40:43], v[84:87], v[140:143], v[40:43]
    ds_read_b64_tr_b16 v[80:81], v10 offset:20480
    ds_read_b64_tr_b16 v[82:83], v10 offset:21504
    v_mfma_f32_16x16x32_bf16 v[44:47], v[88:91], v[140:143], v[44:47]
    ds_read_b64_tr_b16 v[84:85], v11 offset:20480
    ds_read_b64_tr_b16 v[86:87], v11 offset:21504
    v_mfma_f32_16x16x32_bf16 v[48:51], v[92:95], v[140:143], v[48:51]
    ds_read_b64_tr_b16 v[88:89], v12 offset:20480
    ds_read_b64_tr_b16 v[90:91], v12 offset:21504
    ds_read_b64_tr_b16 v[92:93], v13 offset:20480
    ds_read_b64_tr_b16 v[94:95], v13 offset:21504
    s_waitcnt vmcnt(3) lgkmcnt(8)
    v_mfma_f32_16x16x32_bf16 v[36:39], v[64:67], v[144:147], v[36:39]
    v_mfma_f32_16x16x32_bf16 v[40:43], v[68:71], v[144:147], v[40:43]
    ds_read_b64_tr_b16 v[64:65], v10 offset:24576
    ds_read_b64_tr_b16 v[66:67], v10 offset:25600
    v_mfma_f32_16x16x32_bf16 v[44:47], v[72:75], v[144:147], v[44:47]
    ds_read_b64_tr_b16 v[68:69], v11 offset:24576
    ds_read_b64_tr_b16 v[70:71], v11 offset:25600
    v_mfma_f32_16x16x32_bf16 v[48:51], v[76:79], v[144:147], v[48:51]
    ds_read_b64_tr_b16 v[72:73], v12 offset:24576
    ds_read_b64_tr_b16 v[74:75], v12 offset:25600
    ds_read_b64_tr_b16 v[76:77], v13 offset:24576
    ds_read_b64_tr_b16 v[78:79], v13 offset:25600
    s_waitcnt vmcnt(2) lgkmcnt(8)
    v_mfma_f32_16x16x32_bf16 v[36:39], v[80:83], v[148:151], v[36:39]
    v_mfma_f32_16x16x32_bf16 v[40:43], v[84:87], v[148:151], v[40:43]
    ds_read_b64_tr_b16 v[80:81], v10 offset:28672
    ds_read_b64_tr_b16 v[82:83], v10 offset:29696
    v_mfma_f32_16x16x32_bf16 v[44:47], v[88:91], v[148:151], v[44:47]
    ds_read_b64_tr_b16 v[84:85], v11 offset:28672
    ds_read_b64_tr_b16 v[86:87], v11 offset:29696
    v_mfma_f32_16x16x32_bf16 v[48:51], v[92:95], v[148:151], v[48:51]
    ds_read_b64_tr_b16 v[88:89], v12 offset:28672
    ds_read_b64_tr_b16 v[90:91], v12 offset:29696
    ds_read_b64_tr_b16 v[92:93], v13 offset:28672
    ds_read_b64_tr_b16 v[94:95], v13 offset:29696
    s_waitcnt vmcnt(1) lgkmcnt(8)
    v_mfma_f32_16x16x32_bf16 v[36:39], v[64:67], v[152:155], v[36:39]
    v_mfma_f32_16x16x32_bf16 v[40:43], v[68:71], v[152:155], v[40:43]
    v_mfma_f32_16x16x32_bf16 v[44:47], v[72:75], v[152:155], v[44:47]
    v_mfma_f32_16x16x32_bf16 v[48:51], v[76:79], v[152:155], v[48:51]
    s_waitcnt vmcnt(0) lgkmcnt(0)
    v_mfma_f32_16x16x32_bf16 v[36:39], v[80:83], v[156:159], v[36:39]
    v_mfma_f32_16x16x32_bf16 v[40:43], v[84:87], v[156:159], v[40:43]
    v_mfma_f32_16x16x32_bf16 v[44:47], v[88:91], v[156:159], v[44:47]
    v_mfma_f32_16x16x32_bf16 v[48:51], v[92:95], v[156:159], v[48:51]
    v_mov_b32 v60, 0
    v_mov_b32 v61, 0
    v_mov_b32 v62, 0
    v_mov_b32 v63, 0
    s_nop 4
    v_cvt_pk_bf16_f32 v64, v36, v37
    v_cvt_pk_bf16_f32 v65, v38, v39
    v_cvt_pk_bf16_f32 v66, v40, v41
    v_cvt_pk_bf16_f32 v67, v42, v43
    v_lshlrev_b32 v36, 16, v64
    v_and_b32 v37, 0xffff0000, v64
    v_lshlrev_b32 v38, 16, v65
    v_and_b32 v39, 0xffff0000, v65
    v_lshlrev_b32 v40, 16, v66
    v_and_b32 v41, 0xffff0000, v66
    v_lshlrev_b32 v42, 16, v67
    v_and_b32 v43, 0xffff0000, v67
    v_lshlrev_b32 v68, 16, v20
    v_and_b32 v69, 0xffff0000, v20
    v_lshlrev_b32 v70, 16, v21
    v_and_b32 v71, 0xffff0000, v21
    v_lshlrev_b32 v72, 16, v22
    v_and_b32 v73, 0xffff0000, v22
    v_lshlrev_b32 v74, 16, v23
    v_and_b32 v75, 0xffff0000, v23
    v_pk_add_f32 v[68:69], v[68:69], v[28:29] op_sel_hi:[1,0] neg_lo:[0,1] neg_hi:[0,1]
    v_pk_add_f32 v[70:71], v[70:71], v[28:29] op_sel_hi:[1,0] neg_lo:[0,1] neg_hi:[0,1]
    v_pk_add_f32 v[72:73], v[72:73], v[28:29] op_sel_hi:[1,0] neg_lo:[0,1] neg_hi:[0,1]
    v_pk_add_f32 v[74:75], v[74:75], v[28:29] op_sel_hi:[1,0] neg_lo:[0,1] neg_hi:[0,1]
    v_cvt_pk_bf16_f32 v64, v68, v69
    v_cvt_pk_bf16_f32 v65, v70, v71
    v_cvt_pk_bf16_f32 v66, v72, v73
    v_cvt_pk_bf16_f32 v67, v74, v75
    v_lshlrev_b32 v68, 16, v64
    v_and_b32 v69, 0xffff0000, v64
    v_lshlrev_b32 v70, 16, v65
    v_and_b32 v71, 0xffff0000, v65
    v_lshlrev_b32 v72, 16, v66
    v_and_b32 v73, 0xffff0000, v66
    v_lshlrev_b32 v74, 16, v67
    v_and_b32 v75, 0xffff0000, v67
    v_pk_mul_f32 v[68:69], v[68:69], v[28:29] op_sel:[0,1] op_sel_hi:[1,1]
    v_pk_mul_f32 v[70:71], v[70:71], v[28:29] op_sel:[0,1] op_sel_hi:[1,1]
    v_pk_mul_f32 v[72:73], v[72:73], v[28:29] op_sel:[0,1] op_sel_hi:[1,1]
    v_pk_mul_f32 v[74:75], v[74:75], v[28:29] op_sel:[0,1] op_sel_hi:[1,1]
    v_cvt_pk_bf16_f32 v64, v68, v69
    v_cvt_pk_bf16_f32 v65, v70, v71
    v_cvt_pk_bf16_f32 v66, v72, v73
    v_cvt_pk_bf16_f32 v67, v74, v75
    v_lshlrev_b32 v68, 16, v64
    v_and_b32 v69, 0xffff0000, v64
    v_lshlrev_b32 v70, 16, v65
    v_and_b32 v71, 0xffff0000, v65
    v_lshlrev_b32 v72, 16, v66
    v_and_b32 v73, 0xffff0000, v66
    v_lshlrev_b32 v74, 16, v67
    v_and_b32 v75, 0xffff0000, v67
    v_pk_add_f32 v[36:37], v[36:37], v[68:69]
    v_pk_add_f32 v[38:39], v[38:39], v[70:71]
    v_pk_add_f32 v[40:41], v[40:41], v[72:73]
    v_pk_add_f32 v[42:43], v[42:43], v[74:75]
    v_cvt_pk_bf16_f32 v168, v36, v37
    v_cvt_pk_bf16_f32 v169, v38, v39
    v_cvt_pk_bf16_f32 v170, v40, v41
    v_cvt_pk_bf16_f32 v171, v42, v43
    v_lshlrev_b32 v36, 16, v168
    v_and_b32 v37, 0xffff0000, v168
    v_lshlrev_b32 v38, 16, v169
    v_and_b32 v39, 0xffff0000, v169
    v_lshlrev_b32 v40, 16, v170
    v_and_b32 v41, 0xffff0000, v170
    v_lshlrev_b32 v42, 16, v171
    v_and_b32 v43, 0xffff0000, v171
    v_pk_add_f32 v[60:61], v[60:61], v[36:37]
    v_pk_fma_f32 v[62:63], v[36:37], v[36:37], v[62:63]
    v_pk_add_f32 v[60:61], v[60:61], v[38:39]
    v_pk_fma_f32 v[62:63], v[38:39], v[38:39], v[62:63]
    v_pk_add_f32 v[60:61], v[60:61], v[40:41]
    v_pk_fma_f32 v[62:63], v[40:41], v[40:41], v[62:63]
    v_pk_add_f32 v[60:61], v[60:61], v[42:43]
    v_pk_fma_f32 v[62:63], v[42:43], v[42:43], v[62:63]
    v_cvt_pk_bf16_f32 v64, v44, v45
    v_cvt_pk_bf16_f32 v65, v46, v47
    v_cvt_pk_bf16_f32 v66, v48, v49
    v_cvt_pk_bf16_f32 v67, v50, v51
    v_lshlrev_b32 v44, 16, v64
    v_and_b32 v45, 0xffff0000, v64
    v_lshlrev_b32 v46, 16, v65
    v_and_b32 v47, 0xffff0000, v65
    v_lshlrev_b32 v48, 16, v66
    v_and_b32 v49, 0xffff0000, v66
    v_lshlrev_b32 v50, 16, v67
    v_and_b32 v51, 0xffff0000, v67
    v_lshlrev_b32 v68, 16, v24
    v_and_b32 v69, 0xffff0000, v24
    v_lshlrev_b32 v70, 16, v25
    v_and_b32 v71, 0xffff0000, v25
    v_lshlrev_b32 v72, 16, v26
    v_and_b32 v73, 0xffff0000, v26
    v_lshlrev_b32 v74, 16, v27
    v_and_b32 v75, 0xffff0000, v27
    v_pk_add_f32 v[68:69], v[68:69], v[28:29] op_sel_hi:[1,0] neg_lo:[0,1] neg_hi:[0,1]
    v_pk_add_f32 v[70:71], v[70:71], v[28:29] op_sel_hi:[1,0] neg_lo:[0,1] neg_hi:[0,1]
    v_pk_add_f32 v[72:73], v[72:73], v[28:29] op_sel_hi:[1,0] neg_lo:[0,1] neg_hi:[0,1]
    v_pk_add_f32 v[74:75], v[74:75], v[28:29] op_sel_hi:[1,0] neg_lo:[0,1] neg_hi:[0,1]
    v_cvt_pk_bf16_f32 v64, v68, v69
    v_cvt_pk_bf16_f32 v65, v70, v71
    v_cvt_pk_bf16_f32 v66, v72, v73
    v_cvt_pk_bf16_f32 v67, v74, v75
    v_lshlrev_b32 v68, 16, v64
    v_and_b32 v69, 0xffff0000, v64
    v_lshlrev_b32 v70, 16, v65
    v_and_b32 v71, 0xffff0000, v65
    v_lshlrev_b32 v72, 16, v66
    v_and_b32 v73, 0xffff0000, v66
    v_lshlrev_b32 v74, 16, v67
    v_and_b32 v75, 0xffff0000, v67
    v_pk_mul_f32 v[68:69], v[68:69], v[28:29] op_sel:[0,1] op_sel_hi:[1,1]
    v_pk_mul_f32 v[70:71], v[70:71], v[28:29] op_sel:[0,1] op_sel_hi:[1,1]
    v_pk_mul_f32 v[72:73], v[72:73], v[28:29] op_sel:[0,1] op_sel_hi:[1,1]
    v_pk_mul_f32 v[74:75], v[74:75], v[28:29] op_sel:[0,1] op_sel_hi:[1,1]
    v_cvt_pk_bf16_f32 v64, v68, v69
    v_cvt_pk_bf16_f32 v65, v70, v71
    v_cvt_pk_bf16_f32 v66, v72, v73
    v_cvt_pk_bf16_f32 v67, v74, v75
    v_lshlrev_b32 v68, 16, v64
    v_and_b32 v69, 0xffff0000, v64
    v_lshlrev_b32 v70, 16, v65
    v_and_b32 v71, 0xffff0000, v65
    v_lshlrev_b32 v72, 16, v66
    v_and_b32 v73, 0xffff0000, v66
    v_lshlrev_b32 v74, 16, v67
    v_and_b32 v75, 0xffff0000, v67
    v_pk_add_f32 v[44:45], v[44:45], v[68:69]
    v_pk_add_f32 v[46:47], v[46:47], v[70:71]
    v_pk_add_f32 v[48:49], v[48:49], v[72:73]
    v_pk_add_f32 v[50:51], v[50:51], v[74:75]
    v_cvt_pk_bf16_f32 v172, v44, v45
    v_cvt_pk_bf16_f32 v173, v46, v47
    v_cvt_pk_bf16_f32 v174, v48, v49
    v_cvt_pk_bf16_f32 v175, v50, v51
    v_lshlrev_b32 v44, 16, v172
    v_and_b32 v45, 0xffff0000, v172
    v_lshlrev_b32 v46, 16, v173
    v_and_b32 v47, 0xffff0000, v173
    v_lshlrev_b32 v48, 16, v174
    v_and_b32 v49, 0xffff0000, v174
    v_lshlrev_b32 v50, 16, v175
    v_and_b32 v51, 0xffff0000, v175
    v_pk_add_f32 v[60:61], v[60:61], v[44:45]
    v_pk_fma_f32 v[62:63], v[44:45], v[44:45], v[62:63]
    v_pk_add_f32 v[60:61], v[60:61], v[46:47]
    v_pk_fma_f32 v[62:63], v[46:47], v[46:47], v[62:63]
    v_pk_add_f32 v[60:61], v[60:61], v[48:49]
    v_pk_fma_f32 v[62:63], v[48:49], v[48:49], v[62:63]
    v_pk_add_f32 v[60:61], v[60:61], v[50:51]
    v_pk_fma_f32 v[62:63], v[50:51], v[50:51], v[62:63]
    v_add_f32 v60, v60, v61
    v_add_f32 v61, v62, v63
    v_and_b32 v7, 1, v15
    v_lshrrev_b32 v8, 1, v15
    v_lshl_add_u32 v7, v7, 1, v8
    v_and_b32 v8, 15, v2
    v_lshl_add_u32 v7, v7, 4, v8
    s_lshl_b32 s21, s16, 11
    s_add_u32 s21, s21, s38
    v_lshl_add_u32 v7, v7, 4, s21

    v_mov_b32 v62, v60
    v_mov_b32 v63, v61
    v_permlane16_swap_b32 v168, v170
    v_permlane16_swap_b32 v169, v171
    v_permlane16_swap_b32 v172, v174
    v_permlane16_swap_b32 v173, v175
    v_permlane16_swap_b32 v60, v62
    v_permlane16_swap_b32 v61, v63
    global_store_dwordx4 v7, v[168:171], s[26:27] offset:0
    global_store_dwordx4 v7, v[172:175], s[26:27] offset:1024
    v_pk_add_f32 v[60:61], v[60:61], v[62:63]
    s_nop 0
    v_mov_b32 v62, v60
    v_mov_b32 v63, v61
    s_nop 1
    v_permlane32_swap_b32 v60, v62
    v_permlane32_swap_b32 v61, v63
    s_nop 1
    v_pk_add_f32 v[60:61], v[60:61], v[62:63]
    s_lshl_b32 s21, s16, 3
    v_add_u32 v19, s21, v19
    v_cmp_gt_u32 vcc, 16, v2
    s_and_saveexec_b64 s[32:33], vcc
    global_store_dwordx2 v19, v[60:61], s[28:29]
    s_mov_b64 exec, s[32:33]

    s_endpgm
K4_loader:
    s_waitcnt lgkmcnt(0)
    s_mov_b32 s12, s6
    s_mov_b32 s13, s7
    s_mov_b32 s14, 524288
    s_mov_b32 s15, 0x00020000
    v_lshrrev_b32 v3, 5, v2
    v_lshlrev_b32 v3, 3, v3
    v_bfe_u32 v4, v2, 3, 2
    v_add_u32 v3, v3, v4
    v_mul_u32_u24 v12, 1024, v3
    v_bfe_u32 v3, v2, 1, 2
    v_bfe_u32 v4, v2, 4, 2
    v_xor_b32 v3, v3, v4
    v_lshl_add_u32 v12, v3, 5, v12
    v_and_b32 v3, 1, v2
    v_lshl_add_u32 v12, v3, 4, v12
    s_add_u32 s35, s20, 0
    s_lshl_b32 s22, s3, 10
    s_mov_b32 m0, s22
    s_add_u32 s22, s22, 4096
    buffer_load_dwordx4 v12, s[12:15], s35 offen lds
    s_add_u32 s35, s35, 32768
    s_mov_b32 m0, s22
    s_add_u32 s22, s22, 4096
    buffer_load_dwordx4 v12, s[12:15], s35 offen lds
    s_add_u32 s35, s35, 32768
    s_mov_b32 m0, s22
    s_add_u32 s22, s22, 4096
    buffer_load_dwordx4 v12, s[12:15], s35 offen lds
    s_add_u32 s35, s35, 32768
    s_mov_b32 m0, s22
    s_add_u32 s22, s22, 4096
    buffer_load_dwordx4 v12, s[12:15], s35 offen lds
    s_add_u32 s35, s20, 131072
    s_lshl_b32 s22, s3, 10
    s_add_u32 s22, s22, 16384
    s_mov_b32 m0, s22
    s_add_u32 s22, s22, 4096
    buffer_load_dwordx4 v12, s[12:15], s35 offen lds
    s_add_u32 s35, s35, 32768
    s_mov_b32 m0, s22
    s_add_u32 s22, s22, 4096
    buffer_load_dwordx4 v12, s[12:15], s35 offen lds
    s_add_u32 s35, s35, 32768
    s_mov_b32 m0, s22
    s_add_u32 s22, s22, 4096
    buffer_load_dwordx4 v12, s[12:15], s35 offen lds
    s_add_u32 s35, s35, 32768
    s_mov_b32 m0, s22
    s_add_u32 s22, s22, 4096
    buffer_load_dwordx4 v12, s[12:15], s35 offen lds
    s_waitcnt vmcnt(4)
    s_barrier
    s_add_u32 s35, s20, 262144
    s_lshl_b32 s22, s3, 10
    s_add_u32 s22, s22, 32768
    s_mov_b32 m0, s22
    s_add_u32 s22, s22, 4096
    buffer_load_dwordx4 v12, s[12:15], s35 offen lds
    s_add_u32 s35, s35, 32768
    s_mov_b32 m0, s22
    s_add_u32 s22, s22, 4096
    buffer_load_dwordx4 v12, s[12:15], s35 offen lds
    s_add_u32 s35, s35, 32768
    s_mov_b32 m0, s22
    s_add_u32 s22, s22, 4096
    buffer_load_dwordx4 v12, s[12:15], s35 offen lds
    s_add_u32 s35, s35, 32768
    s_mov_b32 m0, s22
    s_add_u32 s22, s22, 4096
    buffer_load_dwordx4 v12, s[12:15], s35 offen lds
    s_waitcnt vmcnt(4)
    s_barrier
    s_add_u32 s35, s20, 393216
    s_lshl_b32 s22, s3, 10
    s_add_u32 s22, s22, 49152
    s_mov_b32 m0, s22
    s_add_u32 s22, s22, 4096
    buffer_load_dwordx4 v12, s[12:15], s35 offen lds
    s_add_u32 s35, s35, 32768
    s_mov_b32 m0, s22
    s_add_u32 s22, s22, 4096
    buffer_load_dwordx4 v12, s[12:15], s35 offen lds
    s_add_u32 s35, s35, 32768
    s_mov_b32 m0, s22
    s_add_u32 s22, s22, 4096
    buffer_load_dwordx4 v12, s[12:15], s35 offen lds
    s_add_u32 s35, s35, 32768
    s_mov_b32 m0, s22
    s_add_u32 s22, s22, 4096
    buffer_load_dwordx4 v12, s[12:15], s35 offen lds
    s_waitcnt vmcnt(4)
    s_barrier
    s_waitcnt vmcnt(0)
    s_barrier
    s_getpc_b64 s[40:41]
CPF_11:
    s_add_u32 s40, s40, k56_kernel-CPF_11
    s_addc_u32 s41, s41, 0
    s_bfe_u32 s42, s2, 0x50003
    s_lshl_b32 s42, s42, 10
    v_and_b32 v30, 63, v0
    v_lshl_add_u32 v30, v30, 4, s42
    v_min_u32 v30, K_code_end-k56_kernel-16, v30
    global_load_dwordx4 v[32:35], v30, s[40:41]
K4_exit:
    s_endpgm
.text
.globl k56_kernel
.p2align 8
.type k56_kernel,@function
k56_kernel:
    s_cmp_ge_u32 s2, 256
    s_cbranch_scc1 K56_exit
    s_load_dwordx2 s[4:5], s[0:1], 128
    s_load_dwordx2 s[6:7], s[0:1], 104
    s_load_dwordx2 s[52:53], s[0:1], 112

    v_lshrrev_b32 v1, 6, v0
    v_and_b32 v2, 63, v0
    v_readfirstlane_b32 s44, v1
    s_and_b32 s3, s44, 3
    s_bfe_u32 s16, s2, 0x40003
    s_and_b32 s17, s2, 7
    s_lshl_b32 s17, s17, 1
    s_lshr_b32 s19, s2, 7
    s_add_u32 s17, s17, s19

    s_lshl_b32 s39, s17, 7
    s_lshl_b32 s23, s3, 5
    s_add_u32 s39, s39, s23
    s_lshl_b32 s38, s39, 10
    s_mul_i32 s20, s3, 7168
    s_mul_i32 s37, s16, 114688
    s_add_u32 s20, s20, s37
    s_lshl_b32 s45, s17, 7
    s_cmp_ge_u32 s44, 4
    s_cbranch_scc1 K56_loader
    v_and_b32 v14, 15, v2
    v_lshrrev_b32 v15, 4, v2
    v_add_u32 v14, s39, v14
    v_lshlrev_b32 v13, 6, v14
    s_mul_i32 s21, s16, 448
    v_lshl_add_u32 v8, v15, 4, s21
    v_lshl_add_u32 v11, v2, 4, s38
    v_add_u32 v12, 0x4000, v11
    s_waitcnt lgkmcnt(0)

    s_add_u32 s8, s4, 0x1000000
    s_addc_u32 s9, s5, 0
    s_add_u32 s24, s4, 0x1a20000
    s_addc_u32 s25, s5, 0
    s_add_u32 s26, s4, 0x1200000
    s_addc_u32 s27, s5, 0
    s_add_u32 s28, s4, 0x1a00800
    s_addc_u32 s29, s5, 0
    s_add_u32 s46, s4, 0x1b00000
    s_addc_u32 s47, s5, 0
    global_load_dwordx4 v[144:147], v13, s[24:25] offset:0
    global_load_dwordx4 v[148:151], v13, s[24:25] offset:16
    global_load_dwordx4 v[152:155], v13, s[24:25] offset:32
    global_load_dwordx4 v[156:159], v13, s[24:25] offset:48
    global_load_dwordx4 v[160:163], v13, s[24:25] offset:1024
    global_load_dwordx4 v[164:167], v13, s[24:25] offset:1040
    global_load_dwordx4 v[168:171], v13, s[24:25] offset:1056
    global_load_dwordx4 v[172:175], v13, s[24:25] offset:1072
    global_load_dwordx4 v[204:207], v8, s[28:29] offset:0
    global_load_dwordx4 v[208:211], v8, s[28:29] offset:64
    global_load_dwordx4 v[212:215], v8, s[28:29] offset:128
    global_load_dwordx4 v[216:219], v8, s[28:29] offset:192
    global_load_dwordx4 v[220:223], v8, s[28:29] offset:256
    global_load_dwordx4 v[224:227], v8, s[28:29] offset:320
    global_load_dwordx4 v[228:231], v8, s[28:29] offset:384
    global_load_dwordx4 v[72:75], v11, s[8:9] offset:0
    global_load_dwordx4 v[76:79], v12, s[8:9] offset:0
    global_load_dwordx4 v[80:83], v11, s[8:9] offset:1024
    global_load_dwordx4 v[84:87], v12, s[8:9] offset:1024
    global_load_dwordx4 v[88:91], v11, s[8:9] offset:2048
    global_load_dwordx4 v[92:95], v12, s[8:9] offset:2048
    global_load_dwordx4 v[96:99], v11, s[8:9] offset:3072
    global_load_dwordx4 v[100:103], v12, s[8:9] offset:3072
    s_add_u32 s8, s8, 4096
    s_addc_u32 s9, s9, 0
    global_load_dwordx4 v[104:107], v11, s[8:9] offset:0
    global_load_dwordx4 v[108:111], v12, s[8:9] offset:0
    global_load_dwordx4 v[112:115], v11, s[8:9] offset:1024
    global_load_dwordx4 v[116:119], v12, s[8:9] offset:1024
    global_load_dwordx4 v[120:123], v11, s[8:9] offset:2048
    global_load_dwordx4 v[124:127], v12, s[8:9] offset:2048
    global_load_dwordx4 v[128:131], v11, s[8:9] offset:3072
    global_load_dwordx4 v[132:135], v12, s[8:9] offset:3072
    v_lshrrev_b32 v3, 5, v2
    v_lshlrev_b32 v3, 4, v3
    v_bfe_u32 v4, v2, 2, 3
    v_add_u32 v3, v3, v4
    v_mul_u32_u24 v3, 224, v3
    v_and_b32 v4, 3, v2
    v_lshl_add_u32 v10, v4, 3, v3
    s_waitcnt vmcnt(23)
    v_pk_add_f32 v[144:145], v[144:145], v[152:153]
    v_pk_add_f32 v[146:147], v[146:147], v[154:155]
    v_pk_add_f32 v[148:149], v[148:149], v[156:157]
    v_pk_add_f32 v[150:151], v[150:151], v[158:159]
    v_pk_add_f32 v[144:145], v[144:145], v[148:149]
    v_pk_add_f32 v[146:147], v[146:147], v[150:151]
    v_pk_add_f32 v[144:145], v[144:145], v[146:147]
    v_mul_f32 v144, 0x3b000000, v144
    v_mul_f32 v145, 0x3b000000, v145
    v_fma_f32 v145, -v144, v144, v145
    v_max_f32 v145, 0, v145
    v_cvt_pk_bf16_f32 v3, v144, v145
    v_lshlrev_b32 v144, 16, v3
    v_and_b32 v145, 0xffff0000, v3
    v_add_f32 v145, 0x3727c5ac, v145
    v_cvt_pk_bf16_f32 v3, v145, v145
    v_lshlrev_b32 v145, 16, v3
    v_sqrt_f32 v145, v145
    s_nop 0
    v_cvt_pk_bf16_f32 v3, v145, v145
    v_lshlrev_b32 v145, 16, v3
    v_rcp_f32 v145, v145
    s_nop 0
    v_mov_b32 v4, v145
    v_mul_f32 v5, v144, v145
    v_pk_add_f32 v[160:161], v[160:161], v[168:169]
    v_pk_add_f32 v[162:163], v[162:163], v[170:171]
    v_pk_add_f32 v[164:165], v[164:165], v[172:173]
    v_pk_add_f32 v[166:167], v[166:167], v[174:175]
    v_pk_add_f32 v[160:161], v[160:161], v[164:165]
    v_pk_add_f32 v[162:163], v[162:163], v[166:167]
    v_pk_add_f32 v[160:161], v[160:161], v[162:163]
    v_mul_f32 v160, 0x3b000000, v160
    v_mul_f32 v161, 0x3b000000, v161
    v_fma_f32 v161, -v160, v160, v161
    v_max_f32 v161, 0, v161
    v_cvt_pk_bf16_f32 v3, v160, v161
    v_lshlrev_b32 v160, 16, v3
    v_and_b32 v161, 0xffff0000, v3
    v_add_f32 v161, 0x3727c5ac, v161
    v_cvt_pk_bf16_f32 v3, v161, v161
    v_lshlrev_b32 v161, 16, v3
    v_sqrt_f32 v161, v161
    s_nop 0
    v_cvt_pk_bf16_f32 v3, v161, v161
    v_lshlrev_b32 v161, 16, v3
    v_rcp_f32 v161, v161
    s_nop 0
    v_mov_b32 v6, v161
    v_mul_f32 v7, v160, v161
    v_mov_b32 v144, 0
    v_mov_b32 v145, 0
    v_mov_b32 v146, 0
    v_mov_b32 v147, 0
    v_mov_b32 v148, 0
    v_mov_b32 v149, 0
    v_mov_b32 v150, 0
    v_mov_b32 v151, 0
    v_mov_b32 v152, 0
    v_mov_b32 v153, 0
    v_mov_b32 v154, 0
    v_mov_b32 v155, 0
    v_mov_b32 v156, 0
    v_mov_b32 v157, 0
    v_mov_b32 v158, 0
    v_mov_b32 v159, 0
    v_mov_b32 v160, 0
    v_mov_b32 v161, 0
    v_mov_b32 v162, 0
    v_mov_b32 v163, 0
    v_mov_b32 v164, 0
    v_mov_b32 v165, 0
    v_mov_b32 v166, 0
    v_mov_b32 v167, 0
    v_mov_b32 v168, 0
    v_mov_b32 v169, 0
    v_mov_b32 v170, 0
    v_mov_b32 v171, 0
    v_mov_b32 v172, 0
    v_mov_b32 v173, 0
    v_mov_b32 v174, 0
    v_mov_b32 v175, 0
    v_mov_b32 v176, 0
    v_mov_b32 v177, 0
    v_mov_b32 v178, 0
    v_mov_b32 v179, 0
    v_mov_b32 v180, 0
    v_mov_b32 v181, 0
    v_mov_b32 v182, 0
    v_mov_b32 v183, 0
    v_mov_b32 v184, 0
    v_mov_b32 v185, 0
    v_mov_b32 v186, 0
    v_mov_b32 v187, 0
    v_mov_b32 v188, 0
    v_mov_b32 v189, 0
    v_mov_b32 v190, 0
    v_mov_b32 v191, 0
    v_mov_b32 v192, 0
    v_mov_b32 v193, 0
    v_mov_b32 v194, 0
    v_mov_b32 v195, 0
    v_mov_b32 v196, 0
    v_mov_b32 v197, 0
    v_mov_b32 v198, 0
    v_mov_b32 v199, 0
    s_barrier
    ds_read_b64_tr_b16 v[16:17], v10 offset:0
    ds_read_b64_tr_b16 v[18:19], v10 offset:1792
    ds_read_b64_tr_b16 v[20:21], v10 offset:32
    ds_read_b64_tr_b16 v[22:23], v10 offset:1824
    ds_read_b64_tr_b16 v[24:25], v10 offset:64
    ds_read_b64_tr_b16 v[26:27], v10 offset:1856
    ds_read_b64_tr_b16 v[28:29], v10 offset:96
    ds_read_b64_tr_b16 v[30:31], v10 offset:1888
    ds_read_b64_tr_b16 v[32:33], v10 offset:128
    ds_read_b64_tr_b16 v[34:35], v10 offset:1920
    ds_read_b64_tr_b16 v[36:37], v10 offset:160
    ds_read_b64_tr_b16 v[38:39], v10 offset:1952
    ds_read_b64_tr_b16 v[40:41], v10 offset:192
    ds_read_b64_tr_b16 v[42:43], v10 offset:1984
    ds_read_b64_tr_b16 v[44:45], v10 offset:7168
    ds_read_b64_tr_b16 v[46:47], v10 offset:8960
    ds_read_b64_tr_b16 v[48:49], v10 offset:7200
    ds_read_b64_tr_b16 v[50:51], v10 offset:8992
    ds_read_b64_tr_b16 v[52:53], v10 offset:7232
    ds_read_b64_tr_b16 v[54:55], v10 offset:9024
    ds_read_b64_tr_b16 v[56:57], v10 offset:7264
    ds_read_b64_tr_b16 v[58:59], v10 offset:9056
    ds_read_b64_tr_b16 v[60:61], v10 offset:7296
    ds_read_b64_tr_b16 v[62:63], v10 offset:9088
    ds_read_b64_tr_b16 v[64:65], v10 offset:7328
    ds_read_b64_tr_b16 v[66:67], v10 offset:9120
    ds_read_b64_tr_b16 v[68:69], v10 offset:7360
    ds_read_b64_tr_b16 v[70:71], v10 offset:9152
    s_waitcnt vmcnt(14) lgkmcnt(14)
    v_mfma_f32_16x16x32_bf16 v[144:147], v[16:19], v[72:75], v[144:147]
    v_mfma_f32_16x16x32_bf16 v[172:175], v[16:19], v[76:79], v[172:175]
    v_mfma_f32_16x16x32_bf16 v[148:151], v[20:23], v[72:75], v[148:151]
    v_mfma_f32_16x16x32_bf16 v[176:179], v[20:23], v[76:79], v[176:179]
    ds_read_b64_tr_b16 v[16:17], v10 offset:14336
    ds_read_b64_tr_b16 v[18:19], v10 offset:16128
    v_mfma_f32_16x16x32_bf16 v[152:155], v[24:27], v[72:75], v[152:155]
    v_mfma_f32_16x16x32_bf16 v[180:183], v[24:27], v[76:79], v[180:183]
    ds_read_b64_tr_b16 v[20:21], v10 offset:14368
    ds_read_b64_tr_b16 v[22:23], v10 offset:16160
    v_mfma_f32_16x16x32_bf16 v[156:159], v[28:31], v[72:75], v[156:159]
    v_mfma_f32_16x16x32_bf16 v[184:187], v[28:31], v[76:79], v[184:187]
    ds_read_b64_tr_b16 v[24:25], v10 offset:14400
    ds_read_b64_tr_b16 v[26:27], v10 offset:16192
    v_mfma_f32_16x16x32_bf16 v[160:163], v[32:35], v[72:75], v[160:163]
    v_mfma_f32_16x16x32_bf16 v[188:191], v[32:35], v[76:79], v[188:191]
    ds_read_b64_tr_b16 v[28:29], v10 offset:14432
    ds_read_b64_tr_b16 v[30:31], v10 offset:16224
    v_mfma_f32_16x16x32_bf16 v[164:167], v[36:39], v[72:75], v[164:167]
    v_mfma_f32_16x16x32_bf16 v[192:195], v[36:39], v[76:79], v[192:195]
    ds_read_b64_tr_b16 v[32:33], v10 offset:14464
    ds_read_b64_tr_b16 v[34:35], v10 offset:16256
    v_mfma_f32_16x16x32_bf16 v[168:171], v[40:43], v[72:75], v[168:171]
    v_mfma_f32_16x16x32_bf16 v[196:199], v[40:43], v[76:79], v[196:199]
    ds_read_b64_tr_b16 v[36:37], v10 offset:14496
    ds_read_b64_tr_b16 v[38:39], v10 offset:16288
    ds_read_b64_tr_b16 v[40:41], v10 offset:14528
    ds_read_b64_tr_b16 v[42:43], v10 offset:16320
    s_add_u32 s8, s8, 4096
    s_addc_u32 s9, s9, 0
    global_load_dwordx4 v[72:75], v11, s[8:9] offset:0
    global_load_dwordx4 v[76:79], v12, s[8:9] offset:0
    s_waitcnt vmcnt(14) lgkmcnt(14)
    v_mfma_f32_16x16x32_bf16 v[144:147], v[44:47], v[80:83], v[144:147]
    v_mfma_f32_16x16x32_bf16 v[172:175], v[44:47], v[84:87], v[172:175]
    v_mfma_f32_16x16x32_bf16 v[148:151], v[48:51], v[80:83], v[148:151]
    v_mfma_f32_16x16x32_bf16 v[176:179], v[48:51], v[84:87], v[176:179]
    ds_read_b64_tr_b16 v[44:45], v10 offset:21504
    ds_read_b64_tr_b16 v[46:47], v10 offset:23296
    v_mfma_f32_16x16x32_bf16 v[152:155], v[52:55], v[80:83], v[152:155]
    v_mfma_f32_16x16x32_bf16 v[180:183], v[52:55], v[84:87], v[180:183]
    ds_read_b64_tr_b16 v[48:49], v10 offset:21536
    ds_read_b64_tr_b16 v[50:51], v10 offset:23328
    v_mfma_f32_16x16x32_bf16 v[156:159], v[56:59], v[80:83], v[156:159]
    v_mfma_f32_16x16x32_bf16 v[184:187], v[56:59], v[84:87], v[184:187]
    ds_read_b64_tr_b16 v[52:53], v10 offset:21568
    ds_read_b64_tr_b16 v[54:55], v10 offset:23360
    v_mfma_f32_16x16x32_bf16 v[160:163], v[60:63], v[80:83], v[160:163]
    v_mfma_f32_16x16x32_bf16 v[188:191], v[60:63], v[84:87], v[188:191]
    ds_read_b64_tr_b16 v[56:57], v10 offset:21600
    ds_read_b64_tr_b16 v[58:59], v10 offset:23392
    v_mfma_f32_16x16x32_bf16 v[164:167], v[64:67], v[80:83], v[164:167]
    v_mfma_f32_16x16x32_bf16 v[192:195], v[64:67], v[84:87], v[192:195]
    ds_read_b64_tr_b16 v[60:61], v10 offset:21632
    ds_read_b64_tr_b16 v[62:63], v10 offset:23424
    v_mfma_f32_16x16x32_bf16 v[168:171], v[68:71], v[80:83], v[168:171]
    v_mfma_f32_16x16x32_bf16 v[196:199], v[68:71], v[84:87], v[196:199]
    ds_read_b64_tr_b16 v[64:65], v10 offset:21664
    ds_read_b64_tr_b16 v[66:67], v10 offset:23456
    ds_read_b64_tr_b16 v[68:69], v10 offset:21696
    ds_read_b64_tr_b16 v[70:71], v10 offset:23488
    global_load_dwordx4 v[80:83], v11, s[8:9] offset:1024
    global_load_dwordx4 v[84:87], v12, s[8:9] offset:1024
    s_waitcnt vmcnt(14) lgkmcnt(14)
    s_barrier
    v_mfma_f32_16x16x32_bf16 v[144:147], v[16:19], v[88:91], v[144:147]
    v_mfma_f32_16x16x32_bf16 v[172:175], v[16:19], v[92:95], v[172:175]
    v_mfma_f32_16x16x32_bf16 v[148:151], v[20:23], v[88:91], v[148:151]
    v_mfma_f32_16x16x32_bf16 v[176:179], v[20:23], v[92:95], v[176:179]
    ds_read_b64_tr_b16 v[16:17], v10 offset:28672
    ds_read_b64_tr_b16 v[18:19], v10 offset:30464
    v_mfma_f32_16x16x32_bf16 v[152:155], v[24:27], v[88:91], v[152:155]
    v_mfma_f32_16x16x32_bf16 v[180:183], v[24:27], v[92:95], v[180:183]
    ds_read_b64_tr_b16 v[20:21], v10 offset:28704
    ds_read_b64_tr_b16 v[22:23], v10 offset:30496
    v_mfma_f32_16x16x32_bf16 v[156:159], v[28:31], v[88:91], v[156:159]
    v_mfma_f32_16x16x32_bf16 v[184:187], v[28:31], v[92:95], v[184:187]
    ds_read_b64_tr_b16 v[24:25], v10 offset:28736
    ds_read_b64_tr_b16 v[26:27], v10 offset:30528
    v_mfma_f32_16x16x32_bf16 v[160:163], v[32:35], v[88:91], v[160:163]
    v_mfma_f32_16x16x32_bf16 v[188:191], v[32:35], v[92:95], v[188:191]
    ds_read_b64_tr_b16 v[28:29], v10 offset:28768
    ds_read_b64_tr_b16 v[30:31], v10 offset:30560
    v_mfma_f32_16x16x32_bf16 v[164:167], v[36:39], v[88:91], v[164:167]
    v_mfma_f32_16x16x32_bf16 v[192:195], v[36:39], v[92:95], v[192:195]
    ds_read_b64_tr_b16 v[32:33], v10 offset:28800
    ds_read_b64_tr_b16 v[34:35], v10 offset:30592
    v_mfma_f32_16x16x32_bf16 v[168:171], v[40:43], v[88:91], v[168:171]
    v_mfma_f32_16x16x32_bf16 v[196:199], v[40:43], v[92:95], v[196:199]
    ds_read_b64_tr_b16 v[36:37], v10 offset:28832
    ds_read_b64_tr_b16 v[38:39], v10 offset:30624
    ds_read_b64_tr_b16 v[40:41], v10 offset:28864
    ds_read_b64_tr_b16 v[42:43], v10 offset:30656
    global_load_dwordx4 v[88:91], v11, s[8:9] offset:2048
    global_load_dwordx4 v[92:95], v12, s[8:9] offset:2048
    s_waitcnt vmcnt(14) lgkmcnt(14)
    v_mfma_f32_16x16x32_bf16 v[144:147], v[44:47], v[96:99], v[144:147]
    v_mfma_f32_16x16x32_bf16 v[172:175], v[44:47], v[100:103], v[172:175]
    v_mfma_f32_16x16x32_bf16 v[148:151], v[48:51], v[96:99], v[148:151]
    v_mfma_f32_16x16x32_bf16 v[176:179], v[48:51], v[100:103], v[176:179]
    ds_read_b64_tr_b16 v[44:45], v10 offset:35840
    ds_read_b64_tr_b16 v[46:47], v10 offset:37632
    v_mfma_f32_16x16x32_bf16 v[152:155], v[52:55], v[96:99], v[152:155]
    v_mfma_f32_16x16x32_bf16 v[180:183], v[52:55], v[100:103], v[180:183]
    ds_read_b64_tr_b16 v[48:49], v10 offset:35872
    ds_read_b64_tr_b16 v[50:51], v10 offset:37664
    v_mfma_f32_16x16x32_bf16 v[156:159], v[56:59], v[96:99], v[156:159]
    v_mfma_f32_16x16x32_bf16 v[184:187], v[56:59], v[100:103], v[184:187]
    ds_read_b64_tr_b16 v[52:53], v10 offset:35904
    ds_read_b64_tr_b16 v[54:55], v10 offset:37696
    v_mfma_f32_16x16x32_bf16 v[160:163], v[60:63], v[96:99], v[160:163]
    v_mfma_f32_16x16x32_bf16 v[188:191], v[60:63], v[100:103], v[188:191]
    ds_read_b64_tr_b16 v[56:57], v10 offset:35936
    ds_read_b64_tr_b16 v[58:59], v10 offset:37728
    v_mfma_f32_16x16x32_bf16 v[164:167], v[64:67], v[96:99], v[164:167]
    v_mfma_f32_16x16x32_bf16 v[192:195], v[64:67], v[100:103], v[192:195]
    ds_read_b64_tr_b16 v[60:61], v10 offset:35968
    ds_read_b64_tr_b16 v[62:63], v10 offset:37760
    v_mfma_f32_16x16x32_bf16 v[168:171], v[68:71], v[96:99], v[168:171]
    v_mfma_f32_16x16x32_bf16 v[196:199], v[68:71], v[100:103], v[196:199]
    ds_read_b64_tr_b16 v[64:65], v10 offset:36000
    ds_read_b64_tr_b16 v[66:67], v10 offset:37792
    ds_read_b64_tr_b16 v[68:69], v10 offset:36032
    ds_read_b64_tr_b16 v[70:71], v10 offset:37824
    global_load_dwordx4 v[96:99], v11, s[8:9] offset:3072
    global_load_dwordx4 v[100:103], v12, s[8:9] offset:3072
    s_waitcnt vmcnt(14) lgkmcnt(14)
    v_mfma_f32_16x16x32_bf16 v[144:147], v[16:19], v[104:107], v[144:147]
    v_mfma_f32_16x16x32_bf16 v[172:175], v[16:19], v[108:111], v[172:175]
    v_mfma_f32_16x16x32_bf16 v[148:151], v[20:23], v[104:107], v[148:151]
    v_mfma_f32_16x16x32_bf16 v[176:179], v[20:23], v[108:111], v[176:179]
    ds_read_b64_tr_b16 v[16:17], v10 offset:43008
    ds_read_b64_tr_b16 v[18:19], v10 offset:44800
    v_mfma_f32_16x16x32_bf16 v[152:155], v[24:27], v[104:107], v[152:155]
    v_mfma_f32_16x16x32_bf16 v[180:183], v[24:27], v[108:111], v[180:183]
    ds_read_b64_tr_b16 v[20:21], v10 offset:43040
    ds_read_b64_tr_b16 v[22:23], v10 offset:44832
    v_mfma_f32_16x16x32_bf16 v[156:159], v[28:31], v[104:107], v[156:159]
    v_mfma_f32_16x16x32_bf16 v[184:187], v[28:31], v[108:111], v[184:187]
    ds_read_b64_tr_b16 v[24:25], v10 offset:43072
    ds_read_b64_tr_b16 v[26:27], v10 offset:44864
    v_mfma_f32_16x16x32_bf16 v[160:163], v[32:35], v[104:107], v[160:163]
    v_mfma_f32_16x16x32_bf16 v[188:191], v[32:35], v[108:111], v[188:191]
    ds_read_b64_tr_b16 v[28:29], v10 offset:43104
    ds_read_b64_tr_b16 v[30:31], v10 offset:44896
    v_mfma_f32_16x16x32_bf16 v[164:167], v[36:39], v[104:107], v[164:167]
    v_mfma_f32_16x16x32_bf16 v[192:195], v[36:39], v[108:111], v[192:195]
    ds_read_b64_tr_b16 v[32:33], v10 offset:43136
    ds_read_b64_tr_b16 v[34:35], v10 offset:44928
    v_mfma_f32_16x16x32_bf16 v[168:171], v[40:43], v[104:107], v[168:171]
    v_mfma_f32_16x16x32_bf16 v[196:199], v[40:43], v[108:111], v[196:199]
    ds_read_b64_tr_b16 v[36:37], v10 offset:43168
    ds_read_b64_tr_b16 v[38:39], v10 offset:44960
    ds_read_b64_tr_b16 v[40:41], v10 offset:43200
    ds_read_b64_tr_b16 v[42:43], v10 offset:44992
    s_add_u32 s8, s8, 4096
    s_addc_u32 s9, s9, 0
    global_load_dwordx4 v[104:107], v11, s[8:9] offset:0
    global_load_dwordx4 v[108:111], v12, s[8:9] offset:0
    s_waitcnt vmcnt(14) lgkmcnt(14)
    v_mfma_f32_16x16x32_bf16 v[144:147], v[44:47], v[112:115], v[144:147]
    v_mfma_f32_16x16x32_bf16 v[172:175], v[44:47], v[116:119], v[172:175]
    v_mfma_f32_16x16x32_bf16 v[148:151], v[48:51], v[112:115], v[148:151]
    v_mfma_f32_16x16x32_bf16 v[176:179], v[48:51], v[116:119], v[176:179]
    ds_read_b64_tr_b16 v[44:45], v10 offset:50176
    ds_read_b64_tr_b16 v[46:47], v10 offset:51968
    v_mfma_f32_16x16x32_bf16 v[152:155], v[52:55], v[112:115], v[152:155]
    v_mfma_f32_16x16x32_bf16 v[180:183], v[52:55], v[116:119], v[180:183]
    ds_read_b64_tr_b16 v[48:49], v10 offset:50208
    ds_read_b64_tr_b16 v[50:51], v10 offset:52000
    v_mfma_f32_16x16x32_bf16 v[156:159], v[56:59], v[112:115], v[156:159]
    v_mfma_f32_16x16x32_bf16 v[184:187], v[56:59], v[116:119], v[184:187]
    ds_read_b64_tr_b16 v[52:53], v10 offset:50240
    ds_read_b64_tr_b16 v[54:55], v10 offset:52032
    v_mfma_f32_16x16x32_bf16 v[160:163], v[60:63], v[112:115], v[160:163]
    v_mfma_f32_16x16x32_bf16 v[188:191], v[60:63], v[116:119], v[188:191]
    ds_read_b64_tr_b16 v[56:57], v10 offset:50272
    ds_read_b64_tr_b16 v[58:59], v10 offset:52064
    v_mfma_f32_16x16x32_bf16 v[164:167], v[64:67], v[112:115], v[164:167]
    v_mfma_f32_16x16x32_bf16 v[192:195], v[64:67], v[116:119], v[192:195]
    ds_read_b64_tr_b16 v[60:61], v10 offset:50304
    ds_read_b64_tr_b16 v[62:63], v10 offset:52096
    v_mfma_f32_16x16x32_bf16 v[168:171], v[68:71], v[112:115], v[168:171]
    v_mfma_f32_16x16x32_bf16 v[196:199], v[68:71], v[116:119], v[196:199]
    ds_read_b64_tr_b16 v[64:65], v10 offset:50336
    ds_read_b64_tr_b16 v[66:67], v10 offset:52128
    ds_read_b64_tr_b16 v[68:69], v10 offset:50368
    ds_read_b64_tr_b16 v[70:71], v10 offset:52160
    global_load_dwordx4 v[112:115], v11, s[8:9] offset:1024
    global_load_dwordx4 v[116:119], v12, s[8:9] offset:1024
    s_waitcnt vmcnt(14) lgkmcnt(14)
    s_barrier
    v_add_u32 v10, 32768, v10
    v_mfma_f32_16x16x32_bf16 v[144:147], v[16:19], v[120:123], v[144:147]
    v_mfma_f32_16x16x32_bf16 v[172:175], v[16:19], v[124:127], v[172:175]
    v_mfma_f32_16x16x32_bf16 v[148:151], v[20:23], v[120:123], v[148:151]
    v_mfma_f32_16x16x32_bf16 v[176:179], v[20:23], v[124:127], v[176:179]
    ds_read_b64_tr_b16 v[16:17], v10 offset:24576
    ds_read_b64_tr_b16 v[18:19], v10 offset:26368
    v_mfma_f32_16x16x32_bf16 v[152:155], v[24:27], v[120:123], v[152:155]
    v_mfma_f32_16x16x32_bf16 v[180:183], v[24:27], v[124:127], v[180:183]
    ds_read_b64_tr_b16 v[20:21], v10 offset:24608
    ds_read_b64_tr_b16 v[22:23], v10 offset:26400
    v_mfma_f32_16x16x32_bf16 v[156:159], v[28:31], v[120:123], v[156:159]
    v_mfma_f32_16x16x32_bf16 v[184:187], v[28:31], v[124:127], v[184:187]
    ds_read_b64_tr_b16 v[24:25], v10 offset:24640
    ds_read_b64_tr_b16 v[26:27], v10 offset:26432
    v_mfma_f32_16x16x32_bf16 v[160:163], v[32:35], v[120:123], v[160:163]
    v_mfma_f32_16x16x32_bf16 v[188:191], v[32:35], v[124:127], v[188:191]
    ds_read_b64_tr_b16 v[28:29], v10 offset:24672
    ds_read_b64_tr_b16 v[30:31], v10 offset:26464
    v_mfma_f32_16x16x32_bf16 v[164:167], v[36:39], v[120:123], v[164:167]
    v_mfma_f32_16x16x32_bf16 v[192:195], v[36:39], v[124:127], v[192:195]
    ds_read_b64_tr_b16 v[32:33], v10 offset:24704
    ds_read_b64_tr_b16 v[34:35], v10 offset:26496
    v_mfma_f32_16x16x32_bf16 v[168:171], v[40:43], v[120:123], v[168:171]
    v_mfma_f32_16x16x32_bf16 v[196:199], v[40:43], v[124:127], v[196:199]
    ds_read_b64_tr_b16 v[36:37], v10 offset:24736
    ds_read_b64_tr_b16 v[38:39], v10 offset:26528
    ds_read_b64_tr_b16 v[40:41], v10 offset:24768
    ds_read_b64_tr_b16 v[42:43], v10 offset:26560
    global_load_dwordx4 v[120:123], v11, s[8:9] offset:2048
    global_load_dwordx4 v[124:127], v12, s[8:9] offset:2048
    s_waitcnt vmcnt(14) lgkmcnt(14)
    v_mfma_f32_16x16x32_bf16 v[144:147], v[44:47], v[128:131], v[144:147]
    v_mfma_f32_16x16x32_bf16 v[172:175], v[44:47], v[132:135], v[172:175]
    v_mfma_f32_16x16x32_bf16 v[148:151], v[48:51], v[128:131], v[148:151]
    v_mfma_f32_16x16x32_bf16 v[176:179], v[48:51], v[132:135], v[176:179]
    ds_read_b64_tr_b16 v[44:45], v10 offset:31744
    ds_read_b64_tr_b16 v[46:47], v10 offset:33536
    v_mfma_f32_16x16x32_bf16 v[152:155], v[52:55], v[128:131], v[152:155]
    v_mfma_f32_16x16x32_bf16 v[180:183], v[52:55], v[132:135], v[180:183]
    ds_read_b64_tr_b16 v[48:49], v10 offset:31776
    ds_read_b64_tr_b16 v[50:51], v10 offset:33568
    v_mfma_f32_16x16x32_bf16 v[156:159], v[56:59], v[128:131], v[156:159]
    v_mfma_f32_16x16x32_bf16 v[184:187], v[56:59], v[132:135], v[184:187]
    ds_read_b64_tr_b16 v[52:53], v10 offset:31808
    ds_read_b64_tr_b16 v[54:55], v10 offset:33600
    v_mfma_f32_16x16x32_bf16 v[160:163], v[60:63], v[128:131], v[160:163]
    v_mfma_f32_16x16x32_bf16 v[188:191], v[60:63], v[132:135], v[188:191]
    ds_read_b64_tr_b16 v[56:57], v10 offset:31840
    ds_read_b64_tr_b16 v[58:59], v10 offset:33632
    v_mfma_f32_16x16x32_bf16 v[164:167], v[64:67], v[128:131], v[164:167]
    v_mfma_f32_16x16x32_bf16 v[192:195], v[64:67], v[132:135], v[192:195]
    ds_read_b64_tr_b16 v[60:61], v10 offset:31872
    ds_read_b64_tr_b16 v[62:63], v10 offset:33664
    v_mfma_f32_16x16x32_bf16 v[168:171], v[68:71], v[128:131], v[168:171]
    v_mfma_f32_16x16x32_bf16 v[196:199], v[68:71], v[132:135], v[196:199]
    ds_read_b64_tr_b16 v[64:65], v10 offset:31904
    ds_read_b64_tr_b16 v[66:67], v10 offset:33696
    ds_read_b64_tr_b16 v[68:69], v10 offset:31936
    ds_read_b64_tr_b16 v[70:71], v10 offset:33728
    global_load_dwordx4 v[128:131], v11, s[8:9] offset:3072
    global_load_dwordx4 v[132:135], v12, s[8:9] offset:3072
    s_waitcnt vmcnt(14) lgkmcnt(14)
    v_mfma_f32_16x16x32_bf16 v[144:147], v[16:19], v[72:75], v[144:147]
    v_mfma_f32_16x16x32_bf16 v[172:175], v[16:19], v[76:79], v[172:175]
    v_mfma_f32_16x16x32_bf16 v[148:151], v[20:23], v[72:75], v[148:151]
    v_mfma_f32_16x16x32_bf16 v[176:179], v[20:23], v[76:79], v[176:179]
    ds_read_b64_tr_b16 v[16:17], v10 offset:38912
    ds_read_b64_tr_b16 v[18:19], v10 offset:40704
    v_mfma_f32_16x16x32_bf16 v[152:155], v[24:27], v[72:75], v[152:155]
    v_mfma_f32_16x16x32_bf16 v[180:183], v[24:27], v[76:79], v[180:183]
    ds_read_b64_tr_b16 v[20:21], v10 offset:38944
    ds_read_b64_tr_b16 v[22:23], v10 offset:40736
    v_mfma_f32_16x16x32_bf16 v[156:159], v[28:31], v[72:75], v[156:159]
    v_mfma_f32_16x16x32_bf16 v[184:187], v[28:31], v[76:79], v[184:187]
    ds_read_b64_tr_b16 v[24:25], v10 offset:38976
    ds_read_b64_tr_b16 v[26:27], v10 offset:40768
    v_mfma_f32_16x16x32_bf16 v[160:163], v[32:35], v[72:75], v[160:163]
    v_mfma_f32_16x16x32_bf16 v[188:191], v[32:35], v[76:79], v[188:191]
    ds_read_b64_tr_b16 v[28:29], v10 offset:39008
    ds_read_b64_tr_b16 v[30:31], v10 offset:40800
    v_mfma_f32_16x16x32_bf16 v[164:167], v[36:39], v[72:75], v[164:167]
    v_mfma_f32_16x16x32_bf16 v[192:195], v[36:39], v[76:79], v[192:195]
    ds_read_b64_tr_b16 v[32:33], v10 offset:39040
    ds_read_b64_tr_b16 v[34:35], v10 offset:40832
    v_mfma_f32_16x16x32_bf16 v[168:171], v[40:43], v[72:75], v[168:171]
    v_mfma_f32_16x16x32_bf16 v[196:199], v[40:43], v[76:79], v[196:199]
    ds_read_b64_tr_b16 v[36:37], v10 offset:39072
    ds_read_b64_tr_b16 v[38:39], v10 offset:40864
    ds_read_b64_tr_b16 v[40:41], v10 offset:39104
    ds_read_b64_tr_b16 v[42:43], v10 offset:40896
    s_waitcnt vmcnt(12) lgkmcnt(14)
    v_mfma_f32_16x16x32_bf16 v[144:147], v[44:47], v[80:83], v[144:147]
    v_mfma_f32_16x16x32_bf16 v[172:175], v[44:47], v[84:87], v[172:175]
    v_mfma_f32_16x16x32_bf16 v[148:151], v[48:51], v[80:83], v[148:151]
    v_mfma_f32_16x16x32_bf16 v[176:179], v[48:51], v[84:87], v[176:179]
    ds_read_b64_tr_b16 v[44:45], v10 offset:46080
    ds_read_b64_tr_b16 v[46:47], v10 offset:47872
    v_mfma_f32_16x16x32_bf16 v[152:155], v[52:55], v[80:83], v[152:155]
    v_mfma_f32_16x16x32_bf16 v[180:183], v[52:55], v[84:87], v[180:183]
    ds_read_b64_tr_b16 v[48:49], v10 offset:46112
    ds_read_b64_tr_b16 v[50:51], v10 offset:47904
    v_mfma_f32_16x16x32_bf16 v[156:159], v[56:59], v[80:83], v[156:159]
    v_mfma_f32_16x16x32_bf16 v[184:187], v[56:59], v[84:87], v[184:187]
    ds_read_b64_tr_b16 v[52:53], v10 offset:46144
    ds_read_b64_tr_b16 v[54:55], v10 offset:47936
    v_mfma_f32_16x16x32_bf16 v[160:163], v[60:63], v[80:83], v[160:163]
    v_mfma_f32_16x16x32_bf16 v[188:191], v[60:63], v[84:87], v[188:191]
    ds_read_b64_tr_b16 v[56:57], v10 offset:46176
    ds_read_b64_tr_b16 v[58:59], v10 offset:47968
    v_mfma_f32_16x16x32_bf16 v[164:167], v[64:67], v[80:83], v[164:167]
    v_mfma_f32_16x16x32_bf16 v[192:195], v[64:67], v[84:87], v[192:195]
    ds_read_b64_tr_b16 v[60:61], v10 offset:46208
    ds_read_b64_tr_b16 v[62:63], v10 offset:48000
    v_mfma_f32_16x16x32_bf16 v[168:171], v[68:71], v[80:83], v[168:171]
    v_mfma_f32_16x16x32_bf16 v[196:199], v[68:71], v[84:87], v[196:199]
    ds_read_b64_tr_b16 v[64:65], v10 offset:46240
    ds_read_b64_tr_b16 v[66:67], v10 offset:48032
    ds_read_b64_tr_b16 v[68:69], v10 offset:46272
    ds_read_b64_tr_b16 v[70:71], v10 offset:48064
    s_waitcnt vmcnt(10) lgkmcnt(14)
    s_barrier
    v_add_u32 v10, 32768, v10
    v_mfma_f32_16x16x32_bf16 v[144:147], v[16:19], v[88:91], v[144:147]
    v_mfma_f32_16x16x32_bf16 v[172:175], v[16:19], v[92:95], v[172:175]
    v_mfma_f32_16x16x32_bf16 v[148:151], v[20:23], v[88:91], v[148:151]
    v_mfma_f32_16x16x32_bf16 v[176:179], v[20:23], v[92:95], v[176:179]
    ds_read_b64_tr_b16 v[16:17], v10 offset:20480
    ds_read_b64_tr_b16 v[18:19], v10 offset:22272
    v_mfma_f32_16x16x32_bf16 v[152:155], v[24:27], v[88:91], v[152:155]
    v_mfma_f32_16x16x32_bf16 v[180:183], v[24:27], v[92:95], v[180:183]
    ds_read_b64_tr_b16 v[20:21], v10 offset:20512
    ds_read_b64_tr_b16 v[22:23], v10 offset:22304
    v_mfma_f32_16x16x32_bf16 v[156:159], v[28:31], v[88:91], v[156:159]
    v_mfma_f32_16x16x32_bf16 v[184:187], v[28:31], v[92:95], v[184:187]
    ds_read_b64_tr_b16 v[24:25], v10 offset:20544
    ds_read_b64_tr_b16 v[26:27], v10 offset:22336
    v_mfma_f32_16x16x32_bf16 v[160:163], v[32:35], v[88:91], v[160:163]
    v_mfma_f32_16x16x32_bf16 v[188:191], v[32:35], v[92:95], v[188:191]
    ds_read_b64_tr_b16 v[28:29], v10 offset:20576
    ds_read_b64_tr_b16 v[30:31], v10 offset:22368
    v_mfma_f32_16x16x32_bf16 v[164:167], v[36:39], v[88:91], v[164:167]
    v_mfma_f32_16x16x32_bf16 v[192:195], v[36:39], v[92:95], v[192:195]
    ds_read_b64_tr_b16 v[32:33], v10 offset:20608
    ds_read_b64_tr_b16 v[34:35], v10 offset:22400
    v_mfma_f32_16x16x32_bf16 v[168:171], v[40:43], v[88:91], v[168:171]
    v_mfma_f32_16x16x32_bf16 v[196:199], v[40:43], v[92:95], v[196:199]
    ds_read_b64_tr_b16 v[36:37], v10 offset:20640
    ds_read_b64_tr_b16 v[38:39], v10 offset:22432
    ds_read_b64_tr_b16 v[40:41], v10 offset:20672
    ds_read_b64_tr_b16 v[42:43], v10 offset:22464
    s_waitcnt vmcnt(8) lgkmcnt(14)
    v_mfma_f32_16x16x32_bf16 v[144:147], v[44:47], v[96:99], v[144:147]
    v_mfma_f32_16x16x32_bf16 v[172:175], v[44:47], v[100:103], v[172:175]
    v_mfma_f32_16x16x32_bf16 v[148:151], v[48:51], v[96:99], v[148:151]
    v_mfma_f32_16x16x32_bf16 v[176:179], v[48:51], v[100:103], v[176:179]
    ds_read_b64_tr_b16 v[44:45], v10 offset:27648
    ds_read_b64_tr_b16 v[46:47], v10 offset:29440
    v_mfma_f32_16x16x32_bf16 v[152:155], v[52:55], v[96:99], v[152:155]
    v_mfma_f32_16x16x32_bf16 v[180:183], v[52:55], v[100:103], v[180:183]
    ds_read_b64_tr_b16 v[48:49], v10 offset:27680
    ds_read_b64_tr_b16 v[50:51], v10 offset:29472
    v_mfma_f32_16x16x32_bf16 v[156:159], v[56:59], v[96:99], v[156:159]
    v_mfma_f32_16x16x32_bf16 v[184:187], v[56:59], v[100:103], v[184:187]
    ds_read_b64_tr_b16 v[52:53], v10 offset:27712
    ds_read_b64_tr_b16 v[54:55], v10 offset:29504
    v_mfma_f32_16x16x32_bf16 v[160:163], v[60:63], v[96:99], v[160:163]
    v_mfma_f32_16x16x32_bf16 v[188:191], v[60:63], v[100:103], v[188:191]
    ds_read_b64_tr_b16 v[56:57], v10 offset:27744
    ds_read_b64_tr_b16 v[58:59], v10 offset:29536
    v_mfma_f32_16x16x32_bf16 v[164:167], v[64:67], v[96:99], v[164:167]
    v_mfma_f32_16x16x32_bf16 v[192:195], v[64:67], v[100:103], v[192:195]
    ds_read_b64_tr_b16 v[60:61], v10 offset:27776
    ds_read_b64_tr_b16 v[62:63], v10 offset:29568
    v_mfma_f32_16x16x32_bf16 v[168:171], v[68:71], v[96:99], v[168:171]
    v_mfma_f32_16x16x32_bf16 v[196:199], v[68:71], v[100:103], v[196:199]
    ds_read_b64_tr_b16 v[64:65], v10 offset:27808
    ds_read_b64_tr_b16 v[66:67], v10 offset:29600
    ds_read_b64_tr_b16 v[68:69], v10 offset:27840
    ds_read_b64_tr_b16 v[70:71], v10 offset:29632
    s_waitcnt vmcnt(6) lgkmcnt(14)
    v_mfma_f32_16x16x32_bf16 v[144:147], v[16:19], v[104:107], v[144:147]
    v_mfma_f32_16x16x32_bf16 v[172:175], v[16:19], v[108:111], v[172:175]
    v_mfma_f32_16x16x32_bf16 v[148:151], v[20:23], v[104:107], v[148:151]
    v_mfma_f32_16x16x32_bf16 v[176:179], v[20:23], v[108:111], v[176:179]
    ds_read_b64_tr_b16 v[16:17], v10 offset:34816
    ds_read_b64_tr_b16 v[18:19], v10 offset:36608
    v_mfma_f32_16x16x32_bf16 v[152:155], v[24:27], v[104:107], v[152:155]
    v_mfma_f32_16x16x32_bf16 v[180:183], v[24:27], v[108:111], v[180:183]
    ds_read_b64_tr_b16 v[20:21], v10 offset:34848
    ds_read_b64_tr_b16 v[22:23], v10 offset:36640
    v_mfma_f32_16x16x32_bf16 v[156:159], v[28:31], v[104:107], v[156:159]
    v_mfma_f32_16x16x32_bf16 v[184:187], v[28:31], v[108:111], v[184:187]
    ds_read_b64_tr_b16 v[24:25], v10 offset:34880
    ds_read_b64_tr_b16 v[26:27], v10 offset:36672
    v_mfma_f32_16x16x32_bf16 v[160:163], v[32:35], v[104:107], v[160:163]
    v_mfma_f32_16x16x32_bf16 v[188:191], v[32:35], v[108:111], v[188:191]
    ds_read_b64_tr_b16 v[28:29], v10 offset:34912
    ds_read_b64_tr_b16 v[30:31], v10 offset:36704
    v_mfma_f32_16x16x32_bf16 v[164:167], v[36:39], v[104:107], v[164:167]
    v_mfma_f32_16x16x32_bf16 v[192:195], v[36:39], v[108:111], v[192:195]
    ds_read_b64_tr_b16 v[32:33], v10 offset:34944
    ds_read_b64_tr_b16 v[34:35], v10 offset:36736
    v_mfma_f32_16x16x32_bf16 v[168:171], v[40:43], v[104:107], v[168:171]
    v_mfma_f32_16x16x32_bf16 v[196:199], v[40:43], v[108:111], v[196:199]
    ds_read_b64_tr_b16 v[36:37], v10 offset:34976
    ds_read_b64_tr_b16 v[38:39], v10 offset:36768
    ds_read_b64_tr_b16 v[40:41], v10 offset:35008
    ds_read_b64_tr_b16 v[42:43], v10 offset:36800
    s_waitcnt vmcnt(4) lgkmcnt(14)
    v_mfma_f32_16x16x32_bf16 v[144:147], v[44:47], v[112:115], v[144:147]
    v_mfma_f32_16x16x32_bf16 v[172:175], v[44:47], v[116:119], v[172:175]
    v_mfma_f32_16x16x32_bf16 v[148:151], v[48:51], v[112:115], v[148:151]
    v_mfma_f32_16x16x32_bf16 v[176:179], v[48:51], v[116:119], v[176:179]
    ds_read_b64_tr_b16 v[44:45], v10 offset:41984
    ds_read_b64_tr_b16 v[46:47], v10 offset:43776
    v_mfma_f32_16x16x32_bf16 v[152:155], v[52:55], v[112:115], v[152:155]
    v_mfma_f32_16x16x32_bf16 v[180:183], v[52:55], v[116:119], v[180:183]
    ds_read_b64_tr_b16 v[48:49], v10 offset:42016
    ds_read_b64_tr_b16 v[50:51], v10 offset:43808
    v_mfma_f32_16x16x32_bf16 v[156:159], v[56:59], v[112:115], v[156:159]
    v_mfma_f32_16x16x32_bf16 v[184:187], v[56:59], v[116:119], v[184:187]
    ds_read_b64_tr_b16 v[52:53], v10 offset:42048
    ds_read_b64_tr_b16 v[54:55], v10 offset:43840
    v_mfma_f32_16x16x32_bf16 v[160:163], v[60:63], v[112:115], v[160:163]
    v_mfma_f32_16x16x32_bf16 v[188:191], v[60:63], v[116:119], v[188:191]
    ds_read_b64_tr_b16 v[56:57], v10 offset:42080
    ds_read_b64_tr_b16 v[58:59], v10 offset:43872
    v_mfma_f32_16x16x32_bf16 v[164:167], v[64:67], v[112:115], v[164:167]
    v_mfma_f32_16x16x32_bf16 v[192:195], v[64:67], v[116:119], v[192:195]
    ds_read_b64_tr_b16 v[60:61], v10 offset:42112
    ds_read_b64_tr_b16 v[62:63], v10 offset:43904
    v_mfma_f32_16x16x32_bf16 v[168:171], v[68:71], v[112:115], v[168:171]
    v_mfma_f32_16x16x32_bf16 v[196:199], v[68:71], v[116:119], v[196:199]
    ds_read_b64_tr_b16 v[64:65], v10 offset:42144
    ds_read_b64_tr_b16 v[66:67], v10 offset:43936
    ds_read_b64_tr_b16 v[68:69], v10 offset:42176
    ds_read_b64_tr_b16 v[70:71], v10 offset:43968
    s_waitcnt vmcnt(2) lgkmcnt(14)
    v_mfma_f32_16x16x32_bf16 v[144:147], v[16:19], v[120:123], v[144:147]
    v_mfma_f32_16x16x32_bf16 v[172:175], v[16:19], v[124:127], v[172:175]
    v_mfma_f32_16x16x32_bf16 v[148:151], v[20:23], v[120:123], v[148:151]
    v_mfma_f32_16x16x32_bf16 v[176:179], v[20:23], v[124:127], v[176:179]
    v_mfma_f32_16x16x32_bf16 v[152:155], v[24:27], v[120:123], v[152:155]
    v_mfma_f32_16x16x32_bf16 v[180:183], v[24:27], v[124:127], v[180:183]
    v_mfma_f32_16x16x32_bf16 v[156:159], v[28:31], v[120:123], v[156:159]
    v_mfma_f32_16x16x32_bf16 v[184:187], v[28:31], v[124:127], v[184:187]
    v_mfma_f32_16x16x32_bf16 v[160:163], v[32:35], v[120:123], v[160:163]
    v_mfma_f32_16x16x32_bf16 v[188:191], v[32:35], v[124:127], v[188:191]
    v_mfma_f32_16x16x32_bf16 v[164:167], v[36:39], v[120:123], v[164:167]
    v_mfma_f32_16x16x32_bf16 v[192:195], v[36:39], v[124:127], v[192:195]
    v_mfma_f32_16x16x32_bf16 v[168:171], v[40:43], v[120:123], v[168:171]
    v_mfma_f32_16x16x32_bf16 v[196:199], v[40:43], v[124:127], v[196:199]
    s_waitcnt vmcnt(0) lgkmcnt(0)
    v_mfma_f32_16x16x32_bf16 v[144:147], v[44:47], v[128:131], v[144:147]
    v_mfma_f32_16x16x32_bf16 v[172:175], v[44:47], v[132:135], v[172:175]
    v_mfma_f32_16x16x32_bf16 v[148:151], v[48:51], v[128:131], v[148:151]
    v_mfma_f32_16x16x32_bf16 v[176:179], v[48:51], v[132:135], v[176:179]
    v_mfma_f32_16x16x32_bf16 v[152:155], v[52:55], v[128:131], v[152:155]
    v_mfma_f32_16x16x32_bf16 v[180:183], v[52:55], v[132:135], v[180:183]
    v_mfma_f32_16x16x32_bf16 v[156:159], v[56:59], v[128:131], v[156:159]
    v_mfma_f32_16x16x32_bf16 v[184:187], v[56:59], v[132:135], v[184:187]
    v_mfma_f32_16x16x32_bf16 v[160:163], v[60:63], v[128:131], v[160:163]
    v_mfma_f32_16x16x32_bf16 v[188:191], v[60:63], v[132:135], v[188:191]
    v_mfma_f32_16x16x32_bf16 v[164:167], v[64:67], v[128:131], v[164:167]
    v_mfma_f32_16x16x32_bf16 v[192:195], v[64:67], v[132:135], v[192:195]
    v_mfma_f32_16x16x32_bf16 v[168:171], v[68:71], v[128:131], v[168:171]
    v_mfma_f32_16x16x32_bf16 v[196:199], v[68:71], v[132:135], v[196:199]
    s_barrier
    v_mov_b32 v72, 0x40135761
    v_mov_b32 v73, 0x3dd2d3e8
    v_mov_b32 v74, 1.0
    v_mov_b32 v75, 1.0
    s_mul_i32 s21, s39, 3584
    s_mul_i32 s22, s16, 3584
    s_add_u32 s21, s21, s22
    v_and_b32 v3, 1, v15
    v_lshrrev_b32 v13, 1, v15
    v_and_b32 v8, 15, v2
    v_lshl_add_u32 v8, v8, 4, s21
    v_lshl_add_u32 v12, v3, 1, v13
    v_lshl_add_u32 v12, v12, 8, v8
    v_add_u32 v11, 57344, v12
    v_mul_u32_u24 v3, 57344, v3
    v_lshl_add_u32 v10, v13, 8, v8
    v_add_u32 v10, v10, v3

    v_pk_mul_f32 v[64:65], v[204:205], v[4:5] op_sel:[0,1] op_sel_hi:[1,1]
    v_pk_mul_f32 v[66:67], v[206:207], v[4:5] op_sel:[0,1] op_sel_hi:[1,1]
    v_pk_mul_f32 v[68:69], v[208:209], v[4:5] op_sel:[0,1] op_sel_hi:[1,1]
    v_pk_mul_f32 v[70:71], v[210:211], v[4:5] op_sel:[0,1] op_sel_hi:[1,1]
    v_pk_fma_f32 v[144:145], v[144:145], v[4:5], v[64:65] op_sel_hi:[1,0,1] neg_lo:[0,0,1] neg_hi:[0,0,1]
    v_pk_fma_f32 v[146:147], v[146:147], v[4:5], v[66:67] op_sel_hi:[1,0,1] neg_lo:[0,0,1] neg_hi:[0,0,1]
    v_pk_fma_f32 v[148:149], v[148:149], v[4:5], v[68:69] op_sel_hi:[1,0,1] neg_lo:[0,0,1] neg_hi:[0,0,1]
    v_pk_fma_f32 v[150:151], v[150:151], v[4:5], v[70:71] op_sel_hi:[1,0,1] neg_lo:[0,0,1] neg_hi:[0,0,1]
    v_cvt_pk_bf16_f32 v64, v144, v145
    v_cvt_pk_bf16_f32 v66, v146, v147
    v_cvt_pk_bf16_f32 v68, v148, v149
    v_cvt_pk_bf16_f32 v70, v150, v151
    v_lshlrev_b32 v144, 16, v64
    v_and_b32 v145, 0xffff0000, v64
    v_lshlrev_b32 v146, 16, v66
    v_and_b32 v147, 0xffff0000, v66
    v_lshlrev_b32 v148, 16, v68
    v_and_b32 v149, 0xffff0000, v68
    v_lshlrev_b32 v150, 16, v70
    v_and_b32 v151, 0xffff0000, v70
    v_pk_mul_f32 v[64:65], v[212:213], v[4:5] op_sel:[0,1] op_sel_hi:[1,1]
    v_pk_mul_f32 v[66:67], v[214:215], v[4:5] op_sel:[0,1] op_sel_hi:[1,1]
    v_pk_mul_f32 v[68:69], v[216:217], v[4:5] op_sel:[0,1] op_sel_hi:[1,1]
    v_pk_mul_f32 v[70:71], v[218:219], v[4:5] op_sel:[0,1] op_sel_hi:[1,1]
    v_pk_fma_f32 v[152:153], v[152:153], v[4:5], v[64:65] op_sel_hi:[1,0,1] neg_lo:[0,0,1] neg_hi:[0,0,1]
    v_pk_fma_f32 v[154:155], v[154:155], v[4:5], v[66:67] op_sel_hi:[1,0,1] neg_lo:[0,0,1] neg_hi:[0,0,1]
    v_pk_fma_f32 v[156:157], v[156:157], v[4:5], v[68:69] op_sel_hi:[1,0,1] neg_lo:[0,0,1] neg_hi:[0,0,1]
    v_pk_fma_f32 v[158:159], v[158:159], v[4:5], v[70:71] op_sel_hi:[1,0,1] neg_lo:[0,0,1] neg_hi:[0,0,1]
    v_cvt_pk_bf16_f32 v64, v152, v153
    v_cvt_pk_bf16_f32 v66, v154, v155
    v_cvt_pk_bf16_f32 v68, v156, v157
    v_cvt_pk_bf16_f32 v70, v158, v159
    v_lshlrev_b32 v152, 16, v64
    v_and_b32 v153, 0xffff0000, v64
    v_lshlrev_b32 v154, 16, v66
    v_and_b32 v155, 0xffff0000, v66
    v_lshlrev_b32 v156, 16, v68
    v_and_b32 v157, 0xffff0000, v68
    v_lshlrev_b32 v158, 16, v70
    v_and_b32 v159, 0xffff0000, v70
    v_pk_mul_f32 v[64:65], v[220:221], v[4:5] op_sel:[0,1] op_sel_hi:[1,1]
    v_pk_mul_f32 v[66:67], v[222:223], v[4:5] op_sel:[0,1] op_sel_hi:[1,1]
    v_pk_mul_f32 v[68:69], v[224:225], v[4:5] op_sel:[0,1] op_sel_hi:[1,1]
    v_pk_mul_f32 v[70:71], v[226:227], v[4:5] op_sel:[0,1] op_sel_hi:[1,1]
    v_pk_fma_f32 v[160:161], v[160:161], v[4:5], v[64:65] op_sel_hi:[1,0,1] neg_lo:[0,0,1] neg_hi:[0,0,1]
    v_pk_fma_f32 v[162:163], v[162:163], v[4:5], v[66:67] op_sel_hi:[1,0,1] neg_lo:[0,0,1] neg_hi:[0,0,1]
    v_pk_fma_f32 v[164:165], v[164:165], v[4:5], v[68:69] op_sel_hi:[1,0,1] neg_lo:[0,0,1] neg_hi:[0,0,1]
    v_pk_fma_f32 v[166:167], v[166:167], v[4:5], v[70:71] op_sel_hi:[1,0,1] neg_lo:[0,0,1] neg_hi:[0,0,1]
    v_cvt_pk_bf16_f32 v64, v160, v161
    v_cvt_pk_bf16_f32 v66, v162, v163
    v_cvt_pk_bf16_f32 v68, v164, v165
    v_cvt_pk_bf16_f32 v70, v166, v167
    v_lshlrev_b32 v160, 16, v64
    v_and_b32 v161, 0xffff0000, v64
    v_lshlrev_b32 v162, 16, v66
    v_and_b32 v163, 0xffff0000, v66
    v_lshlrev_b32 v164, 16, v68
    v_and_b32 v165, 0xffff0000, v68
    v_lshlrev_b32 v166, 16, v70
    v_and_b32 v167, 0xffff0000, v70
    v_pk_mul_f32 v[64:65], v[228:229], v[4:5] op_sel:[0,1] op_sel_hi:[1,1]
    v_pk_mul_f32 v[66:67], v[230:231], v[4:5] op_sel:[0,1] op_sel_hi:[1,1]
    v_pk_fma_f32 v[168:169], v[168:169], v[4:5], v[64:65] op_sel_hi:[1,0,1] neg_lo:[0,0,1] neg_hi:[0,0,1]
    v_pk_fma_f32 v[170:171], v[170:171], v[4:5], v[66:67] op_sel_hi:[1,0,1] neg_lo:[0,0,1] neg_hi:[0,0,1]
    v_cvt_pk_bf16_f32 v64, v168, v169
    v_cvt_pk_bf16_f32 v66, v170, v171
    v_lshlrev_b32 v168, 16, v64
    v_and_b32 v169, 0xffff0000, v64
    v_lshlrev_b32 v170, 16, v66
    v_and_b32 v171, 0xffff0000, v66
    v_pk_mul_f32 v[64:65], v[144:145], v[144:145]
    v_pk_mul_f32 v[66:67], v[146:147], v[146:147]
    v_pk_mul_f32 v[68:69], v[148:149], v[148:149]
    v_pk_mul_f32 v[70:71], v[150:151], v[150:151]
    v_pk_fma_f32 v[64:65], v[64:65], v[72:73], v[72:73] op_sel:[0,1,0] op_sel_hi:[1,1,0]
    v_pk_fma_f32 v[66:67], v[66:67], v[72:73], v[72:73] op_sel:[0,1,0] op_sel_hi:[1,1,0]
    v_pk_fma_f32 v[68:69], v[68:69], v[72:73], v[72:73] op_sel:[0,1,0] op_sel_hi:[1,1,0]
    v_pk_fma_f32 v[70:71], v[70:71], v[72:73], v[72:73] op_sel:[0,1,0] op_sel_hi:[1,1,0]
    v_pk_mul_f32 v[64:65], v[64:65], v[144:145]
    v_pk_mul_f32 v[66:67], v[66:67], v[146:147]
    v_pk_mul_f32 v[68:69], v[68:69], v[148:149]
    v_pk_mul_f32 v[70:71], v[70:71], v[150:151]
    v_exp_f32 v64, -v64
    v_exp_f32 v65, -v65
    v_exp_f32 v66, -v66
    v_exp_f32 v67, -v67
    v_exp_f32 v68, -v68
    v_exp_f32 v69, -v69
    v_exp_f32 v70, -v70
    v_exp_f32 v71, -v71
    v_pk_add_f32 v[64:65], v[64:65], v[74:75]
    v_pk_add_f32 v[66:67], v[66:67], v[74:75]
    v_pk_add_f32 v[68:69], v[68:69], v[74:75]
    v_pk_add_f32 v[70:71], v[70:71], v[74:75]
    v_rcp_f32 v64, v64
    v_rcp_f32 v65, v65
    v_rcp_f32 v66, v66
    v_rcp_f32 v67, v67
    v_rcp_f32 v68, v68
    v_rcp_f32 v69, v69
    v_rcp_f32 v70, v70
    v_rcp_f32 v71, v71
    v_pk_mul_f32 v[144:145], v[144:145], v[64:65]
    v_pk_mul_f32 v[146:147], v[146:147], v[66:67]
    v_pk_mul_f32 v[148:149], v[148:149], v[68:69]
    v_pk_mul_f32 v[150:151], v[150:151], v[70:71]
    v_pk_mul_f32 v[64:65], v[152:153], v[152:153]
    v_pk_mul_f32 v[66:67], v[154:155], v[154:155]
    v_pk_mul_f32 v[68:69], v[156:157], v[156:157]
    v_pk_mul_f32 v[70:71], v[158:159], v[158:159]
    v_pk_fma_f32 v[64:65], v[64:65], v[72:73], v[72:73] op_sel:[0,1,0] op_sel_hi:[1,1,0]
    v_pk_fma_f32 v[66:67], v[66:67], v[72:73], v[72:73] op_sel:[0,1,0] op_sel_hi:[1,1,0]
    v_pk_fma_f32 v[68:69], v[68:69], v[72:73], v[72:73] op_sel:[0,1,0] op_sel_hi:[1,1,0]
    v_pk_fma_f32 v[70:71], v[70:71], v[72:73], v[72:73] op_sel:[0,1,0] op_sel_hi:[1,1,0]
    v_pk_mul_f32 v[64:65], v[64:65], v[152:153]
    v_pk_mul_f32 v[66:67], v[66:67], v[154:155]
    v_pk_mul_f32 v[68:69], v[68:69], v[156:157]
    v_pk_mul_f32 v[70:71], v[70:71], v[158:159]
    v_exp_f32 v64, -v64
    v_exp_f32 v65, -v65
    v_exp_f32 v66, -v66
    v_exp_f32 v67, -v67
    v_exp_f32 v68, -v68
    v_exp_f32 v69, -v69
    v_exp_f32 v70, -v70
    v_exp_f32 v71, -v71
    v_pk_add_f32 v[64:65], v[64:65], v[74:75]
    v_pk_add_f32 v[66:67], v[66:67], v[74:75]
    v_pk_add_f32 v[68:69], v[68:69], v[74:75]
    v_pk_add_f32 v[70:71], v[70:71], v[74:75]
    v_rcp_f32 v64, v64
    v_rcp_f32 v65, v65
    v_rcp_f32 v66, v66
    v_rcp_f32 v67, v67
    v_rcp_f32 v68, v68
    v_rcp_f32 v69, v69
    v_rcp_f32 v70, v70
    v_rcp_f32 v71, v71
    v_pk_mul_f32 v[152:153], v[152:153], v[64:65]
    v_pk_mul_f32 v[154:155], v[154:155], v[66:67]
    v_pk_mul_f32 v[156:157], v[156:157], v[68:69]
    v_pk_mul_f32 v[158:159], v[158:159], v[70:71]
    v_pk_mul_f32 v[64:65], v[160:161], v[160:161]
    v_pk_mul_f32 v[66:67], v[162:163], v[162:163]
    v_pk_mul_f32 v[68:69], v[164:165], v[164:165]
    v_pk_mul_f32 v[70:71], v[166:167], v[166:167]
    v_pk_fma_f32 v[64:65], v[64:65], v[72:73], v[72:73] op_sel:[0,1,0] op_sel_hi:[1,1,0]
    v_pk_fma_f32 v[66:67], v[66:67], v[72:73], v[72:73] op_sel:[0,1,0] op_sel_hi:[1,1,0]
    v_pk_fma_f32 v[68:69], v[68:69], v[72:73], v[72:73] op_sel:[0,1,0] op_sel_hi:[1,1,0]
    v_pk_fma_f32 v[70:71], v[70:71], v[72:73], v[72:73] op_sel:[0,1,0] op_sel_hi:[1,1,0]
    v_pk_mul_f32 v[64:65], v[64:65], v[160:161]
    v_pk_mul_f32 v[66:67], v[66:67], v[162:163]
    v_pk_mul_f32 v[68:69], v[68:69], v[164:165]
    v_pk_mul_f32 v[70:71], v[70:71], v[166:167]
    v_exp_f32 v64, -v64
    v_exp_f32 v65, -v65
    v_exp_f32 v66, -v66
    v_exp_f32 v67, -v67
    v_exp_f32 v68, -v68
    v_exp_f32 v69, -v69
    v_exp_f32 v70, -v70
    v_exp_f32 v71, -v71
    v_pk_add_f32 v[64:65], v[64:65], v[74:75]
    v_pk_add_f32 v[66:67], v[66:67], v[74:75]
    v_pk_add_f32 v[68:69], v[68:69], v[74:75]
    v_pk_add_f32 v[70:71], v[70:71], v[74:75]
    v_rcp_f32 v64, v64
    v_rcp_f32 v65, v65
    v_rcp_f32 v66, v66
    v_rcp_f32 v67, v67
    v_rcp_f32 v68, v68
    v_rcp_f32 v69, v69
    v_rcp_f32 v70, v70
    v_rcp_f32 v71, v71
    v_pk_mul_f32 v[160:161], v[160:161], v[64:65]
    v_pk_mul_f32 v[162:163], v[162:163], v[66:67]
    v_pk_mul_f32 v[164:165], v[164:165], v[68:69]
    v_pk_mul_f32 v[166:167], v[166:167], v[70:71]
    v_pk_mul_f32 v[64:65], v[168:169], v[168:169]
    v_pk_mul_f32 v[66:67], v[170:171], v[170:171]
    v_pk_fma_f32 v[64:65], v[64:65], v[72:73], v[72:73] op_sel:[0,1,0] op_sel_hi:[1,1,0]
    v_pk_fma_f32 v[66:67], v[66:67], v[72:73], v[72:73] op_sel:[0,1,0] op_sel_hi:[1,1,0]
    v_pk_mul_f32 v[64:65], v[64:65], v[168:169]
    v_pk_mul_f32 v[66:67], v[66:67], v[170:171]
    v_exp_f32 v64, -v64
    v_exp_f32 v65, -v65
    v_exp_f32 v66, -v66
    v_exp_f32 v67, -v67
    v_pk_add_f32 v[64:65], v[64:65], v[74:75]
    v_pk_add_f32 v[66:67], v[66:67], v[74:75]
    v_rcp_f32 v64, v64
    v_rcp_f32 v65, v65
    v_rcp_f32 v66, v66
    v_rcp_f32 v67, v67
    v_pk_mul_f32 v[168:169], v[168:169], v[64:65]
    v_pk_mul_f32 v[170:171], v[170:171], v[66:67]
    v_cvt_pk_bf16_f32 v80, v144, v145
    v_cvt_pk_bf16_f32 v81, v146, v147
    v_cvt_pk_bf16_f32 v82, v148, v149
    v_cvt_pk_bf16_f32 v83, v150, v151
    v_cvt_pk_bf16_f32 v84, v152, v153
    v_cvt_pk_bf16_f32 v85, v154, v155
    v_cvt_pk_bf16_f32 v86, v156, v157
    v_cvt_pk_bf16_f32 v87, v158, v159
    v_cvt_pk_bf16_f32 v88, v160, v161
    v_cvt_pk_bf16_f32 v89, v162, v163
    v_cvt_pk_bf16_f32 v90, v164, v165
    v_cvt_pk_bf16_f32 v91, v166, v167
    v_cvt_pk_bf16_f32 v112, v168, v169
    v_cvt_pk_bf16_f32 v113, v170, v171
    s_nop 1
    v_permlane16_swap_b32 v80, v82
    v_permlane16_swap_b32 v81, v83
    v_permlane16_swap_b32 v84, v86
    v_permlane16_swap_b32 v85, v87
    v_permlane16_swap_b32 v88, v90
    v_permlane16_swap_b32 v89, v91
    s_nop 1
    global_store_dwordx4 v12, v[80:83], s[26:27] offset:0 sc1
    global_store_dwordx4 v12, v[84:87], s[26:27] offset:1024 sc1
    global_store_dwordx4 v12, v[88:91], s[26:27] offset:2048 sc1
    v_pk_mul_f32 v[64:65], v[204:205], v[6:7] op_sel:[0,1] op_sel_hi:[1,1]
    v_pk_mul_f32 v[66:67], v[206:207], v[6:7] op_sel:[0,1] op_sel_hi:[1,1]
    v_pk_mul_f32 v[68:69], v[208:209], v[6:7] op_sel:[0,1] op_sel_hi:[1,1]
    v_pk_mul_f32 v[70:71], v[210:211], v[6:7] op_sel:[0,1] op_sel_hi:[1,1]
    v_pk_fma_f32 v[172:173], v[172:173], v[6:7], v[64:65] op_sel_hi:[1,0,1] neg_lo:[0,0,1] neg_hi:[0,0,1]
    v_pk_fma_f32 v[174:175], v[174:175], v[6:7], v[66:67] op_sel_hi:[1,0,1] neg_lo:[0,0,1] neg_hi:[0,0,1]
    v_pk_fma_f32 v[176:177], v[176:177], v[6:7], v[68:69] op_sel_hi:[1,0,1] neg_lo:[0,0,1] neg_hi:[0,0,1]
    v_pk_fma_f32 v[178:179], v[178:179], v[6:7], v[70:71] op_sel_hi:[1,0,1] neg_lo:[0,0,1] neg_hi:[0,0,1]
    v_cvt_pk_bf16_f32 v64, v172, v173
    v_cvt_pk_bf16_f32 v66, v174, v175
    v_cvt_pk_bf16_f32 v68, v176, v177
    v_cvt_pk_bf16_f32 v70, v178, v179
    v_lshlrev_b32 v172, 16, v64
    v_and_b32 v173, 0xffff0000, v64
    v_lshlrev_b32 v174, 16, v66
    v_and_b32 v175, 0xffff0000, v66
    v_lshlrev_b32 v176, 16, v68
    v_and_b32 v177, 0xffff0000, v68
    v_lshlrev_b32 v178, 16, v70
    v_and_b32 v179, 0xffff0000, v70
    v_pk_mul_f32 v[64:65], v[212:213], v[6:7] op_sel:[0,1] op_sel_hi:[1,1]
    v_pk_mul_f32 v[66:67], v[214:215], v[6:7] op_sel:[0,1] op_sel_hi:[1,1]
    v_pk_mul_f32 v[68:69], v[216:217], v[6:7] op_sel:[0,1] op_sel_hi:[1,1]
    v_pk_mul_f32 v[70:71], v[218:219], v[6:7] op_sel:[0,1] op_sel_hi:[1,1]
    v_pk_fma_f32 v[180:181], v[180:181], v[6:7], v[64:65] op_sel_hi:[1,0,1] neg_lo:[0,0,1] neg_hi:[0,0,1]
    v_pk_fma_f32 v[182:183], v[182:183], v[6:7], v[66:67] op_sel_hi:[1,0,1] neg_lo:[0,0,1] neg_hi:[0,0,1]
    v_pk_fma_f32 v[184:185], v[184:185], v[6:7], v[68:69] op_sel_hi:[1,0,1] neg_lo:[0,0,1] neg_hi:[0,0,1]
    v_pk_fma_f32 v[186:187], v[186:187], v[6:7], v[70:71] op_sel_hi:[1,0,1] neg_lo:[0,0,1] neg_hi:[0,0,1]
    v_cvt_pk_bf16_f32 v64, v180, v181
    v_cvt_pk_bf16_f32 v66, v182, v183
    v_cvt_pk_bf16_f32 v68, v184, v185
    v_cvt_pk_bf16_f32 v70, v186, v187
    v_lshlrev_b32 v180, 16, v64
    v_and_b32 v181, 0xffff0000, v64
    v_lshlrev_b32 v182, 16, v66
    v_and_b32 v183, 0xffff0000, v66
    v_lshlrev_b32 v184, 16, v68
    v_and_b32 v185, 0xffff0000, v68
    v_lshlrev_b32 v186, 16, v70
    v_and_b32 v187, 0xffff0000, v70
    v_pk_mul_f32 v[64:65], v[220:221], v[6:7] op_sel:[0,1] op_sel_hi:[1,1]
    v_pk_mul_f32 v[66:67], v[222:223], v[6:7] op_sel:[0,1] op_sel_hi:[1,1]
    v_pk_mul_f32 v[68:69], v[224:225], v[6:7] op_sel:[0,1] op_sel_hi:[1,1]
    v_pk_mul_f32 v[70:71], v[226:227], v[6:7] op_sel:[0,1] op_sel_hi:[1,1]
    v_pk_fma_f32 v[188:189], v[188:189], v[6:7], v[64:65] op_sel_hi:[1,0,1] neg_lo:[0,0,1] neg_hi:[0,0,1]
    v_pk_fma_f32 v[190:191], v[190:191], v[6:7], v[66:67] op_sel_hi:[1,0,1] neg_lo:[0,0,1] neg_hi:[0,0,1]
    v_pk_fma_f32 v[192:193], v[192:193], v[6:7], v[68:69] op_sel_hi:[1,0,1] neg_lo:[0,0,1] neg_hi:[0,0,1]
    v_pk_fma_f32 v[194:195], v[194:195], v[6:7], v[70:71] op_sel_hi:[1,0,1] neg_lo:[0,0,1] neg_hi:[0,0,1]
    v_cvt_pk_bf16_f32 v64, v188, v189
    v_cvt_pk_bf16_f32 v66, v190, v191
    v_cvt_pk_bf16_f32 v68, v192, v193
    v_cvt_pk_bf16_f32 v70, v194, v195
    v_lshlrev_b32 v188, 16, v64
    v_and_b32 v189, 0xffff0000, v64
    v_lshlrev_b32 v190, 16, v66
    v_and_b32 v191, 0xffff0000, v66
    v_lshlrev_b32 v192, 16, v68
    v_and_b32 v193, 0xffff0000, v68
    v_lshlrev_b32 v194, 16, v70
    v_and_b32 v195, 0xffff0000, v70
    v_pk_mul_f32 v[64:65], v[228:229], v[6:7] op_sel:[0,1] op_sel_hi:[1,1]
    v_pk_mul_f32 v[66:67], v[230:231], v[6:7] op_sel:[0,1] op_sel_hi:[1,1]
    v_pk_fma_f32 v[196:197], v[196:197], v[6:7], v[64:65] op_sel_hi:[1,0,1] neg_lo:[0,0,1] neg_hi:[0,0,1]
    v_pk_fma_f32 v[198:199], v[198:199], v[6:7], v[66:67] op_sel_hi:[1,0,1] neg_lo:[0,0,1] neg_hi:[0,0,1]
    v_cvt_pk_bf16_f32 v64, v196, v197
    v_cvt_pk_bf16_f32 v66, v198, v199
    v_lshlrev_b32 v196, 16, v64
    v_and_b32 v197, 0xffff0000, v64
    v_lshlrev_b32 v198, 16, v66
    v_and_b32 v199, 0xffff0000, v66
    v_pk_mul_f32 v[64:65], v[172:173], v[172:173]
    v_pk_mul_f32 v[66:67], v[174:175], v[174:175]
    v_pk_mul_f32 v[68:69], v[176:177], v[176:177]
    v_pk_mul_f32 v[70:71], v[178:179], v[178:179]
    v_pk_fma_f32 v[64:65], v[64:65], v[72:73], v[72:73] op_sel:[0,1,0] op_sel_hi:[1,1,0]
    v_pk_fma_f32 v[66:67], v[66:67], v[72:73], v[72:73] op_sel:[0,1,0] op_sel_hi:[1,1,0]
    v_pk_fma_f32 v[68:69], v[68:69], v[72:73], v[72:73] op_sel:[0,1,0] op_sel_hi:[1,1,0]
    v_pk_fma_f32 v[70:71], v[70:71], v[72:73], v[72:73] op_sel:[0,1,0] op_sel_hi:[1,1,0]
    v_pk_mul_f32 v[64:65], v[64:65], v[172:173]
    v_pk_mul_f32 v[66:67], v[66:67], v[174:175]
    v_pk_mul_f32 v[68:69], v[68:69], v[176:177]
    v_pk_mul_f32 v[70:71], v[70:71], v[178:179]
    v_exp_f32 v64, -v64
    v_exp_f32 v65, -v65
    v_exp_f32 v66, -v66
    v_exp_f32 v67, -v67
    v_exp_f32 v68, -v68
    v_exp_f32 v69, -v69
    v_exp_f32 v70, -v70
    v_exp_f32 v71, -v71
    v_pk_add_f32 v[64:65], v[64:65], v[74:75]
    v_pk_add_f32 v[66:67], v[66:67], v[74:75]
    v_pk_add_f32 v[68:69], v[68:69], v[74:75]
    v_pk_add_f32 v[70:71], v[70:71], v[74:75]
    v_rcp_f32 v64, v64
    v_rcp_f32 v65, v65
    v_rcp_f32 v66, v66
    v_rcp_f32 v67, v67
    v_rcp_f32 v68, v68
    v_rcp_f32 v69, v69
    v_rcp_f32 v70, v70
    v_rcp_f32 v71, v71
    v_pk_mul_f32 v[172:173], v[172:173], v[64:65]
    v_pk_mul_f32 v[174:175], v[174:175], v[66:67]
    v_pk_mul_f32 v[176:177], v[176:177], v[68:69]
    v_pk_mul_f32 v[178:179], v[178:179], v[70:71]
    v_pk_mul_f32 v[64:65], v[180:181], v[180:181]
    v_pk_mul_f32 v[66:67], v[182:183], v[182:183]
    v_pk_mul_f32 v[68:69], v[184:185], v[184:185]
    v_pk_mul_f32 v[70:71], v[186:187], v[186:187]
    v_pk_fma_f32 v[64:65], v[64:65], v[72:73], v[72:73] op_sel:[0,1,0] op_sel_hi:[1,1,0]
    v_pk_fma_f32 v[66:67], v[66:67], v[72:73], v[72:73] op_sel:[0,1,0] op_sel_hi:[1,1,0]
    v_pk_fma_f32 v[68:69], v[68:69], v[72:73], v[72:73] op_sel:[0,1,0] op_sel_hi:[1,1,0]
    v_pk_fma_f32 v[70:71], v[70:71], v[72:73], v[72:73] op_sel:[0,1,0] op_sel_hi:[1,1,0]
    v_pk_mul_f32 v[64:65], v[64:65], v[180:181]
    v_pk_mul_f32 v[66:67], v[66:67], v[182:183]
    v_pk_mul_f32 v[68:69], v[68:69], v[184:185]
    v_pk_mul_f32 v[70:71], v[70:71], v[186:187]
    v_exp_f32 v64, -v64
    v_exp_f32 v65, -v65
    v_exp_f32 v66, -v66
    v_exp_f32 v67, -v67
    v_exp_f32 v68, -v68
    v_exp_f32 v69, -v69
    v_exp_f32 v70, -v70
    v_exp_f32 v71, -v71
    v_pk_add_f32 v[64:65], v[64:65], v[74:75]
    v_pk_add_f32 v[66:67], v[66:67], v[74:75]
    v_pk_add_f32 v[68:69], v[68:69], v[74:75]
    v_pk_add_f32 v[70:71], v[70:71], v[74:75]
    v_rcp_f32 v64, v64
    v_rcp_f32 v65, v65
    v_rcp_f32 v66, v66
    v_rcp_f32 v67, v67
    v_rcp_f32 v68, v68
    v_rcp_f32 v69, v69
    v_rcp_f32 v70, v70
    v_rcp_f32 v71, v71
    v_pk_mul_f32 v[180:181], v[180:181], v[64:65]
    v_pk_mul_f32 v[182:183], v[182:183], v[66:67]
    v_pk_mul_f32 v[184:185], v[184:185], v[68:69]
    v_pk_mul_f32 v[186:187], v[186:187], v[70:71]
    v_pk_mul_f32 v[64:65], v[188:189], v[188:189]
    v_pk_mul_f32 v[66:67], v[190:191], v[190:191]
    v_pk_mul_f32 v[68:69], v[192:193], v[192:193]
    v_pk_mul_f32 v[70:71], v[194:195], v[194:195]
    v_pk_fma_f32 v[64:65], v[64:65], v[72:73], v[72:73] op_sel:[0,1,0] op_sel_hi:[1,1,0]
    v_pk_fma_f32 v[66:67], v[66:67], v[72:73], v[72:73] op_sel:[0,1,0] op_sel_hi:[1,1,0]
    v_pk_fma_f32 v[68:69], v[68:69], v[72:73], v[72:73] op_sel:[0,1,0] op_sel_hi:[1,1,0]
    v_pk_fma_f32 v[70:71], v[70:71], v[72:73], v[72:73] op_sel:[0,1,0] op_sel_hi:[1,1,0]
    v_pk_mul_f32 v[64:65], v[64:65], v[188:189]
    v_pk_mul_f32 v[66:67], v[66:67], v[190:191]
    v_pk_mul_f32 v[68:69], v[68:69], v[192:193]
    v_pk_mul_f32 v[70:71], v[70:71], v[194:195]
    v_exp_f32 v64, -v64
    v_exp_f32 v65, -v65
    v_exp_f32 v66, -v66
    v_exp_f32 v67, -v67
    v_exp_f32 v68, -v68
    v_exp_f32 v69, -v69
    v_exp_f32 v70, -v70
    v_exp_f32 v71, -v71
    v_pk_add_f32 v[64:65], v[64:65], v[74:75]
    v_pk_add_f32 v[66:67], v[66:67], v[74:75]
    v_pk_add_f32 v[68:69], v[68:69], v[74:75]
    v_pk_add_f32 v[70:71], v[70:71], v[74:75]
    v_rcp_f32 v64, v64
    v_rcp_f32 v65, v65
    v_rcp_f32 v66, v66
    v_rcp_f32 v67, v67
    v_rcp_f32 v68, v68
    v_rcp_f32 v69, v69
    v_rcp_f32 v70, v70
    v_rcp_f32 v71, v71
    v_pk_mul_f32 v[188:189], v[188:189], v[64:65]
    v_pk_mul_f32 v[190:191], v[190:191], v[66:67]
    v_pk_mul_f32 v[192:193], v[192:193], v[68:69]
    v_pk_mul_f32 v[194:195], v[194:195], v[70:71]
    v_pk_mul_f32 v[64:65], v[196:197], v[196:197]
    v_pk_mul_f32 v[66:67], v[198:199], v[198:199]
    v_pk_fma_f32 v[64:65], v[64:65], v[72:73], v[72:73] op_sel:[0,1,0] op_sel_hi:[1,1,0]
    v_pk_fma_f32 v[66:67], v[66:67], v[72:73], v[72:73] op_sel:[0,1,0] op_sel_hi:[1,1,0]
    v_pk_mul_f32 v[64:65], v[64:65], v[196:197]
    v_pk_mul_f32 v[66:67], v[66:67], v[198:199]
    v_exp_f32 v64, -v64
    v_exp_f32 v65, -v65
    v_exp_f32 v66, -v66
    v_exp_f32 v67, -v67
    v_pk_add_f32 v[64:65], v[64:65], v[74:75]
    v_pk_add_f32 v[66:67], v[66:67], v[74:75]
    v_rcp_f32 v64, v64
    v_rcp_f32 v65, v65
    v_rcp_f32 v66, v66
    v_rcp_f32 v67, v67
    v_pk_mul_f32 v[196:197], v[196:197], v[64:65]
    v_pk_mul_f32 v[198:199], v[198:199], v[66:67]
    v_cvt_pk_bf16_f32 v96, v172, v173
    v_cvt_pk_bf16_f32 v97, v174, v175
    v_cvt_pk_bf16_f32 v98, v176, v177
    v_cvt_pk_bf16_f32 v99, v178, v179
    v_cvt_pk_bf16_f32 v100, v180, v181
    v_cvt_pk_bf16_f32 v101, v182, v183
    v_cvt_pk_bf16_f32 v102, v184, v185
    v_cvt_pk_bf16_f32 v103, v186, v187
    v_cvt_pk_bf16_f32 v104, v188, v189
    v_cvt_pk_bf16_f32 v105, v190, v191
    v_cvt_pk_bf16_f32 v106, v192, v193
    v_cvt_pk_bf16_f32 v107, v194, v195
    v_cvt_pk_bf16_f32 v114, v196, v197
    v_cvt_pk_bf16_f32 v115, v198, v199
    s_nop 1
    v_permlane16_swap_b32 v96, v98
    v_permlane16_swap_b32 v97, v99
    v_permlane16_swap_b32 v100, v102
    v_permlane16_swap_b32 v101, v103
    v_permlane16_swap_b32 v104, v106
    v_permlane16_swap_b32 v105, v107
    s_nop 1
    global_store_dwordx4 v11, v[96:99], s[26:27] offset:0 sc1
    global_store_dwordx4 v11, v[100:103], s[26:27] offset:1024 sc1
    global_store_dwordx4 v11, v[104:107], s[26:27] offset:2048 sc1
    v_permlane16_swap_b32 v112, v114
    v_permlane16_swap_b32 v113, v115
    s_nop 1
    global_store_dwordx4 v10, v[112:115], s[26:27] offset:3072 sc1

    s_bfe_u32 s16, s2, 0x30003
    s_and_b32 s17, s2, 7
    s_lshl_b32 s17, s17, 2
    s_lshr_b32 s19, s2, 6
    s_add_u32 s17, s17, s19

    s_lshr_b32 s18, s3, 1
    s_lshl_b32 s18, s18, 4
    s_and_b32 s19, s3, 1
    s_lshl_b32 s19, s19, 2
    s_add_u32 s18, s18, s19
    s_lshl_b32 s39, s17, 6
    s_lshl_b32 s23, s3, 4
    s_add_u32 s39, s39, s23
    s_lshl_b32 s38, s39, 10
    s_lshl_b32 s20, s18, 10
    s_lshl_b32 s37, s16, 7
    s_add_u32 s20, s20, s37
    s_lshl_b32 s34, s17, 1
    s_add_u32 s34, s34, s16
    s_mul_hi_u32 s35, s34, 0x24924925
    s_mul_i32 s35, s35, 7
    s_sub_u32 s34, s34, s35
    s_lshl_b32 s34, s34, 1

    s_mul_i32 s21, s39, 3584
    v_lshl_add_u32 v17, v2, 4, s21
    s_lshl_b32 s36, s34, 12
    s_lshr_b32 s43, s17, 1
    s_lshl_b32 s43, s43, 7

    v_lshrrev_b32 v18, 1, v15
    v_lshlrev_b32 v18, 8, v18
    v_and_b32 v5, 15, v2
    v_lshl_add_u32 v18, v5, 4, v18
    v_and_b32 v5, 1, v15
    v_lshl_add_u32 v18, v5, 3, v18
    s_lshl_b32 s21, s16, 11
    s_add_u32 s21, s21, s38
    v_add_u32 v18, s21, v18
    s_waitcnt vmcnt(0)
    s_barrier
    v_cmp_eq_u32 vcc, 0, v0
    s_and_saveexec_b64 s[48:49], vcc
    s_cbranch_execz SIG_12
    v_mov_b32 v60, s45
    v_mov_b32 v61, 1
    global_atomic_add v60, v61, s[46:47] sc1
SIG_12:
    s_mov_b64 exec, s[48:49]
    s_add_u32 s8, s4, 0x1200000
    s_addc_u32 s9, s5, 0
    s_add_u32 s24, s4, 0xa00000
    s_addc_u32 s25, s5, 0
    s_add_u32 s28, s4, 0x1000000
    s_addc_u32 s29, s5, 0
    s_mov_b32 s10, 7340032
    s_mov_b32 s11, 0x00020000
    global_load_dwordx2 v[20:21], v18, s[24:25] offset:0
    global_load_dwordx2 v[22:23], v18, s[24:25] offset:512
    global_load_dwordx2 v[24:25], v18, s[24:25] offset:1024
    global_load_dwordx2 v[26:27], v18, s[24:25] offset:1536
    global_load_dwordx2 v[28:29], v18, s[28:29] offset:0
    global_load_dwordx2 v[30:31], v18, s[28:29] offset:512
    global_load_dwordx2 v[32:33], v18, s[28:29] offset:1024
    global_load_dwordx2 v[34:35], v18, s[28:29] offset:1536
    v_lshrrev_b32 v7, 5, v2
    v_lshlrev_b32 v7, 4, v7
    v_bfe_u32 v10, v2, 2, 3
    v_add_u32 v7, v7, v10
    v_lshlrev_b32 v5, 7, v7
    v_and_b32 v7, 3, v2
    v_lshl_add_u32 v5, v7, 3, v5
    v_lshrrev_b32 v6, 1, v10
    v_xor_b32 v7, 0, v6
    v_lshl_add_u32 v10, v7, 5, v5
    v_xor_b32 v7, 1, v6
    v_lshl_add_u32 v11, v7, 5, v5
    v_xor_b32 v7, 2, v6
    v_lshl_add_u32 v12, v7, 5, v5
    v_xor_b32 v7, 3, v6
    v_lshl_add_u32 v13, v7, 5, v5
    v_mov_b32 v36, 0
    v_mov_b32 v37, 0
    v_mov_b32 v38, 0
    v_mov_b32 v39, 0
    v_mov_b32 v40, 0
    v_mov_b32 v41, 0
    v_mov_b32 v42, 0
    v_mov_b32 v43, 0
    v_mov_b32 v44, 0
    v_mov_b32 v45, 0
    v_mov_b32 v46, 0
    v_mov_b32 v47, 0
    v_mov_b32 v48, 0
    v_mov_b32 v49, 0
    v_mov_b32 v50, 0
    v_mov_b32 v51, 0
    v_readfirstlane_b32 s50, v0
    v_mov_b32 v60, s43
    s_mov_b32 s51, 0
    s_cmp_lg_u32 s50, 0
    s_cbranch_scc1 K56_poll_ok
K56_poll:
    global_load_dword v61, v60, s[46:47] sc1
    s_waitcnt vmcnt(0)
    v_readfirstlane_b32 s50, v61
    s_add_u32 s51, s51, 1
    s_cmp_ge_u32 s50, 16
    s_cbranch_scc1 K56_poll_ok
    s_cmp_lt_u32 s51, 0x8000
    s_cbranch_scc0 K56_poll_ok
    s_sleep 1
    s_branch K56_poll
K56_poll_ok:
    s_barrier
    buffer_load_dwordx4 v[96:99], v17, s[8:11], s36 offen offset:0 sc1
    buffer_load_dwordx4 v[100:103], v17, s[8:11], s36 offen offset:1024 sc1
    buffer_load_dwordx4 v[104:107], v17, s[8:11], s36 offen offset:2048 sc1
    buffer_load_dwordx4 v[108:111], v17, s[8:11], s36 offen offset:3072 sc1
    s_add_u32 s36, s36, 4096
    s_cmp_eq_u32 s36, 57344
    s_cselect_b32 s36, 0, s36
    buffer_load_dwordx4 v[112:115], v17, s[8:11], s36 offen offset:0 sc1
    buffer_load_dwordx4 v[116:119], v17, s[8:11], s36 offen offset:1024 sc1
    buffer_load_dwordx4 v[120:123], v17, s[8:11], s36 offen offset:2048 sc1
    buffer_load_dwordx4 v[124:127], v17, s[8:11], s36 offen offset:3072 sc1
    s_add_u32 s36, s36, 4096
    s_cmp_eq_u32 s36, 57344
    s_cselect_b32 s36, 0, s36
    buffer_load_dwordx4 v[128:131], v17, s[8:11], s36 offen offset:0 sc1
    buffer_load_dwordx4 v[132:135], v17, s[8:11], s36 offen offset:1024 sc1
    buffer_load_dwordx4 v[136:139], v17, s[8:11], s36 offen offset:2048 sc1
    buffer_load_dwordx4 v[140:143], v17, s[8:11], s36 offen offset:3072 sc1
    s_add_u32 s36, s36, 4096
    s_cmp_eq_u32 s36, 57344
    s_cselect_b32 s36, 0, s36
    buffer_load_dwordx4 v[144:147], v17, s[8:11], s36 offen offset:0 sc1
    buffer_load_dwordx4 v[148:151], v17, s[8:11], s36 offen offset:1024 sc1
    buffer_load_dwordx4 v[152:155], v17, s[8:11], s36 offen offset:2048 sc1
    buffer_load_dwordx4 v[156:159], v17, s[8:11], s36 offen offset:3072 sc1
    s_add_u32 s36, s36, 4096
    s_cmp_eq_u32 s36, 57344
    s_cselect_b32 s36, 0, s36
    s_barrier
    ds_read_b64_tr_b16 v[64:65], v10 offset:0
    ds_read_b64_tr_b16 v[66:67], v10 offset:1024
    ds_read_b64_tr_b16 v[68:69], v11 offset:0
    ds_read_b64_tr_b16 v[70:71], v11 offset:1024
    ds_read_b64_tr_b16 v[72:73], v12 offset:0
    ds_read_b64_tr_b16 v[74:75], v12 offset:1024
    ds_read_b64_tr_b16 v[76:77], v13 offset:0
    ds_read_b64_tr_b16 v[78:79], v13 offset:1024
    ds_read_b64_tr_b16 v[80:81], v10 offset:4096
    ds_read_b64_tr_b16 v[82:83], v10 offset:5120
    ds_read_b64_tr_b16 v[84:85], v11 offset:4096
    ds_read_b64_tr_b16 v[86:87], v11 offset:5120
    ds_read_b64_tr_b16 v[88:89], v12 offset:4096
    ds_read_b64_tr_b16 v[90:91], v12 offset:5120
    ds_read_b64_tr_b16 v[92:93], v13 offset:4096
    ds_read_b64_tr_b16 v[94:95], v13 offset:5120
    s_waitcnt vmcnt(15) lgkmcnt(8)
    v_mfma_f32_16x16x32_bf16 v[36:39], v[64:67], v[96:99], v[36:39]
    v_mfma_f32_16x16x32_bf16 v[40:43], v[68:71], v[96:99], v[40:43]
    ds_read_b64_tr_b16 v[64:65], v10 offset:8192
    ds_read_b64_tr_b16 v[66:67], v10 offset:9216
    v_mfma_f32_16x16x32_bf16 v[44:47], v[72:75], v[96:99], v[44:47]
    ds_read_b64_tr_b16 v[68:69], v11 offset:8192
    ds_read_b64_tr_b16 v[70:71], v11 offset:9216
    v_mfma_f32_16x16x32_bf16 v[48:51], v[76:79], v[96:99], v[48:51]
    ds_read_b64_tr_b16 v[72:73], v12 offset:8192
    ds_read_b64_tr_b16 v[74:75], v12 offset:9216
    ds_read_b64_tr_b16 v[76:77], v13 offset:8192
    ds_read_b64_tr_b16 v[78:79], v13 offset:9216
    buffer_load_dwordx4 v[96:99], v17, s[8:11], s36 offen offset:0 sc1
    s_waitcnt vmcnt(15) lgkmcnt(8)
    v_mfma_f32_16x16x32_bf16 v[36:39], v[80:83], v[100:103], v[36:39]
    v_mfma_f32_16x16x32_bf16 v[40:43], v[84:87], v[100:103], v[40:43]
    ds_read_b64_tr_b16 v[80:81], v10 offset:12288
    ds_read_b64_tr_b16 v[82:83], v10 offset:13312
    v_mfma_f32_16x16x32_bf16 v[44:47], v[88:91], v[100:103], v[44:47]
    ds_read_b64_tr_b16 v[84:85], v11 offset:12288
    ds_read_b64_tr_b16 v[86:87], v11 offset:13312
    v_mfma_f32_16x16x32_bf16 v[48:51], v[92:95], v[100:103], v[48:51]
    ds_read_b64_tr_b16 v[88:89], v12 offset:12288
    ds_read_b64_tr_b16 v[90:91], v12 offset:13312
    ds_read_b64_tr_b16 v[92:93], v13 offset:12288
    ds_read_b64_tr_b16 v[94:95], v13 offset:13312
    buffer_load_dwordx4 v[100:103], v17, s[8:11], s36 offen offset:1024 sc1
    s_waitcnt vmcnt(15) lgkmcnt(8)
    s_barrier
    v_mfma_f32_16x16x32_bf16 v[36:39], v[64:67], v[104:107], v[36:39]
    v_mfma_f32_16x16x32_bf16 v[40:43], v[68:71], v[104:107], v[40:43]
    ds_read_b64_tr_b16 v[64:65], v10 offset:16384
    ds_read_b64_tr_b16 v[66:67], v10 offset:17408
    v_mfma_f32_16x16x32_bf16 v[44:47], v[72:75], v[104:107], v[44:47]
    ds_read_b64_tr_b16 v[68:69], v11 offset:16384
    ds_read_b64_tr_b16 v[70:71], v11 offset:17408
    v_mfma_f32_16x16x32_bf16 v[48:51], v[76:79], v[104:107], v[48:51]
    ds_read_b64_tr_b16 v[72:73], v12 offset:16384
    ds_read_b64_tr_b16 v[74:75], v12 offset:17408
    ds_read_b64_tr_b16 v[76:77], v13 offset:16384
    ds_read_b64_tr_b16 v[78:79], v13 offset:17408
    buffer_load_dwordx4 v[104:107], v17, s[8:11], s36 offen offset:2048 sc1
    s_waitcnt vmcnt(15) lgkmcnt(8)
    v_mfma_f32_16x16x32_bf16 v[36:39], v[80:83], v[108:111], v[36:39]
    v_mfma_f32_16x16x32_bf16 v[40:43], v[84:87], v[108:111], v[40:43]
    ds_read_b64_tr_b16 v[80:81], v10 offset:20480
    ds_read_b64_tr_b16 v[82:83], v10 offset:21504
    v_mfma_f32_16x16x32_bf16 v[44:47], v[88:91], v[108:111], v[44:47]
    ds_read_b64_tr_b16 v[84:85], v11 offset:20480
    ds_read_b64_tr_b16 v[86:87], v11 offset:21504
    v_mfma_f32_16x16x32_bf16 v[48:51], v[92:95], v[108:111], v[48:51]
    ds_read_b64_tr_b16 v[88:89], v12 offset:20480
    ds_read_b64_tr_b16 v[90:91], v12 offset:21504
    ds_read_b64_tr_b16 v[92:93], v13 offset:20480
    ds_read_b64_tr_b16 v[94:95], v13 offset:21504
    buffer_load_dwordx4 v[108:111], v17, s[8:11], s36 offen offset:3072 sc1
    s_add_u32 s36, s36, 4096
    s_cmp_eq_u32 s36, 57344
    s_cselect_b32 s36, 0, s36
    s_waitcnt vmcnt(15) lgkmcnt(8)
    v_mfma_f32_16x16x32_bf16 v[36:39], v[64:67], v[112:115], v[36:39]
    v_mfma_f32_16x16x32_bf16 v[40:43], v[68:71], v[112:115], v[40:43]
    ds_read_b64_tr_b16 v[64:65], v10 offset:24576
    ds_read_b64_tr_b16 v[66:67], v10 offset:25600
    v_mfma_f32_16x16x32_bf16 v[44:47], v[72:75], v[112:115], v[44:47]
    ds_read_b64_tr_b16 v[68:69], v11 offset:24576
    ds_read_b64_tr_b16 v[70:71], v11 offset:25600
    v_mfma_f32_16x16x32_bf16 v[48:51], v[76:79], v[112:115], v[48:51]
    ds_read_b64_tr_b16 v[72:73], v12 offset:24576
    ds_read_b64_tr_b16 v[74:75], v12 offset:25600
    ds_read_b64_tr_b16 v[76:77], v13 offset:24576
    ds_read_b64_tr_b16 v[78:79], v13 offset:25600
    buffer_load_dwordx4 v[112:115], v17, s[8:11], s36 offen offset:0 sc1
    s_waitcnt vmcnt(15) lgkmcnt(8)
    v_mfma_f32_16x16x32_bf16 v[36:39], v[80:83], v[116:119], v[36:39]
    v_mfma_f32_16x16x32_bf16 v[40:43], v[84:87], v[116:119], v[40:43]
    ds_read_b64_tr_b16 v[80:81], v10 offset:28672
    ds_read_b64_tr_b16 v[82:83], v10 offset:29696
    v_mfma_f32_16x16x32_bf16 v[44:47], v[88:91], v[116:119], v[44:47]
    ds_read_b64_tr_b16 v[84:85], v11 offset:28672
    ds_read_b64_tr_b16 v[86:87], v11 offset:29696
    v_mfma_f32_16x16x32_bf16 v[48:51], v[92:95], v[116:119], v[48:51]
    ds_read_b64_tr_b16 v[88:89], v12 offset:28672
    ds_read_b64_tr_b16 v[90:91], v12 offset:29696
    ds_read_b64_tr_b16 v[92:93], v13 offset:28672
    ds_read_b64_tr_b16 v[94:95], v13 offset:29696
    buffer_load_dwordx4 v[116:119], v17, s[8:11], s36 offen offset:1024 sc1
    s_waitcnt vmcnt(15) lgkmcnt(8)
    s_barrier
    v_add_u32 v10, 32768, v10
    v_add_u32 v11, 32768, v11
    v_add_u32 v12, 32768, v12
    v_add_u32 v13, 32768, v13
    v_mfma_f32_16x16x32_bf16 v[36:39], v[64:67], v[120:123], v[36:39]
    v_mfma_f32_16x16x32_bf16 v[40:43], v[68:71], v[120:123], v[40:43]
    ds_read_b64_tr_b16 v[64:65], v10 offset:0
    ds_read_b64_tr_b16 v[66:67], v10 offset:1024
    v_mfma_f32_16x16x32_bf16 v[44:47], v[72:75], v[120:123], v[44:47]
    ds_read_b64_tr_b16 v[68:69], v11 offset:0
    ds_read_b64_tr_b16 v[70:71], v11 offset:1024
    v_mfma_f32_16x16x32_bf16 v[48:51], v[76:79], v[120:123], v[48:51]
    ds_read_b64_tr_b16 v[72:73], v12 offset:0
    ds_read_b64_tr_b16 v[74:75], v12 offset:1024
    ds_read_b64_tr_b16 v[76:77], v13 offset:0
    ds_read_b64_tr_b16 v[78:79], v13 offset:1024
    buffer_load_dwordx4 v[120:123], v17, s[8:11], s36 offen offset:2048 sc1
    s_waitcnt vmcnt(15) lgkmcnt(8)
    v_mfma_f32_16x16x32_bf16 v[36:39], v[80:83], v[124:127], v[36:39]
    v_mfma_f32_16x16x32_bf16 v[40:43], v[84:87], v[124:127], v[40:43]
    ds_read_b64_tr_b16 v[80:81], v10 offset:4096
    ds_read_b64_tr_b16 v[82:83], v10 offset:5120
    v_mfma_f32_16x16x32_bf16 v[44:47], v[88:91], v[124:127], v[44:47]
    ds_read_b64_tr_b16 v[84:85], v11 offset:4096
    ds_read_b64_tr_b16 v[86:87], v11 offset:5120
    v_mfma_f32_16x16x32_bf16 v[48:51], v[92:95], v[124:127], v[48:51]
    ds_read_b64_tr_b16 v[88:89], v12 offset:4096
    ds_read_b64_tr_b16 v[90:91], v12 offset:5120
    ds_read_b64_tr_b16 v[92:93], v13 offset:4096
    ds_read_b64_tr_b16 v[94:95], v13 offset:5120
    buffer_load_dwordx4 v[124:127], v17, s[8:11], s36 offen offset:3072 sc1
    s_add_u32 s36, s36, 4096
    s_cmp_eq_u32 s36, 57344
    s_cselect_b32 s36, 0, s36
    s_waitcnt vmcnt(15) lgkmcnt(8)
    v_mfma_f32_16x16x32_bf16 v[36:39], v[64:67], v[128:131], v[36:39]
    v_mfma_f32_16x16x32_bf16 v[40:43], v[68:71], v[128:131], v[40:43]
    ds_read_b64_tr_b16 v[64:65], v10 offset:8192
    ds_read_b64_tr_b16 v[66:67], v10 offset:9216
    v_mfma_f32_16x16x32_bf16 v[44:47], v[72:75], v[128:131], v[44:47]
    ds_read_b64_tr_b16 v[68:69], v11 offset:8192
    ds_read_b64_tr_b16 v[70:71], v11 offset:9216
    v_mfma_f32_16x16x32_bf16 v[48:51], v[76:79], v[128:131], v[48:51]
    ds_read_b64_tr_b16 v[72:73], v12 offset:8192
    ds_read_b64_tr_b16 v[74:75], v12 offset:9216
    ds_read_b64_tr_b16 v[76:77], v13 offset:8192
    ds_read_b64_tr_b16 v[78:79], v13 offset:9216
    buffer_load_dwordx4 v[128:131], v17, s[8:11], s36 offen offset:0 sc1
    s_waitcnt vmcnt(15) lgkmcnt(8)
    v_mfma_f32_16x16x32_bf16 v[36:39], v[80:83], v[132:135], v[36:39]
    v_mfma_f32_16x16x32_bf16 v[40:43], v[84:87], v[132:135], v[40:43]
    ds_read_b64_tr_b16 v[80:81], v10 offset:12288
    ds_read_b64_tr_b16 v[82:83], v10 offset:13312
    v_mfma_f32_16x16x32_bf16 v[44:47], v[88:91], v[132:135], v[44:47]
    ds_read_b64_tr_b16 v[84:85], v11 offset:12288
    ds_read_b64_tr_b16 v[86:87], v11 offset:13312
    v_mfma_f32_16x16x32_bf16 v[48:51], v[92:95], v[132:135], v[48:51]
    ds_read_b64_tr_b16 v[88:89], v12 offset:12288
    ds_read_b64_tr_b16 v[90:91], v12 offset:13312
    ds_read_b64_tr_b16 v[92:93], v13 offset:12288
    ds_read_b64_tr_b16 v[94:95], v13 offset:13312
    buffer_load_dwordx4 v[132:135], v17, s[8:11], s36 offen offset:1024 sc1
    s_waitcnt vmcnt(15) lgkmcnt(8)
    s_barrier
    v_mfma_f32_16x16x32_bf16 v[36:39], v[64:67], v[136:139], v[36:39]
    v_mfma_f32_16x16x32_bf16 v[40:43], v[68:71], v[136:139], v[40:43]
    ds_read_b64_tr_b16 v[64:65], v10 offset:16384
    ds_read_b64_tr_b16 v[66:67], v10 offset:17408
    v_mfma_f32_16x16x32_bf16 v[44:47], v[72:75], v[136:139], v[44:47]
    ds_read_b64_tr_b16 v[68:69], v11 offset:16384
    ds_read_b64_tr_b16 v[70:71], v11 offset:17408
    v_mfma_f32_16x16x32_bf16 v[48:51], v[76:79], v[136:139], v[48:51]
    ds_read_b64_tr_b16 v[72:73], v12 offset:16384
    ds_read_b64_tr_b16 v[74:75], v12 offset:17408
    ds_read_b64_tr_b16 v[76:77], v13 offset:16384
    ds_read_b64_tr_b16 v[78:79], v13 offset:17408
    buffer_load_dwordx4 v[136:139], v17, s[8:11], s36 offen offset:2048 sc1
    s_waitcnt vmcnt(15) lgkmcnt(8)
    v_mfma_f32_16x16x32_bf16 v[36:39], v[80:83], v[140:143], v[36:39]
    v_mfma_f32_16x16x32_bf16 v[40:43], v[84:87], v[140:143], v[40:43]
    ds_read_b64_tr_b16 v[80:81], v10 offset:20480
    ds_read_b64_tr_b16 v[82:83], v10 offset:21504
    v_mfma_f32_16x16x32_bf16 v[44:47], v[88:91], v[140:143], v[44:47]
    ds_read_b64_tr_b16 v[84:85], v11 offset:20480
    ds_read_b64_tr_b16 v[86:87], v11 offset:21504
    v_mfma_f32_16x16x32_bf16 v[48:51], v[92:95], v[140:143], v[48:51]
    ds_read_b64_tr_b16 v[88:89], v12 offset:20480
    ds_read_b64_tr_b16 v[90:91], v12 offset:21504
    ds_read_b64_tr_b16 v[92:93], v13 offset:20480
    ds_read_b64_tr_b16 v[94:95], v13 offset:21504
    buffer_load_dwordx4 v[140:143], v17, s[8:11], s36 offen offset:3072 sc1
    s_add_u32 s36, s36, 4096
    s_cmp_eq_u32 s36, 57344
    s_cselect_b32 s36, 0, s36
    s_waitcnt vmcnt(15) lgkmcnt(8)
    v_mfma_f32_16x16x32_bf16 v[36:39], v[64:67], v[144:147], v[36:39]
    v_mfma_f32_16x16x32_bf16 v[40:43], v[68:71], v[144:147], v[40:43]
    ds_read_b64_tr_b16 v[64:65], v10 offset:24576
    ds_read_b64_tr_b16 v[66:67], v10 offset:25600
    v_mfma_f32_16x16x32_bf16 v[44:47], v[72:75], v[144:147], v[44:47]
    ds_read_b64_tr_b16 v[68:69], v11 offset:24576
    ds_read_b64_tr_b16 v[70:71], v11 offset:25600
    v_mfma_f32_16x16x32_bf16 v[48:51], v[76:79], v[144:147], v[48:51]
    ds_read_b64_tr_b16 v[72:73], v12 offset:24576
    ds_read_b64_tr_b16 v[74:75], v12 offset:25600
    ds_read_b64_tr_b16 v[76:77], v13 offset:24576
    ds_read_b64_tr_b16 v[78:79], v13 offset:25600
    buffer_load_dwordx4 v[144:147], v17, s[8:11], s36 offen offset:0 sc1
    s_waitcnt vmcnt(15) lgkmcnt(8)
    v_mfma_f32_16x16x32_bf16 v[36:39], v[80:83], v[148:151], v[36:39]
    v_mfma_f32_16x16x32_bf16 v[40:43], v[84:87], v[148:151], v[40:43]
    ds_read_b64_tr_b16 v[80:81], v10 offset:28672
    ds_read_b64_tr_b16 v[82:83], v10 offset:29696
    v_mfma_f32_16x16x32_bf16 v[44:47], v[88:91], v[148:151], v[44:47]
    ds_read_b64_tr_b16 v[84:85], v11 offset:28672
    ds_read_b64_tr_b16 v[86:87], v11 offset:29696
    v_mfma_f32_16x16x32_bf16 v[48:51], v[92:95], v[148:151], v[48:51]
    ds_read_b64_tr_b16 v[88:89], v12 offset:28672
    ds_read_b64_tr_b16 v[90:91], v12 offset:29696
    ds_read_b64_tr_b16 v[92:93], v13 offset:28672
    ds_read_b64_tr_b16 v[94:95], v13 offset:29696
    buffer_load_dwordx4 v[148:151], v17, s[8:11], s36 offen offset:1024 sc1
    s_waitcnt vmcnt(15) lgkmcnt(8)
    s_barrier
    v_add_u32 v10, 32768, v10
    v_add_u32 v11, 32768, v11
    v_add_u32 v12, 32768, v12
    v_add_u32 v13, 32768, v13
    v_mfma_f32_16x16x32_bf16 v[36:39], v[64:67], v[152:155], v[36:39]
    v_mfma_f32_16x16x32_bf16 v[40:43], v[68:71], v[152:155], v[40:43]
    ds_read_b64_tr_b16 v[64:65], v10 offset:0
    ds_read_b64_tr_b16 v[66:67], v10 offset:1024
    v_mfma_f32_16x16x32_bf16 v[44:47], v[72:75], v[152:155], v[44:47]
    ds_read_b64_tr_b16 v[68:69], v11 offset:0
    ds_read_b64_tr_b16 v[70:71], v11 offset:1024
    v_mfma_f32_16x16x32_bf16 v[48:51], v[76:79], v[152:155], v[48:51]
    ds_read_b64_tr_b16 v[72:73], v12 offset:0
    ds_read_b64_tr_b16 v[74:75], v12 offset:1024
    ds_read_b64_tr_b16 v[76:77], v13 offset:0
    ds_read_b64_tr_b16 v[78:79], v13 offset:1024
    buffer_load_dwordx4 v[152:155], v17, s[8:11], s36 offen offset:2048 sc1
    s_waitcnt vmcnt(15) lgkmcnt(8)
    v_mfma_f32_16x16x32_bf16 v[36:39], v[80:83], v[156:159], v[36:39]
    v_mfma_f32_16x16x32_bf16 v[40:43], v[84:87], v[156:159], v[40:43]
    ds_read_b64_tr_b16 v[80:81], v10 offset:4096
    ds_read_b64_tr_b16 v[82:83], v10 offset:5120
    v_mfma_f32_16x16x32_bf16 v[44:47], v[88:91], v[156:159], v[44:47]
    ds_read_b64_tr_b16 v[84:85], v11 offset:4096
    ds_read_b64_tr_b16 v[86:87], v11 offset:5120
    v_mfma_f32_16x16x32_bf16 v[48:51], v[92:95], v[156:159], v[48:51]
    ds_read_b64_tr_b16 v[88:89], v12 offset:4096
    ds_read_b64_tr_b16 v[90:91], v12 offset:5120
    ds_read_b64_tr_b16 v[92:93], v13 offset:4096
    ds_read_b64_tr_b16 v[94:95], v13 offset:5120
    buffer_load_dwordx4 v[156:159], v17, s[8:11], s36 offen offset:3072 sc1
    s_add_u32 s36, s36, 4096
    s_cmp_eq_u32 s36, 57344
    s_cselect_b32 s36, 0, s36
    s_waitcnt vmcnt(15) lgkmcnt(8)
    v_mfma_f32_16x16x32_bf16 v[36:39], v[64:67], v[96:99], v[36:39]
    v_mfma_f32_16x16x32_bf16 v[40:43], v[68:71], v[96:99], v[40:43]
    ds_read_b64_tr_b16 v[64:65], v10 offset:8192
    ds_read_b64_tr_b16 v[66:67], v10 offset:9216
    v_mfma_f32_16x16x32_bf16 v[44:47], v[72:75], v[96:99], v[44:47]
    ds_read_b64_tr_b16 v[68:69], v11 offset:8192
    ds_read_b64_tr_b16 v[70:71], v11 offset:9216
    v_mfma_f32_16x16x32_bf16 v[48:51], v[76:79], v[96:99], v[48:51]
    ds_read_b64_tr_b16 v[72:73], v12 offset:8192
    ds_read_b64_tr_b16 v[74:75], v12 offset:9216
    ds_read_b64_tr_b16 v[76:77], v13 offset:8192
    ds_read_b64_tr_b16 v[78:79], v13 offset:9216
    buffer_load_dwordx4 v[96:99], v17, s[8:11], s36 offen offset:0 sc1
    s_waitcnt vmcnt(15) lgkmcnt(8)
    v_mfma_f32_16x16x32_bf16 v[36:39], v[80:83], v[100:103], v[36:39]
    v_mfma_f32_16x16x32_bf16 v[40:43], v[84:87], v[100:103], v[40:43]
    ds_read_b64_tr_b16 v[80:81], v10 offset:12288
    ds_read_b64_tr_b16 v[82:83], v10 offset:13312
    v_mfma_f32_16x16x32_bf16 v[44:47], v[88:91], v[100:103], v[44:47]
    ds_read_b64_tr_b16 v[84:85], v11 offset:12288
    ds_read_b64_tr_b16 v[86:87], v11 offset:13312
    v_mfma_f32_16x16x32_bf16 v[48:51], v[92:95], v[100:103], v[48:51]
    ds_read_b64_tr_b16 v[88:89], v12 offset:12288
    ds_read_b64_tr_b16 v[90:91], v12 offset:13312
    ds_read_b64_tr_b16 v[92:93], v13 offset:12288
    ds_read_b64_tr_b16 v[94:95], v13 offset:13312
    buffer_load_dwordx4 v[100:103], v17, s[8:11], s36 offen offset:1024 sc1
    s_waitcnt vmcnt(15) lgkmcnt(8)
    s_barrier
    v_mfma_f32_16x16x32_bf16 v[36:39], v[64:67], v[104:107], v[36:39]
    v_mfma_f32_16x16x32_bf16 v[40:43], v[68:71], v[104:107], v[40:43]
    ds_read_b64_tr_b16 v[64:65], v10 offset:16384
    ds_read_b64_tr_b16 v[66:67], v10 offset:17408
    v_mfma_f32_16x16x32_bf16 v[44:47], v[72:75], v[104:107], v[44:47]
    ds_read_b64_tr_b16 v[68:69], v11 offset:16384
    ds_read_b64_tr_b16 v[70:71], v11 offset:17408
    v_mfma_f32_16x16x32_bf16 v[48:51], v[76:79], v[104:107], v[48:51]
    ds_read_b64_tr_b16 v[72:73], v12 offset:16384
    ds_read_b64_tr_b16 v[74:75], v12 offset:17408
    ds_read_b64_tr_b16 v[76:77], v13 offset:16384
    ds_read_b64_tr_b16 v[78:79], v13 offset:17408
    buffer_load_dwordx4 v[104:107], v17, s[8:11], s36 offen offset:2048 sc1
    s_waitcnt vmcnt(15) lgkmcnt(8)
    v_mfma_f32_16x16x32_bf16 v[36:39], v[80:83], v[108:111], v[36:39]
    v_mfma_f32_16x16x32_bf16 v[40:43], v[84:87], v[108:111], v[40:43]
    ds_read_b64_tr_b16 v[80:81], v10 offset:20480
    ds_read_b64_tr_b16 v[82:83], v10 offset:21504
    v_mfma_f32_16x16x32_bf16 v[44:47], v[88:91], v[108:111], v[44:47]
    ds_read_b64_tr_b16 v[84:85], v11 offset:20480
    ds_read_b64_tr_b16 v[86:87], v11 offset:21504
    v_mfma_f32_16x16x32_bf16 v[48:51], v[92:95], v[108:111], v[48:51]
    ds_read_b64_tr_b16 v[88:89], v12 offset:20480
    ds_read_b64_tr_b16 v[90:91], v12 offset:21504
    ds_read_b64_tr_b16 v[92:93], v13 offset:20480
    ds_read_b64_tr_b16 v[94:95], v13 offset:21504
    buffer_load_dwordx4 v[108:111], v17, s[8:11], s36 offen offset:3072 sc1
    s_add_u32 s36, s36, 4096
    s_cmp_eq_u32 s36, 57344
    s_cselect_b32 s36, 0, s36
    s_waitcnt vmcnt(15) lgkmcnt(8)
    v_mfma_f32_16x16x32_bf16 v[36:39], v[64:67], v[112:115], v[36:39]
    v_mfma_f32_16x16x32_bf16 v[40:43], v[68:71], v[112:115], v[40:43]
    ds_read_b64_tr_b16 v[64:65], v10 offset:24576
    ds_read_b64_tr_b16 v[66:67], v10 offset:25600
    v_mfma_f32_16x16x32_bf16 v[44:47], v[72:75], v[112:115], v[44:47]
    ds_read_b64_tr_b16 v[68:69], v11 offset:24576
    ds_read_b64_tr_b16 v[70:71], v11 offset:25600
    v_mfma_f32_16x16x32_bf16 v[48:51], v[76:79], v[112:115], v[48:51]
    ds_read_b64_tr_b16 v[72:73], v12 offset:24576
    ds_read_b64_tr_b16 v[74:75], v12 offset:25600
    ds_read_b64_tr_b16 v[76:77], v13 offset:24576
    ds_read_b64_tr_b16 v[78:79], v13 offset:25600
    buffer_load_dwordx4 v[112:115], v17, s[8:11], s36 offen offset:0 sc1
    s_waitcnt vmcnt(15) lgkmcnt(8)
    v_mfma_f32_16x16x32_bf16 v[36:39], v[80:83], v[116:119], v[36:39]
    v_mfma_f32_16x16x32_bf16 v[40:43], v[84:87], v[116:119], v[40:43]
    ds_read_b64_tr_b16 v[80:81], v10 offset:28672
    ds_read_b64_tr_b16 v[82:83], v10 offset:29696
    v_mfma_f32_16x16x32_bf16 v[44:47], v[88:91], v[116:119], v[44:47]
    ds_read_b64_tr_b16 v[84:85], v11 offset:28672
    ds_read_b64_tr_b16 v[86:87], v11 offset:29696
    v_mfma_f32_16x16x32_bf16 v[48:51], v[92:95], v[116:119], v[48:51]
    ds_read_b64_tr_b16 v[88:89], v12 offset:28672
    ds_read_b64_tr_b16 v[90:91], v12 offset:29696
    ds_read_b64_tr_b16 v[92:93], v13 offset:28672
    ds_read_b64_tr_b16 v[94:95], v13 offset:29696
    buffer_load_dwordx4 v[116:119], v17, s[8:11], s36 offen offset:1024 sc1
    s_waitcnt vmcnt(15) lgkmcnt(8)
    s_barrier
    v_add_u32 v10, 32768, v10
    v_add_u32 v11, 32768, v11
    v_add_u32 v12, 32768, v12
    v_add_u32 v13, 32768, v13
    v_mfma_f32_16x16x32_bf16 v[36:39], v[64:67], v[120:123], v[36:39]
    v_mfma_f32_16x16x32_bf16 v[40:43], v[68:71], v[120:123], v[40:43]
    ds_read_b64_tr_b16 v[64:65], v10 offset:0
    ds_read_b64_tr_b16 v[66:67], v10 offset:1024
    v_mfma_f32_16x16x32_bf16 v[44:47], v[72:75], v[120:123], v[44:47]
    ds_read_b64_tr_b16 v[68:69], v11 offset:0
    ds_read_b64_tr_b16 v[70:71], v11 offset:1024
    v_mfma_f32_16x16x32_bf16 v[48:51], v[76:79], v[120:123], v[48:51]
    ds_read_b64_tr_b16 v[72:73], v12 offset:0
    ds_read_b64_tr_b16 v[74:75], v12 offset:1024
    ds_read_b64_tr_b16 v[76:77], v13 offset:0
    ds_read_b64_tr_b16 v[78:79], v13 offset:1024
    buffer_load_dwordx4 v[120:123], v17, s[8:11], s36 offen offset:2048 sc1
    s_waitcnt vmcnt(15) lgkmcnt(8)
    v_mfma_f32_16x16x32_bf16 v[36:39], v[80:83], v[124:127], v[36:39]
    v_mfma_f32_16x16x32_bf16 v[40:43], v[84:87], v[124:127], v[40:43]
    ds_read_b64_tr_b16 v[80:81], v10 offset:4096
    ds_read_b64_tr_b16 v[82:83], v10 offset:5120
    v_mfma_f32_16x16x32_bf16 v[44:47], v[88:91], v[124:127], v[44:47]
    ds_read_b64_tr_b16 v[84:85], v11 offset:4096
    ds_read_b64_tr_b16 v[86:87], v11 offset:5120
    v_mfma_f32_16x16x32_bf16 v[48:51], v[92:95], v[124:127], v[48:51]
    ds_read_b64_tr_b16 v[88:89], v12 offset:4096
    ds_read_b64_tr_b16 v[90:91], v12 offset:5120
    ds_read_b64_tr_b16 v[92:93], v13 offset:4096
    ds_read_b64_tr_b16 v[94:95], v13 offset:5120
    buffer_load_dwordx4 v[124:127], v17, s[8:11], s36 offen offset:3072 sc1
    s_add_u32 s36, s36, 4096
    s_cmp_eq_u32 s36, 57344
    s_cselect_b32 s36, 0, s36
    s_waitcnt vmcnt(15) lgkmcnt(8)
    v_mfma_f32_16x16x32_bf16 v[36:39], v[64:67], v[128:131], v[36:39]
    v_mfma_f32_16x16x32_bf16 v[40:43], v[68:71], v[128:131], v[40:43]
    ds_read_b64_tr_b16 v[64:65], v10 offset:8192
    ds_read_b64_tr_b16 v[66:67], v10 offset:9216
    v_mfma_f32_16x16x32_bf16 v[44:47], v[72:75], v[128:131], v[44:47]
    ds_read_b64_tr_b16 v[68:69], v11 offset:8192
    ds_read_b64_tr_b16 v[70:71], v11 offset:9216
    v_mfma_f32_16x16x32_bf16 v[48:51], v[76:79], v[128:131], v[48:51]
    ds_read_b64_tr_b16 v[72:73], v12 offset:8192
    ds_read_b64_tr_b16 v[74:75], v12 offset:9216
    ds_read_b64_tr_b16 v[76:77], v13 offset:8192
    ds_read_b64_tr_b16 v[78:79], v13 offset:9216
    buffer_load_dwordx4 v[128:131], v17, s[8:11], s36 offen offset:0 sc1
    s_waitcnt vmcnt(15) lgkmcnt(8)
    v_mfma_f32_16x16x32_bf16 v[36:39], v[80:83], v[132:135], v[36:39]
    v_mfma_f32_16x16x32_bf16 v[40:43], v[84:87], v[132:135], v[40:43]
    ds_read_b64_tr_b16 v[80:81], v10 offset:12288
    ds_read_b64_tr_b16 v[82:83], v10 offset:13312
    v_mfma_f32_16x16x32_bf16 v[44:47], v[88:91], v[132:135], v[44:47]
    ds_read_b64_tr_b16 v[84:85], v11 offset:12288
    ds_read_b64_tr_b16 v[86:87], v11 offset:13312
    v_mfma_f32_16x16x32_bf16 v[48:51], v[92:95], v[132:135], v[48:51]
    ds_read_b64_tr_b16 v[88:89], v12 offset:12288
    ds_read_b64_tr_b16 v[90:91], v12 offset:13312
    ds_read_b64_tr_b16 v[92:93], v13 offset:12288
    ds_read_b64_tr_b16 v[94:95], v13 offset:13312
    buffer_load_dwordx4 v[132:135], v17, s[8:11], s36 offen offset:1024 sc1
    s_waitcnt vmcnt(15) lgkmcnt(8)
    s_barrier
    v_mfma_f32_16x16x32_bf16 v[36:39], v[64:67], v[136:139], v[36:39]
    v_mfma_f32_16x16x32_bf16 v[40:43], v[68:71], v[136:139], v[40:43]
    ds_read_b64_tr_b16 v[64:65], v10 offset:16384
    ds_read_b64_tr_b16 v[66:67], v10 offset:17408
    v_mfma_f32_16x16x32_bf16 v[44:47], v[72:75], v[136:139], v[44:47]
    ds_read_b64_tr_b16 v[68:69], v11 offset:16384
    ds_read_b64_tr_b16 v[70:71], v11 offset:17408
    v_mfma_f32_16x16x32_bf16 v[48:51], v[76:79], v[136:139], v[48:51]
    ds_read_b64_tr_b16 v[72:73], v12 offset:16384
    ds_read_b64_tr_b16 v[74:75], v12 offset:17408
    ds_read_b64_tr_b16 v[76:77], v13 offset:16384
    ds_read_b64_tr_b16 v[78:79], v13 offset:17408
    buffer_load_dwordx4 v[136:139], v17, s[8:11], s36 offen offset:2048 sc1
    s_waitcnt vmcnt(15) lgkmcnt(8)
    v_mfma_f32_16x16x32_bf16 v[36:39], v[80:83], v[140:143], v[36:39]
    v_mfma_f32_16x16x32_bf16 v[40:43], v[84:87], v[140:143], v[40:43]
    ds_read_b64_tr_b16 v[80:81], v10 offset:20480
    ds_read_b64_tr_b16 v[82:83], v10 offset:21504
    v_mfma_f32_16x16x32_bf16 v[44:47], v[88:91], v[140:143], v[44:47]
    ds_read_b64_tr_b16 v[84:85], v11 offset:20480
    ds_read_b64_tr_b16 v[86:87], v11 offset:21504
    v_mfma_f32_16x16x32_bf16 v[48:51], v[92:95], v[140:143], v[48:51]
    ds_read_b64_tr_b16 v[88:89], v12 offset:20480
    ds_read_b64_tr_b16 v[90:91], v12 offset:21504
    ds_read_b64_tr_b16 v[92:93], v13 offset:20480
    ds_read_b64_tr_b16 v[94:95], v13 offset:21504
    buffer_load_dwordx4 v[140:143], v17, s[8:11], s36 offen offset:3072 sc1
    s_add_u32 s36, s36, 4096
    s_cmp_eq_u32 s36, 57344
    s_cselect_b32 s36, 0, s36
    s_waitcnt vmcnt(15) lgkmcnt(8)
    v_mfma_f32_16x16x32_bf16 v[36:39], v[64:67], v[144:147], v[36:39]
    v_mfma_f32_16x16x32_bf16 v[40:43], v[68:71], v[144:147], v[40:43]
    ds_read_b64_tr_b16 v[64:65], v10 offset:24576
    ds_read_b64_tr_b16 v[66:67], v10 offset:25600
    v_mfma_f32_16x16x32_bf16 v[44:47], v[72:75], v[144:147], v[44:47]
    ds_read_b64_tr_b16 v[68:69], v11 offset:24576
    ds_read_b64_tr_b16 v[70:71], v11 offset:25600
    v_mfma_f32_16x16x32_bf16 v[48:51], v[76:79], v[144:147], v[48:51]
    ds_read_b64_tr_b16 v[72:73], v12 offset:24576
    ds_read_b64_tr_b16 v[74:75], v12 offset:25600
    ds_read_b64_tr_b16 v[76:77], v13 offset:24576
    ds_read_b64_tr_b16 v[78:79], v13 offset:25600
    buffer_load_dwordx4 v[144:147], v17, s[8:11], s36 offen offset:0 sc1
    s_waitcnt vmcnt(15) lgkmcnt(8)
    v_mfma_f32_16x16x32_bf16 v[36:39], v[80:83], v[148:151], v[36:39]
    v_mfma_f32_16x16x32_bf16 v[40:43], v[84:87], v[148:151], v[40:43]
    ds_read_b64_tr_b16 v[80:81], v10 offset:28672
    ds_read_b64_tr_b16 v[82:83], v10 offset:29696
    v_mfma_f32_16x16x32_bf16 v[44:47], v[88:91], v[148:151], v[44:47]
    ds_read_b64_tr_b16 v[84:85], v11 offset:28672
    ds_read_b64_tr_b16 v[86:87], v11 offset:29696
    v_mfma_f32_16x16x32_bf16 v[48:51], v[92:95], v[148:151], v[48:51]
    ds_read_b64_tr_b16 v[88:89], v12 offset:28672
    ds_read_b64_tr_b16 v[90:91], v12 offset:29696
    ds_read_b64_tr_b16 v[92:93], v13 offset:28672
    ds_read_b64_tr_b16 v[94:95], v13 offset:29696
    buffer_load_dwordx4 v[148:151], v17, s[8:11], s36 offen offset:1024 sc1
    s_waitcnt vmcnt(15) lgkmcnt(8)
    s_barrier
    v_subrev_u32 v10, 98304, v10
    v_subrev_u32 v11, 98304, v11
    v_subrev_u32 v12, 98304, v12
    v_subrev_u32 v13, 98304, v13
    v_mfma_f32_16x16x32_bf16 v[36:39], v[64:67], v[152:155], v[36:39]
    v_mfma_f32_16x16x32_bf16 v[40:43], v[68:71], v[152:155], v[40:43]
    ds_read_b64_tr_b16 v[64:65], v10 offset:0
    ds_read_b64_tr_b16 v[66:67], v10 offset:1024
    v_mfma_f32_16x16x32_bf16 v[44:47], v[72:75], v[152:155], v[44:47]
    ds_read_b64_tr_b16 v[68:69], v11 offset:0
    ds_read_b64_tr_b16 v[70:71], v11 offset:1024
    v_mfma_f32_16x16x32_bf16 v[48:51], v[76:79], v[152:155], v[48:51]
    ds_read_b64_tr_b16 v[72:73], v12 offset:0
    ds_read_b64_tr_b16 v[74:75], v12 offset:1024
    ds_read_b64_tr_b16 v[76:77], v13 offset:0
    ds_read_b64_tr_b16 v[78:79], v13 offset:1024
    buffer_load_dwordx4 v[152:155], v17, s[8:11], s36 offen offset:2048 sc1
    s_waitcnt vmcnt(15) lgkmcnt(8)
    v_mfma_f32_16x16x32_bf16 v[36:39], v[80:83], v[156:159], v[36:39]
    v_mfma_f32_16x16x32_bf16 v[40:43], v[84:87], v[156:159], v[40:43]
    ds_read_b64_tr_b16 v[80:81], v10 offset:4096
    ds_read_b64_tr_b16 v[82:83], v10 offset:5120
    v_mfma_f32_16x16x32_bf16 v[44:47], v[88:91], v[156:159], v[44:47]
    ds_read_b64_tr_b16 v[84:85], v11 offset:4096
    ds_read_b64_tr_b16 v[86:87], v11 offset:5120
    v_mfma_f32_16x16x32_bf16 v[48:51], v[92:95], v[156:159], v[48:51]
    ds_read_b64_tr_b16 v[88:89], v12 offset:4096
    ds_read_b64_tr_b16 v[90:91], v12 offset:5120
    ds_read_b64_tr_b16 v[92:93], v13 offset:4096
    ds_read_b64_tr_b16 v[94:95], v13 offset:5120
    buffer_load_dwordx4 v[156:159], v17, s[8:11], s36 offen offset:3072 sc1
    s_add_u32 s36, s36, 4096
    s_cmp_eq_u32 s36, 57344
    s_cselect_b32 s36, 0, s36
    s_waitcnt vmcnt(15) lgkmcnt(8)
    v_mfma_f32_16x16x32_bf16 v[36:39], v[64:67], v[96:99], v[36:39]
    v_mfma_f32_16x16x32_bf16 v[40:43], v[68:71], v[96:99], v[40:43]
    ds_read_b64_tr_b16 v[64:65], v10 offset:8192
    ds_read_b64_tr_b16 v[66:67], v10 offset:9216
    v_mfma_f32_16x16x32_bf16 v[44:47], v[72:75], v[96:99], v[44:47]
    ds_read_b64_tr_b16 v[68:69], v11 offset:8192
    ds_read_b64_tr_b16 v[70:71], v11 offset:9216
    v_mfma_f32_16x16x32_bf16 v[48:51], v[76:79], v[96:99], v[48:51]
    ds_read_b64_tr_b16 v[72:73], v12 offset:8192
    ds_read_b64_tr_b16 v[74:75], v12 offset:9216
    ds_read_b64_tr_b16 v[76:77], v13 offset:8192
    ds_read_b64_tr_b16 v[78:79], v13 offset:9216
    buffer_load_dwordx4 v[96:99], v17, s[8:11], s36 offen offset:0 sc1
    s_waitcnt vmcnt(15) lgkmcnt(8)
    v_mfma_f32_16x16x32_bf16 v[36:39], v[80:83], v[100:103], v[36:39]
    v_mfma_f32_16x16x32_bf16 v[40:43], v[84:87], v[100:103], v[40:43]
    ds_read_b64_tr_b16 v[80:81], v10 offset:12288
    ds_read_b64_tr_b16 v[82:83], v10 offset:13312
    v_mfma_f32_16x16x32_bf16 v[44:47], v[88:91], v[100:103], v[44:47]
    ds_read_b64_tr_b16 v[84:85], v11 offset:12288
    ds_read_b64_tr_b16 v[86:87], v11 offset:13312
    v_mfma_f32_16x16x32_bf16 v[48:51], v[92:95], v[100:103], v[48:51]
    ds_read_b64_tr_b16 v[88:89], v12 offset:12288
    ds_read_b64_tr_b16 v[90:91], v12 offset:13312
    ds_read_b64_tr_b16 v[92:93], v13 offset:12288
    ds_read_b64_tr_b16 v[94:95], v13 offset:13312
    buffer_load_dwordx4 v[100:103], v17, s[8:11], s36 offen offset:1024 sc1
    s_waitcnt vmcnt(15) lgkmcnt(8)
    s_barrier
    v_mfma_f32_16x16x32_bf16 v[36:39], v[64:67], v[104:107], v[36:39]
    v_mfma_f32_16x16x32_bf16 v[40:43], v[68:71], v[104:107], v[40:43]
    ds_read_b64_tr_b16 v[64:65], v10 offset:16384
    ds_read_b64_tr_b16 v[66:67], v10 offset:17408
    v_mfma_f32_16x16x32_bf16 v[44:47], v[72:75], v[104:107], v[44:47]
    ds_read_b64_tr_b16 v[68:69], v11 offset:16384
    ds_read_b64_tr_b16 v[70:71], v11 offset:17408
    v_mfma_f32_16x16x32_bf16 v[48:51], v[76:79], v[104:107], v[48:51]
    ds_read_b64_tr_b16 v[72:73], v12 offset:16384
    ds_read_b64_tr_b16 v[74:75], v12 offset:17408
    ds_read_b64_tr_b16 v[76:77], v13 offset:16384
    ds_read_b64_tr_b16 v[78:79], v13 offset:17408
    buffer_load_dwordx4 v[104:107], v17, s[8:11], s36 offen offset:2048 sc1
    s_waitcnt vmcnt(15) lgkmcnt(8)
    v_mfma_f32_16x16x32_bf16 v[36:39], v[80:83], v[108:111], v[36:39]
    v_mfma_f32_16x16x32_bf16 v[40:43], v[84:87], v[108:111], v[40:43]
    ds_read_b64_tr_b16 v[80:81], v10 offset:20480
    ds_read_b64_tr_b16 v[82:83], v10 offset:21504
    v_mfma_f32_16x16x32_bf16 v[44:47], v[88:91], v[108:111], v[44:47]
    ds_read_b64_tr_b16 v[84:85], v11 offset:20480
    ds_read_b64_tr_b16 v[86:87], v11 offset:21504
    v_mfma_f32_16x16x32_bf16 v[48:51], v[92:95], v[108:111], v[48:51]
    ds_read_b64_tr_b16 v[88:89], v12 offset:20480
    ds_read_b64_tr_b16 v[90:91], v12 offset:21504
    ds_read_b64_tr_b16 v[92:93], v13 offset:20480
    ds_read_b64_tr_b16 v[94:95], v13 offset:21504
    buffer_load_dwordx4 v[108:111], v17, s[8:11], s36 offen offset:3072 sc1
    s_add_u32 s36, s36, 4096
    s_cmp_eq_u32 s36, 57344
    s_cselect_b32 s36, 0, s36
    s_waitcnt vmcnt(15) lgkmcnt(8)
    v_mfma_f32_16x16x32_bf16 v[36:39], v[64:67], v[112:115], v[36:39]
    v_mfma_f32_16x16x32_bf16 v[40:43], v[68:71], v[112:115], v[40:43]
    ds_read_b64_tr_b16 v[64:65], v10 offset:24576
    ds_read_b64_tr_b16 v[66:67], v10 offset:25600
    v_mfma_f32_16x16x32_bf16 v[44:47], v[72:75], v[112:115], v[44:47]
    ds_read_b64_tr_b16 v[68:69], v11 offset:24576
    ds_read_b64_tr_b16 v[70:71], v11 offset:25600
    v_mfma_f32_16x16x32_bf16 v[48:51], v[76:79], v[112:115], v[48:51]
    ds_read_b64_tr_b16 v[72:73], v12 offset:24576
    ds_read_b64_tr_b16 v[74:75], v12 offset:25600
    ds_read_b64_tr_b16 v[76:77], v13 offset:24576
    ds_read_b64_tr_b16 v[78:79], v13 offset:25600
    buffer_load_dwordx4 v[112:115], v17, s[8:11], s36 offen offset:0 sc1
    s_waitcnt vmcnt(15) lgkmcnt(8)
    v_mfma_f32_16x16x32_bf16 v[36:39], v[80:83], v[116:119], v[36:39]
    v_mfma_f32_16x16x32_bf16 v[40:43], v[84:87], v[116:119], v[40:43]
    ds_read_b64_tr_b16 v[80:81], v10 offset:28672
    ds_read_b64_tr_b16 v[82:83], v10 offset:29696
    v_mfma_f32_16x16x32_bf16 v[44:47], v[88:91], v[116:119], v[44:47]
    ds_read_b64_tr_b16 v[84:85], v11 offset:28672
    ds_read_b64_tr_b16 v[86:87], v11 offset:29696
    v_mfma_f32_16x16x32_bf16 v[48:51], v[92:95], v[116:119], v[48:51]
    ds_read_b64_tr_b16 v[88:89], v12 offset:28672
    ds_read_b64_tr_b16 v[90:91], v12 offset:29696
    ds_read_b64_tr_b16 v[92:93], v13 offset:28672
    ds_read_b64_tr_b16 v[94:95], v13 offset:29696
    buffer_load_dwordx4 v[116:119], v17, s[8:11], s36 offen offset:1024 sc1
    s_waitcnt vmcnt(15) lgkmcnt(8)
    s_barrier
    v_add_u32 v10, 32768, v10
    v_add_u32 v11, 32768, v11
    v_add_u32 v12, 32768, v12
    v_add_u32 v13, 32768, v13
    v_mfma_f32_16x16x32_bf16 v[36:39], v[64:67], v[120:123], v[36:39]
    v_mfma_f32_16x16x32_bf16 v[40:43], v[68:71], v[120:123], v[40:43]
    ds_read_b64_tr_b16 v[64:65], v10 offset:0
    ds_read_b64_tr_b16 v[66:67], v10 offset:1024
    v_mfma_f32_16x16x32_bf16 v[44:47], v[72:75], v[120:123], v[44:47]
    ds_read_b64_tr_b16 v[68:69], v11 offset:0
    ds_read_b64_tr_b16 v[70:71], v11 offset:1024
    v_mfma_f32_16x16x32_bf16 v[48:51], v[76:79], v[120:123], v[48:51]
    ds_read_b64_tr_b16 v[72:73], v12 offset:0
    ds_read_b64_tr_b16 v[74:75], v12 offset:1024
    ds_read_b64_tr_b16 v[76:77], v13 offset:0
    ds_read_b64_tr_b16 v[78:79], v13 offset:1024
    buffer_load_dwordx4 v[120:123], v17, s[8:11], s36 offen offset:2048 sc1
    s_waitcnt vmcnt(15) lgkmcnt(8)
    v_mfma_f32_16x16x32_bf16 v[36:39], v[80:83], v[124:127], v[36:39]
    v_mfma_f32_16x16x32_bf16 v[40:43], v[84:87], v[124:127], v[40:43]
    ds_read_b64_tr_b16 v[80:81], v10 offset:4096
    ds_read_b64_tr_b16 v[82:83], v10 offset:5120
    v_mfma_f32_16x16x32_bf16 v[44:47], v[88:91], v[124:127], v[44:47]
    ds_read_b64_tr_b16 v[84:85], v11 offset:4096
    ds_read_b64_tr_b16 v[86:87], v11 offset:5120
    v_mfma_f32_16x16x32_bf16 v[48:51], v[92:95], v[124:127], v[48:51]
    ds_read_b64_tr_b16 v[88:89], v12 offset:4096
    ds_read_b64_tr_b16 v[90:91], v12 offset:5120
    ds_read_b64_tr_b16 v[92:93], v13 offset:4096
    ds_read_b64_tr_b16 v[94:95], v13 offset:5120
    buffer_load_dwordx4 v[124:127], v17, s[8:11], s36 offen offset:3072 sc1
    s_add_u32 s36, s36, 4096
    s_cmp_eq_u32 s36, 57344
    s_cselect_b32 s36, 0, s36
    s_waitcnt vmcnt(15) lgkmcnt(8)
    v_mfma_f32_16x16x32_bf16 v[36:39], v[64:67], v[128:131], v[36:39]
    v_mfma_f32_16x16x32_bf16 v[40:43], v[68:71], v[128:131], v[40:43]
    ds_read_b64_tr_b16 v[64:65], v10 offset:8192
    ds_read_b64_tr_b16 v[66:67], v10 offset:9216
    v_mfma_f32_16x16x32_bf16 v[44:47], v[72:75], v[128:131], v[44:47]
    ds_read_b64_tr_b16 v[68:69], v11 offset:8192
    ds_read_b64_tr_b16 v[70:71], v11 offset:9216
    v_mfma_f32_16x16x32_bf16 v[48:51], v[76:79], v[128:131], v[48:51]
    ds_read_b64_tr_b16 v[72:73], v12 offset:8192
    ds_read_b64_tr_b16 v[74:75], v12 offset:9216
    ds_read_b64_tr_b16 v[76:77], v13 offset:8192
    ds_read_b64_tr_b16 v[78:79], v13 offset:9216
    s_waitcnt vmcnt(14) lgkmcnt(8)
    v_mfma_f32_16x16x32_bf16 v[36:39], v[80:83], v[132:135], v[36:39]
    v_mfma_f32_16x16x32_bf16 v[40:43], v[84:87], v[132:135], v[40:43]
    ds_read_b64_tr_b16 v[80:81], v10 offset:12288
    ds_read_b64_tr_b16 v[82:83], v10 offset:13312
    v_mfma_f32_16x16x32_bf16 v[44:47], v[88:91], v[132:135], v[44:47]
    ds_read_b64_tr_b16 v[84:85], v11 offset:12288
    ds_read_b64_tr_b16 v[86:87], v11 offset:13312
    v_mfma_f32_16x16x32_bf16 v[48:51], v[92:95], v[132:135], v[48:51]
    ds_read_b64_tr_b16 v[88:89], v12 offset:12288
    ds_read_b64_tr_b16 v[90:91], v12 offset:13312
    ds_read_b64_tr_b16 v[92:93], v13 offset:12288
    ds_read_b64_tr_b16 v[94:95], v13 offset:13312
    s_waitcnt vmcnt(13) lgkmcnt(8)
    s_barrier
    v_mfma_f32_16x16x32_bf16 v[36:39], v[64:67], v[136:139], v[36:39]
    v_mfma_f32_16x16x32_bf16 v[40:43], v[68:71], v[136:139], v[40:43]
    ds_read_b64_tr_b16 v[64:65], v10 offset:16384
    ds_read_b64_tr_b16 v[66:67], v10 offset:17408
    v_mfma_f32_16x16x32_bf16 v[44:47], v[72:75], v[136:139], v[44:47]
    ds_read_b64_tr_b16 v[68:69], v11 offset:16384
    ds_read_b64_tr_b16 v[70:71], v11 offset:17408
    v_mfma_f32_16x16x32_bf16 v[48:51], v[76:79], v[136:139], v[48:51]
    ds_read_b64_tr_b16 v[72:73], v12 offset:16384
    ds_read_b64_tr_b16 v[74:75], v12 offset:17408
    ds_read_b64_tr_b16 v[76:77], v13 offset:16384
    ds_read_b64_tr_b16 v[78:79], v13 offset:17408
    s_waitcnt vmcnt(12) lgkmcnt(8)
    v_mfma_f32_16x16x32_bf16 v[36:39], v[80:83], v[140:143], v[36:39]
    v_mfma_f32_16x16x32_bf16 v[40:43], v[84:87], v[140:143], v[40:43]
    ds_read_b64_tr_b16 v[80:81], v10 offset:20480
    ds_read_b64_tr_b16 v[82:83], v10 offset:21504
    v_mfma_f32_16x16x32_bf16 v[44:47], v[88:91], v[140:143], v[44:47]
    ds_read_b64_tr_b16 v[84:85], v11 offset:20480
    ds_read_b64_tr_b16 v[86:87], v11 offset:21504
    v_mfma_f32_16x16x32_bf16 v[48:51], v[92:95], v[140:143], v[48:51]
    ds_read_b64_tr_b16 v[88:89], v12 offset:20480
    ds_read_b64_tr_b16 v[90:91], v12 offset:21504
    ds_read_b64_tr_b16 v[92:93], v13 offset:20480
    ds_read_b64_tr_b16 v[94:95], v13 offset:21504
    s_waitcnt vmcnt(11) lgkmcnt(8)
    v_mfma_f32_16x16x32_bf16 v[36:39], v[64:67], v[144:147], v[36:39]
    v_mfma_f32_16x16x32_bf16 v[40:43], v[68:71], v[144:147], v[40:43]
    ds_read_b64_tr_b16 v[64:65], v10 offset:24576
    ds_read_b64_tr_b16 v[66:67], v10 offset:25600
    v_mfma_f32_16x16x32_bf16 v[44:47], v[72:75], v[144:147], v[44:47]
    ds_read_b64_tr_b16 v[68:69], v11 offset:24576
    ds_read_b64_tr_b16 v[70:71], v11 offset:25600
    v_mfma_f32_16x16x32_bf16 v[48:51], v[76:79], v[144:147], v[48:51]
    ds_read_b64_tr_b16 v[72:73], v12 offset:24576
    ds_read_b64_tr_b16 v[74:75], v12 offset:25600
    ds_read_b64_tr_b16 v[76:77], v13 offset:24576
    ds_read_b64_tr_b16 v[78:79], v13 offset:25600
    s_waitcnt vmcnt(10) lgkmcnt(8)
    v_mfma_f32_16x16x32_bf16 v[36:39], v[80:83], v[148:151], v[36:39]
    v_mfma_f32_16x16x32_bf16 v[40:43], v[84:87], v[148:151], v[40:43]
    ds_read_b64_tr_b16 v[80:81], v10 offset:28672
    ds_read_b64_tr_b16 v[82:83], v10 offset:29696
    v_mfma_f32_16x16x32_bf16 v[44:47], v[88:91], v[148:151], v[44:47]
    ds_read_b64_tr_b16 v[84:85], v11 offset:28672
    ds_read_b64_tr_b16 v[86:87], v11 offset:29696
    v_mfma_f32_16x16x32_bf16 v[48:51], v[92:95], v[148:151], v[48:51]
    ds_read_b64_tr_b16 v[88:89], v12 offset:28672
    ds_read_b64_tr_b16 v[90:91], v12 offset:29696
    ds_read_b64_tr_b16 v[92:93], v13 offset:28672
    ds_read_b64_tr_b16 v[94:95], v13 offset:29696
    s_waitcnt vmcnt(9) lgkmcnt(8)
    s_barrier
    v_add_u32 v10, 32768, v10
    v_add_u32 v11, 32768, v11
    v_add_u32 v12, 32768, v12
    v_add_u32 v13, 32768, v13
    v_mfma_f32_16x16x32_bf16 v[36:39], v[64:67], v[152:155], v[36:39]
    v_mfma_f32_16x16x32_bf16 v[40:43], v[68:71], v[152:155], v[40:43]
    ds_read_b64_tr_b16 v[64:65], v10 offset:0
    ds_read_b64_tr_b16 v[66:67], v10 offset:1024
    v_mfma_f32_16x16x32_bf16 v[44:47], v[72:75], v[152:155], v[44:47]
    ds_read_b64_tr_b16 v[68:69], v11 offset:0
    ds_read_b64_tr_b16 v[70:71], v11 offset:1024
    v_mfma_f32_16x16x32_bf16 v[48:51], v[76:79], v[152:155], v[48:51]
    ds_read_b64_tr_b16 v[72:73], v12 offset:0
    ds_read_b64_tr_b16 v[74:75], v12 offset:1024
    ds_read_b64_tr_b16 v[76:77], v13 offset:0
    ds_read_b64_tr_b16 v[78:79], v13 offset:1024
    s_waitcnt vmcnt(8) lgkmcnt(8)
    v_mfma_f32_16x16x32_bf16 v[36:39], v[80:83], v[156:159], v[36:39]
    v_mfma_f32_16x16x32_bf16 v[40:43], v[84:87], v[156:159], v[40:43]
    ds_read_b64_tr_b16 v[80:81], v10 offset:4096
    ds_read_b64_tr_b16 v[82:83], v10 offset:5120
    v_mfma_f32_16x16x32_bf16 v[44:47], v[88:91], v[156:159], v[44:47]
    ds_read_b64_tr_b16 v[84:85], v11 offset:4096
    ds_read_b64_tr_b16 v[86:87], v11 offset:5120
    v_mfma_f32_16x16x32_bf16 v[48:51], v[92:95], v[156:159], v[48:51]
    ds_read_b64_tr_b16 v[88:89], v12 offset:4096
    ds_read_b64_tr_b16 v[90:91], v12 offset:5120
    ds_read_b64_tr_b16 v[92:93], v13 offset:4096
    ds_read_b64_tr_b16 v[94:95], v13 offset:5120
    s_waitcnt vmcnt(7) lgkmcnt(8)
    v_mfma_f32_16x16x32_bf16 v[36:39], v[64:67], v[96:99], v[36:39]
    v_mfma_f32_16x16x32_bf16 v[40:43], v[68:71], v[96:99], v[40:43]
    ds_read_b64_tr_b16 v[64:65], v10 offset:8192
    ds_read_b64_tr_b16 v[66:67], v10 offset:9216
    v_mfma_f32_16x16x32_bf16 v[44:47], v[72:75], v[96:99], v[44:47]
    ds_read_b64_tr_b16 v[68:69], v11 offset:8192
    ds_read_b64_tr_b16 v[70:71], v11 offset:9216
    v_mfma_f32_16x16x32_bf16 v[48:51], v[76:79], v[96:99], v[48:51]
    ds_read_b64_tr_b16 v[72:73], v12 offset:8192
    ds_read_b64_tr_b16 v[74:75], v12 offset:9216
    ds_read_b64_tr_b16 v[76:77], v13 offset:8192
    ds_read_b64_tr_b16 v[78:79], v13 offset:9216
    s_waitcnt vmcnt(6) lgkmcnt(8)
    v_mfma_f32_16x16x32_bf16 v[36:39], v[80:83], v[100:103], v[36:39]
    v_mfma_f32_16x16x32_bf16 v[40:43], v[84:87], v[100:103], v[40:43]
    ds_read_b64_tr_b16 v[80:81], v10 offset:12288
    ds_read_b64_tr_b16 v[82:83], v10 offset:13312
    v_mfma_f32_16x16x32_bf16 v[44:47], v[88:91], v[100:103], v[44:47]
    ds_read_b64_tr_b16 v[84:85], v11 offset:12288
    ds_read_b64_tr_b16 v[86:87], v11 offset:13312
    v_mfma_f32_16x16x32_bf16 v[48:51], v[92:95], v[100:103], v[48:51]
    ds_read_b64_tr_b16 v[88:89], v12 offset:12288
    ds_read_b64_tr_b16 v[90:91], v12 offset:13312
    ds_read_b64_tr_b16 v[92:93], v13 offset:12288
    ds_read_b64_tr_b16 v[94:95], v13 offset:13312
    s_waitcnt vmcnt(5) lgkmcnt(8)
    s_barrier
    v_mfma_f32_16x16x32_bf16 v[36:39], v[64:67], v[104:107], v[36:39]
    v_mfma_f32_16x16x32_bf16 v[40:43], v[68:71], v[104:107], v[40:43]
    ds_read_b64_tr_b16 v[64:65], v10 offset:16384
    ds_read_b64_tr_b16 v[66:67], v10 offset:17408
    v_mfma_f32_16x16x32_bf16 v[44:47], v[72:75], v[104:107], v[44:47]
    ds_read_b64_tr_b16 v[68:69], v11 offset:16384
    ds_read_b64_tr_b16 v[70:71], v11 offset:17408
    v_mfma_f32_16x16x32_bf16 v[48:51], v[76:79], v[104:107], v[48:51]
    ds_read_b64_tr_b16 v[72:73], v12 offset:16384
    ds_read_b64_tr_b16 v[74:75], v12 offset:17408
    ds_read_b64_tr_b16 v[76:77], v13 offset:16384
    ds_read_b64_tr_b16 v[78:79], v13 offset:17408
    s_waitcnt vmcnt(4) lgkmcnt(8)
    v_mfma_f32_16x16x32_bf16 v[36:39], v[80:83], v[108:111], v[36:39]
    v_mfma_f32_16x16x32_bf16 v[40:43], v[84:87], v[108:111], v[40:43]
    ds_read_b64_tr_b16 v[80:81], v10 offset:20480
    ds_read_b64_tr_b16 v[82:83], v10 offset:21504
    v_mfma_f32_16x16x32_bf16 v[44:47], v[88:91], v[108:111], v[44:47]
    ds_read_b64_tr_b16 v[84:85], v11 offset:20480
    ds_read_b64_tr_b16 v[86:87], v11 offset:21504
    v_mfma_f32_16x16x32_bf16 v[48:51], v[92:95], v[108:111], v[48:51]
    ds_read_b64_tr_b16 v[88:89], v12 offset:20480
    ds_read_b64_tr_b16 v[90:91], v12 offset:21504
    ds_read_b64_tr_b16 v[92:93], v13 offset:20480
    ds_read_b64_tr_b16 v[94:95], v13 offset:21504
    s_waitcnt vmcnt(3) lgkmcnt(8)
    v_mfma_f32_16x16x32_bf16 v[36:39], v[64:67], v[112:115], v[36:39]
    v_mfma_f32_16x16x32_bf16 v[40:43], v[68:71], v[112:115], v[40:43]
    ds_read_b64_tr_b16 v[64:65], v10 offset:24576
    ds_read_b64_tr_b16 v[66:67], v10 offset:25600
    v_mfma_f32_16x16x32_bf16 v[44:47], v[72:75], v[112:115], v[44:47]
    ds_read_b64_tr_b16 v[68:69], v11 offset:24576
    ds_read_b64_tr_b16 v[70:71], v11 offset:25600
    v_mfma_f32_16x16x32_bf16 v[48:51], v[76:79], v[112:115], v[48:51]
    ds_read_b64_tr_b16 v[72:73], v12 offset:24576
    ds_read_b64_tr_b16 v[74:75], v12 offset:25600
    ds_read_b64_tr_b16 v[76:77], v13 offset:24576
    ds_read_b64_tr_b16 v[78:79], v13 offset:25600
    s_waitcnt vmcnt(2) lgkmcnt(8)
    v_mfma_f32_16x16x32_bf16 v[36:39], v[80:83], v[116:119], v[36:39]
    v_mfma_f32_16x16x32_bf16 v[40:43], v[84:87], v[116:119], v[40:43]
    ds_read_b64_tr_b16 v[80:81], v10 offset:28672
    ds_read_b64_tr_b16 v[82:83], v10 offset:29696
    v_mfma_f32_16x16x32_bf16 v[44:47], v[88:91], v[116:119], v[44:47]
    ds_read_b64_tr_b16 v[84:85], v11 offset:28672
    ds_read_b64_tr_b16 v[86:87], v11 offset:29696
    v_mfma_f32_16x16x32_bf16 v[48:51], v[92:95], v[116:119], v[48:51]
    ds_read_b64_tr_b16 v[88:89], v12 offset:28672
    ds_read_b64_tr_b16 v[90:91], v12 offset:29696
    ds_read_b64_tr_b16 v[92:93], v13 offset:28672
    ds_read_b64_tr_b16 v[94:95], v13 offset:29696
    s_waitcnt vmcnt(1) lgkmcnt(8)
    v_mfma_f32_16x16x32_bf16 v[36:39], v[64:67], v[120:123], v[36:39]
    v_mfma_f32_16x16x32_bf16 v[40:43], v[68:71], v[120:123], v[40:43]
    v_mfma_f32_16x16x32_bf16 v[44:47], v[72:75], v[120:123], v[44:47]
    v_mfma_f32_16x16x32_bf16 v[48:51], v[76:79], v[120:123], v[48:51]
    s_waitcnt vmcnt(0) lgkmcnt(0)
    v_mfma_f32_16x16x32_bf16 v[36:39], v[80:83], v[124:127], v[36:39]
    v_mfma_f32_16x16x32_bf16 v[40:43], v[84:87], v[124:127], v[40:43]
    v_mfma_f32_16x16x32_bf16 v[44:47], v[88:91], v[124:127], v[44:47]
    v_mfma_f32_16x16x32_bf16 v[48:51], v[92:95], v[124:127], v[48:51]
    s_nop 7
    v_cvt_pk_bf16_f32 v64, v36, v37
    v_cvt_pk_bf16_f32 v65, v38, v39
    v_cvt_pk_bf16_f32 v66, v40, v41
    v_cvt_pk_bf16_f32 v67, v42, v43
    v_lshlrev_b32 v36, 16, v64
    v_and_b32 v37, 0xffff0000, v64
    v_lshlrev_b32 v38, 16, v65
    v_and_b32 v39, 0xffff0000, v65
    v_lshlrev_b32 v40, 16, v66
    v_and_b32 v41, 0xffff0000, v66
    v_lshlrev_b32 v42, 16, v67
    v_and_b32 v43, 0xffff0000, v67
    v_lshlrev_b32 v68, 16, v28
    v_and_b32 v69, 0xffff0000, v28
    v_lshlrev_b32 v70, 16, v29
    v_and_b32 v71, 0xffff0000, v29
    v_lshlrev_b32 v72, 16, v30
    v_and_b32 v73, 0xffff0000, v30
    v_lshlrev_b32 v74, 16, v31
    v_and_b32 v75, 0xffff0000, v31
    v_pk_add_f32 v[36:37], v[36:37], v[68:69]
    v_pk_add_f32 v[38:39], v[38:39], v[70:71]
    v_pk_add_f32 v[40:41], v[40:41], v[72:73]
    v_pk_add_f32 v[42:43], v[42:43], v[74:75]
    v_cvt_pk_bf16_f32 v64, v36, v37
    v_cvt_pk_bf16_f32 v65, v38, v39
    v_cvt_pk_bf16_f32 v66, v40, v41
    v_cvt_pk_bf16_f32 v67, v42, v43
    v_lshlrev_b32 v36, 16, v64
    v_and_b32 v37, 0xffff0000, v64
    v_lshlrev_b32 v38, 16, v65
    v_and_b32 v39, 0xffff0000, v65
    v_lshlrev_b32 v40, 16, v66
    v_and_b32 v41, 0xffff0000, v66
    v_lshlrev_b32 v42, 16, v67
    v_and_b32 v43, 0xffff0000, v67
    v_lshlrev_b32 v68, 16, v20
    v_and_b32 v69, 0xffff0000, v20
    v_lshlrev_b32 v70, 16, v21
    v_and_b32 v71, 0xffff0000, v21
    v_lshlrev_b32 v72, 16, v22
    v_and_b32 v73, 0xffff0000, v22
    v_lshlrev_b32 v74, 16, v23
    v_and_b32 v75, 0xffff0000, v23
    v_pk_add_f32 v[36:37], v[36:37], v[68:69]
    v_pk_add_f32 v[38:39], v[38:39], v[70:71]
    v_pk_add_f32 v[40:41], v[40:41], v[72:73]
    v_pk_add_f32 v[42:43], v[42:43], v[74:75]
    v_cvt_pk_bf16_f32 v168, v36, v37
    v_cvt_pk_bf16_f32 v169, v38, v39
    v_cvt_pk_bf16_f32 v170, v40, v41
    v_cvt_pk_bf16_f32 v171, v42, v43
    v_cvt_pk_bf16_f32 v64, v44, v45
    v_cvt_pk_bf16_f32 v65, v46, v47
    v_cvt_pk_bf16_f32 v66, v48, v49
    v_cvt_pk_bf16_f32 v67, v50, v51
    v_lshlrev_b32 v44, 16, v64
    v_and_b32 v45, 0xffff0000, v64
    v_lshlrev_b32 v46, 16, v65
    v_and_b32 v47, 0xffff0000, v65
    v_lshlrev_b32 v48, 16, v66
    v_and_b32 v49, 0xffff0000, v66
    v_lshlrev_b32 v50, 16, v67
    v_and_b32 v51, 0xffff0000, v67
    v_lshlrev_b32 v68, 16, v32
    v_and_b32 v69, 0xffff0000, v32
    v_lshlrev_b32 v70, 16, v33
    v_and_b32 v71, 0xffff0000, v33
    v_lshlrev_b32 v72, 16, v34
    v_and_b32 v73, 0xffff0000, v34
    v_lshlrev_b32 v74, 16, v35
    v_and_b32 v75, 0xffff0000, v35
    v_pk_add_f32 v[44:45], v[44:45], v[68:69]
    v_pk_add_f32 v[46:47], v[46:47], v[70:71]
    v_pk_add_f32 v[48:49], v[48:49], v[72:73]
    v_pk_add_f32 v[50:51], v[50:51], v[74:75]
    v_cvt_pk_bf16_f32 v64, v44, v45
    v_cvt_pk_bf16_f32 v65, v46, v47
    v_cvt_pk_bf16_f32 v66, v48, v49
    v_cvt_pk_bf16_f32 v67, v50, v51
    v_lshlrev_b32 v44, 16, v64
    v_and_b32 v45, 0xffff0000, v64
    v_lshlrev_b32 v46, 16, v65
    v_and_b32 v47, 0xffff0000, v65
    v_lshlrev_b32 v48, 16, v66
    v_and_b32 v49, 0xffff0000, v66
    v_lshlrev_b32 v50, 16, v67
    v_and_b32 v51, 0xffff0000, v67
    v_lshlrev_b32 v68, 16, v24
    v_and_b32 v69, 0xffff0000, v24
    v_lshlrev_b32 v70, 16, v25
    v_and_b32 v71, 0xffff0000, v25
    v_lshlrev_b32 v72, 16, v26
    v_and_b32 v73, 0xffff0000, v26
    v_lshlrev_b32 v74, 16, v27
    v_and_b32 v75, 0xffff0000, v27
    v_pk_add_f32 v[44:45], v[44:45], v[68:69]
    v_pk_add_f32 v[46:47], v[46:47], v[70:71]
    v_pk_add_f32 v[48:49], v[48:49], v[72:73]
    v_pk_add_f32 v[50:51], v[50:51], v[74:75]
    v_cvt_pk_bf16_f32 v172, v44, v45
    v_cvt_pk_bf16_f32 v173, v46, v47
    v_cvt_pk_bf16_f32 v174, v48, v49
    v_cvt_pk_bf16_f32 v175, v50, v51
    s_mul_i32 s21, s3, 2560
    s_add_u32 s21, s21, 131072
    v_and_b32 v64, 15, v2
    v_mul_u32_u24 v64, 144, v64
    v_lshrrev_b32 v65, 4, v2
    v_lshl_add_u32 v64, v65, 3, v64
    v_add_u32 v64, s21, v64
    ds_write_b64 v64, v[168:169] offset:0
    ds_write_b64 v64, v[170:171] offset:32
    ds_write_b64 v64, v[172:173] offset:64
    ds_write_b64 v64, v[174:175] offset:96
    v_lshrrev_b32 v65, 3, v2
    v_and_b32 v66, 7, v2
    v_mul_u32_u24 v64, 144, v65
    v_lshl_add_u32 v64, v66, 4, v64
    v_add_u32 v64, s21, v64
    v_lshlrev_b32 v65, 10, v65
    v_lshl_add_u32 v65, v66, 4, v65
    v_add_u32 v65, s38, v65
    v_add_u32 v65, s37, v65
    v_add_u32 v66, 8192, v65
    s_waitcnt lgkmcnt(0)
    ds_read_b128 v[168:171], v64
    ds_read_b128 v[172:175], v64 offset:1152
    s_waitcnt lgkmcnt(1)
    global_store_dwordx4 v65, v[168:171], s[52:53]
    s_waitcnt lgkmcnt(0)
    global_store_dwordx4 v66, v[172:175], s[52:53]
    s_endpgm
K56_loader:
    s_waitcnt lgkmcnt(0)
    s_add_u32 s12, s4, 0x1c00000
    s_addc_u32 s13, s5, 0
    s_mov_b32 s14, 1835008
    s_mov_b32 s15, 0x00020000
    v_lshlrev_b32 v12, 4, v2
    s_add_u32 s35, s20, 0
    s_mul_i32 s22, s3, 7168
    s_mov_b32 m0, s22
    s_add_u32 s22, s22, 1024
    buffer_load_dwordx4 v12, s[12:15], s35 offen lds
    s_add_u32 s35, s35, 1024
    s_mov_b32 m0, s22
    s_add_u32 s22, s22, 1024
    buffer_load_dwordx4 v12, s[12:15], s35 offen lds
    s_add_u32 s35, s35, 1024
    s_mov_b32 m0, s22
    s_add_u32 s22, s22, 1024
    buffer_load_dwordx4 v12, s[12:15], s35 offen lds
    s_add_u32 s35, s35, 1024
    s_mov_b32 m0, s22
    s_add_u32 s22, s22, 1024
    buffer_load_dwordx4 v12, s[12:15], s35 offen lds
    s_add_u32 s35, s35, 1024
    s_mov_b32 m0, s22
    s_add_u32 s22, s22, 1024
    buffer_load_dwordx4 v12, s[12:15], s35 offen lds
    s_add_u32 s35, s35, 1024
    s_mov_b32 m0, s22
    s_add_u32 s22, s22, 1024
    buffer_load_dwordx4 v12, s[12:15], s35 offen lds
    s_add_u32 s35, s35, 1024
    s_mov_b32 m0, s22
    s_add_u32 s22, s22, 1024
    buffer_load_dwordx4 v12, s[12:15], s35 offen lds
    s_add_u32 s35, s20, 28672
    s_mul_i32 s22, s3, 7168
    s_add_u32 s22, s22, 28672
    s_mov_b32 m0, s22
    s_add_u32 s22, s22, 1024
    buffer_load_dwordx4 v12, s[12:15], s35 offen lds
    s_add_u32 s35, s35, 1024
    s_mov_b32 m0, s22
    s_add_u32 s22, s22, 1024
    buffer_load_dwordx4 v12, s[12:15], s35 offen lds
    s_add_u32 s35, s35, 1024
    s_mov_b32 m0, s22
    s_add_u32 s22, s22, 1024
    buffer_load_dwordx4 v12, s[12:15], s35 offen lds
    s_add_u32 s35, s35, 1024
    s_mov_b32 m0, s22
    s_add_u32 s22, s22, 1024
    buffer_load_dwordx4 v12, s[12:15], s35 offen lds
    s_add_u32 s35, s35, 1024
    s_mov_b32 m0, s22
    s_add_u32 s22, s22, 1024
    buffer_load_dwordx4 v12, s[12:15], s35 offen lds
    s_add_u32 s35, s35, 1024
    s_mov_b32 m0, s22
    s_add_u32 s22, s22, 1024
    buffer_load_dwordx4 v12, s[12:15], s35 offen lds
    s_add_u32 s35, s35, 1024
    s_mov_b32 m0, s22
    s_add_u32 s22, s22, 1024
    buffer_load_dwordx4 v12, s[12:15], s35 offen lds
    s_waitcnt vmcnt(7)
    s_barrier
    s_add_u32 s35, s20, 57344
    s_mul_i32 s22, s3, 7168
    s_add_u32 s22, s22, 57344
    s_mov_b32 m0, s22
    s_add_u32 s22, s22, 1024
    buffer_load_dwordx4 v12, s[12:15], s35 offen lds
    s_add_u32 s35, s35, 1024
    s_mov_b32 m0, s22
    s_add_u32 s22, s22, 1024
    buffer_load_dwordx4 v12, s[12:15], s35 offen lds
    s_add_u32 s35, s35, 1024
    s_mov_b32 m0, s22
    s_add_u32 s22, s22, 1024
    buffer_load_dwordx4 v12, s[12:15], s35 offen lds
    s_add_u32 s35, s35, 1024
    s_mov_b32 m0, s22
    s_add_u32 s22, s22, 1024
    buffer_load_dwordx4 v12, s[12:15], s35 offen lds
    s_add_u32 s35, s35, 1024
    s_mov_b32 m0, s22
    s_add_u32 s22, s22, 1024
    buffer_load_dwordx4 v12, s[12:15], s35 offen lds
    s_add_u32 s35, s35, 1024
    s_mov_b32 m0, s22
    s_add_u32 s22, s22, 1024
    buffer_load_dwordx4 v12, s[12:15], s35 offen lds
    s_add_u32 s35, s35, 1024
    s_mov_b32 m0, s22
    s_add_u32 s22, s22, 1024
    buffer_load_dwordx4 v12, s[12:15], s35 offen lds
    s_waitcnt vmcnt(7)
    s_barrier
    s_add_u32 s35, s20, 86016
    s_mul_i32 s22, s3, 7168
    s_add_u32 s22, s22, 86016
    s_mov_b32 m0, s22
    s_add_u32 s22, s22, 1024
    buffer_load_dwordx4 v12, s[12:15], s35 offen lds
    s_add_u32 s35, s35, 1024
    s_mov_b32 m0, s22
    s_add_u32 s22, s22, 1024
    buffer_load_dwordx4 v12, s[12:15], s35 offen lds
    s_add_u32 s35, s35, 1024
    s_mov_b32 m0, s22
    s_add_u32 s22, s22, 1024
    buffer_load_dwordx4 v12, s[12:15], s35 offen lds
    s_add_u32 s35, s35, 1024
    s_mov_b32 m0, s22
    s_add_u32 s22, s22, 1024
    buffer_load_dwordx4 v12, s[12:15], s35 offen lds
    s_add_u32 s35, s35, 1024
    s_mov_b32 m0, s22
    s_add_u32 s22, s22, 1024
    buffer_load_dwordx4 v12, s[12:15], s35 offen lds
    s_add_u32 s35, s35, 1024
    s_mov_b32 m0, s22
    s_add_u32 s22, s22, 1024
    buffer_load_dwordx4 v12, s[12:15], s35 offen lds
    s_add_u32 s35, s35, 1024
    s_mov_b32 m0, s22
    s_add_u32 s22, s22, 1024
    buffer_load_dwordx4 v12, s[12:15], s35 offen lds
    s_waitcnt vmcnt(7)
    s_barrier
    s_waitcnt vmcnt(0)
    s_barrier

    s_bfe_u32 s16, s2, 0x30003
    s_and_b32 s17, s2, 7
    s_lshl_b32 s17, s17, 2
    s_lshr_b32 s19, s2, 6
    s_add_u32 s17, s17, s19

    s_lshr_b32 s18, s3, 1
    s_lshl_b32 s18, s18, 4
    s_and_b32 s19, s3, 1
    s_lshl_b32 s19, s19, 2
    s_add_u32 s18, s18, s19
    s_lshl_b32 s39, s17, 6
    s_lshl_b32 s23, s3, 4
    s_add_u32 s39, s39, s23
    s_lshl_b32 s38, s39, 10
    s_lshl_b32 s20, s18, 10
    s_lshl_b32 s37, s16, 7
    s_add_u32 s20, s20, s37
    s_lshl_b32 s34, s17, 1
    s_add_u32 s34, s34, s16
    s_mul_hi_u32 s35, s34, 0x24924925
    s_mul_i32 s35, s35, 7
    s_sub_u32 s34, s34, s35
    s_lshl_b32 s34, s34, 1

    s_mov_b32 s12, s6
    s_mov_b32 s13, s7
    s_mov_b32 s14, 1835008
    s_mov_b32 s15, 0x00020000
    s_barrier
    v_lshrrev_b32 v3, 5, v2
    v_lshlrev_b32 v3, 3, v3
    v_bfe_u32 v4, v2, 3, 2
    v_add_u32 v3, v3, v4
    v_mul_u32_u24 v12, 1024, v3
    v_bfe_u32 v3, v2, 1, 2
    v_bfe_u32 v4, v2, 4, 2
    v_xor_b32 v3, v3, v4
    v_lshl_add_u32 v12, v3, 5, v12
    v_and_b32 v3, 1, v2
    v_lshl_add_u32 v12, v3, 4, v12
    s_mul_i32 s35, s34, 131072
    s_add_u32 s35, s35, s20
    s_lshl_b32 s22, s3, 10
    s_mov_b32 m0, s22
    s_add_u32 s22, s22, 4096
    buffer_load_dwordx4 v12, s[12:15], s35 offen lds
    s_add_u32 s35, s35, 32768
    s_mov_b32 m0, s22
    s_add_u32 s22, s22, 4096
    buffer_load_dwordx4 v12, s[12:15], s35 offen lds
    s_add_u32 s35, s35, 32768
    s_mov_b32 m0, s22
    s_add_u32 s22, s22, 4096
    buffer_load_dwordx4 v12, s[12:15], s35 offen lds
    s_add_u32 s35, s35, 32768
    s_mov_b32 m0, s22
    s_add_u32 s22, s22, 4096
    buffer_load_dwordx4 v12, s[12:15], s35 offen lds
    s_add_u32 s34, s34, 1
    s_cmp_eq_u32 s34, 14
    s_cselect_b32 s34, 0, s34
    s_barrier
    s_mul_i32 s35, s34, 131072
    s_add_u32 s35, s35, s20
    s_lshl_b32 s22, s3, 10
    s_add_u32 s22, s22, 16384
    s_mov_b32 m0, s22
    s_add_u32 s22, s22, 4096
    buffer_load_dwordx4 v12, s[12:15], s35 offen lds
    s_add_u32 s35, s35, 32768
    s_mov_b32 m0, s22
    s_add_u32 s22, s22, 4096
    buffer_load_dwordx4 v12, s[12:15], s35 offen lds
    s_add_u32 s35, s35, 32768
    s_mov_b32 m0, s22
    s_add_u32 s22, s22, 4096
    buffer_load_dwordx4 v12, s[12:15], s35 offen lds
    s_add_u32 s35, s35, 32768
    s_mov_b32 m0, s22
    s_add_u32 s22, s22, 4096
    buffer_load_dwordx4 v12, s[12:15], s35 offen lds
    s_add_u32 s34, s34, 1
    s_cmp_eq_u32 s34, 14
    s_cselect_b32 s34, 0, s34
    s_mul_i32 s35, s34, 131072
    s_add_u32 s35, s35, s20
    s_lshl_b32 s22, s3, 10
    s_add_u32 s22, s22, 32768
    s_mov_b32 m0, s22
    s_add_u32 s22, s22, 4096
    buffer_load_dwordx4 v12, s[12:15], s35 offen lds
    s_add_u32 s35, s35, 32768
    s_mov_b32 m0, s22
    s_add_u32 s22, s22, 4096
    buffer_load_dwordx4 v12, s[12:15], s35 offen lds
    s_add_u32 s35, s35, 32768
    s_mov_b32 m0, s22
    s_add_u32 s22, s22, 4096
    buffer_load_dwordx4 v12, s[12:15], s35 offen lds
    s_add_u32 s35, s35, 32768
    s_mov_b32 m0, s22
    s_add_u32 s22, s22, 4096
    buffer_load_dwordx4 v12, s[12:15], s35 offen lds
    s_add_u32 s34, s34, 1
    s_cmp_eq_u32 s34, 14
    s_cselect_b32 s34, 0, s34
    s_mul_i32 s35, s34, 131072
    s_add_u32 s35, s35, s20
    s_lshl_b32 s22, s3, 10
    s_add_u32 s22, s22, 49152
    s_mov_b32 m0, s22
    s_add_u32 s22, s22, 4096
    buffer_load_dwordx4 v12, s[12:15], s35 offen lds
    s_add_u32 s35, s35, 32768
    s_mov_b32 m0, s22
    s_add_u32 s22, s22, 4096
    buffer_load_dwordx4 v12, s[12:15], s35 offen lds
    s_add_u32 s35, s35, 32768
    s_mov_b32 m0, s22
    s_add_u32 s22, s22, 4096
    buffer_load_dwordx4 v12, s[12:15], s35 offen lds
    s_add_u32 s35, s35, 32768
    s_mov_b32 m0, s22
    s_add_u32 s22, s22, 4096
    buffer_load_dwordx4 v12, s[12:15], s35 offen lds
    s_add_u32 s34, s34, 1
    s_cmp_eq_u32 s34, 14
    s_cselect_b32 s34, 0, s34
    s_mul_i32 s35, s34, 131072
    s_add_u32 s35, s35, s20
    s_lshl_b32 s22, s3, 10
    s_add_u32 s22, s22, 65536
    s_mov_b32 m0, s22
    s_add_u32 s22, s22, 4096
    buffer_load_dwordx4 v12, s[12:15], s35 offen lds
    s_add_u32 s35, s35, 32768
    s_mov_b32 m0, s22
    s_add_u32 s22, s22, 4096
    buffer_load_dwordx4 v12, s[12:15], s35 offen lds
    s_add_u32 s35, s35, 32768
    s_mov_b32 m0, s22
    s_add_u32 s22, s22, 4096
    buffer_load_dwordx4 v12, s[12:15], s35 offen lds
    s_add_u32 s35, s35, 32768
    s_mov_b32 m0, s22
    s_add_u32 s22, s22, 4096
    buffer_load_dwordx4 v12, s[12:15], s35 offen lds
    s_add_u32 s34, s34, 1
    s_cmp_eq_u32 s34, 14
    s_cselect_b32 s34, 0, s34
    s_mul_i32 s35, s34, 131072
    s_add_u32 s35, s35, s20
    s_lshl_b32 s22, s3, 10
    s_add_u32 s22, s22, 81920
    s_mov_b32 m0, s22
    s_add_u32 s22, s22, 4096
    buffer_load_dwordx4 v12, s[12:15], s35 offen lds
    s_add_u32 s35, s35, 32768
    s_mov_b32 m0, s22
    s_add_u32 s22, s22, 4096
    buffer_load_dwordx4 v12, s[12:15], s35 offen lds
    s_add_u32 s35, s35, 32768
    s_mov_b32 m0, s22
    s_add_u32 s22, s22, 4096
    buffer_load_dwordx4 v12, s[12:15], s35 offen lds
    s_add_u32 s35, s35, 32768
    s_mov_b32 m0, s22
    s_add_u32 s22, s22, 4096
    buffer_load_dwordx4 v12, s[12:15], s35 offen lds
    s_add_u32 s34, s34, 1
    s_cmp_eq_u32 s34, 14
    s_cselect_b32 s34, 0, s34
    s_mul_i32 s35, s34, 131072
    s_add_u32 s35, s35, s20
    s_lshl_b32 s22, s3, 10
    s_add_u32 s22, s22, 98304
    s_mov_b32 m0, s22
    s_add_u32 s22, s22, 4096
    buffer_load_dwordx4 v12, s[12:15], s35 offen lds
    s_add_u32 s35, s35, 32768
    s_mov_b32 m0, s22
    s_add_u32 s22, s22, 4096
    buffer_load_dwordx4 v12, s[12:15], s35 offen lds
    s_add_u32 s35, s35, 32768
    s_mov_b32 m0, s22
    s_add_u32 s22, s22, 4096
    buffer_load_dwordx4 v12, s[12:15], s35 offen lds
    s_add_u32 s35, s35, 32768
    s_mov_b32 m0, s22
    s_add_u32 s22, s22, 4096
    buffer_load_dwordx4 v12, s[12:15], s35 offen lds
    s_add_u32 s34, s34, 1
    s_cmp_eq_u32 s34, 14
    s_cselect_b32 s34, 0, s34
    s_mul_i32 s35, s34, 131072
    s_add_u32 s35, s35, s20
    s_lshl_b32 s22, s3, 10
    s_add_u32 s22, s22, 114688
    s_mov_b32 m0, s22
    s_add_u32 s22, s22, 4096
    buffer_load_dwordx4 v12, s[12:15], s35 offen lds
    s_add_u32 s35, s35, 32768
    s_mov_b32 m0, s22
    s_add_u32 s22, s22, 4096
    buffer_load_dwordx4 v12, s[12:15], s35 offen lds
    s_add_u32 s35, s35, 32768
    s_mov_b32 m0, s22
    s_add_u32 s22, s22, 4096
    buffer_load_dwordx4 v12, s[12:15], s35 offen lds
    s_add_u32 s35, s35, 32768
    s_mov_b32 m0, s22
    s_add_u32 s22, s22, 4096
    buffer_load_dwordx4 v12, s[12:15], s35 offen lds
    s_add_u32 s34, s34, 1
    s_cmp_eq_u32 s34, 14
    s_cselect_b32 s34, 0, s34
    s_barrier
    s_waitcnt vmcnt(28)
    s_barrier
    s_waitcnt vmcnt(24)
    s_barrier
    s_waitcnt vmcnt(20)
    s_barrier
    s_mul_i32 s35, s34, 131072
    s_add_u32 s35, s35, s20
    s_lshl_b32 s22, s3, 10
    s_mov_b32 m0, s22
    s_add_u32 s22, s22, 4096
    buffer_load_dwordx4 v12, s[12:15], s35 offen lds
    s_add_u32 s35, s35, 32768
    s_mov_b32 m0, s22
    s_add_u32 s22, s22, 4096
    buffer_load_dwordx4 v12, s[12:15], s35 offen lds
    s_add_u32 s35, s35, 32768
    s_mov_b32 m0, s22
    s_add_u32 s22, s22, 4096
    buffer_load_dwordx4 v12, s[12:15], s35 offen lds
    s_add_u32 s35, s35, 32768
    s_mov_b32 m0, s22
    s_add_u32 s22, s22, 4096
    buffer_load_dwordx4 v12, s[12:15], s35 offen lds
    s_add_u32 s34, s34, 1
    s_cmp_eq_u32 s34, 14
    s_cselect_b32 s34, 0, s34
    s_waitcnt vmcnt(20)
    s_barrier
    s_mul_i32 s35, s34, 131072
    s_add_u32 s35, s35, s20
    s_lshl_b32 s22, s3, 10
    s_add_u32 s22, s22, 16384
    s_mov_b32 m0, s22
    s_add_u32 s22, s22, 4096
    buffer_load_dwordx4 v12, s[12:15], s35 offen lds
    s_add_u32 s35, s35, 32768
    s_mov_b32 m0, s22
    s_add_u32 s22, s22, 4096
    buffer_load_dwordx4 v12, s[12:15], s35 offen lds
    s_add_u32 s35, s35, 32768
    s_mov_b32 m0, s22
    s_add_u32 s22, s22, 4096
    buffer_load_dwordx4 v12, s[12:15], s35 offen lds
    s_add_u32 s35, s35, 32768
    s_mov_b32 m0, s22
    s_add_u32 s22, s22, 4096
    buffer_load_dwordx4 v12, s[12:15], s35 offen lds
    s_add_u32 s34, s34, 1
    s_cmp_eq_u32 s34, 14
    s_cselect_b32 s34, 0, s34
    s_waitcnt vmcnt(20)
    s_barrier
    s_mul_i32 s35, s34, 131072
    s_add_u32 s35, s35, s20
    s_lshl_b32 s22, s3, 10
    s_add_u32 s22, s22, 32768
    s_mov_b32 m0, s22
    s_add_u32 s22, s22, 4096
    buffer_load_dwordx4 v12, s[12:15], s35 offen lds
    s_add_u32 s35, s35, 32768
    s_mov_b32 m0, s22
    s_add_u32 s22, s22, 4096
    buffer_load_dwordx4 v12, s[12:15], s35 offen lds
    s_add_u32 s35, s35, 32768
    s_mov_b32 m0, s22
    s_add_u32 s22, s22, 4096
    buffer_load_dwordx4 v12, s[12:15], s35 offen lds
    s_add_u32 s35, s35, 32768
    s_mov_b32 m0, s22
    s_add_u32 s22, s22, 4096
    buffer_load_dwordx4 v12, s[12:15], s35 offen lds
    s_add_u32 s34, s34, 1
    s_cmp_eq_u32 s34, 14
    s_cselect_b32 s34, 0, s34
    s_waitcnt vmcnt(20)
    s_barrier
    s_mul_i32 s35, s34, 131072
    s_add_u32 s35, s35, s20
    s_lshl_b32 s22, s3, 10
    s_add_u32 s22, s22, 49152
    s_mov_b32 m0, s22
    s_add_u32 s22, s22, 4096
    buffer_load_dwordx4 v12, s[12:15], s35 offen lds
    s_add_u32 s35, s35, 32768
    s_mov_b32 m0, s22
    s_add_u32 s22, s22, 4096
    buffer_load_dwordx4 v12, s[12:15], s35 offen lds
    s_add_u32 s35, s35, 32768
    s_mov_b32 m0, s22
    s_add_u32 s22, s22, 4096
    buffer_load_dwordx4 v12, s[12:15], s35 offen lds
    s_add_u32 s35, s35, 32768
    s_mov_b32 m0, s22
    s_add_u32 s22, s22, 4096
    buffer_load_dwordx4 v12, s[12:15], s35 offen lds
    s_add_u32 s34, s34, 1
    s_cmp_eq_u32 s34, 14
    s_cselect_b32 s34, 0, s34
    s_waitcnt vmcnt(20)
    s_barrier
    s_mul_i32 s35, s34, 131072
    s_add_u32 s35, s35, s20
    s_lshl_b32 s22, s3, 10
    s_add_u32 s22, s22, 65536
    s_mov_b32 m0, s22
    s_add_u32 s22, s22, 4096
    buffer_load_dwordx4 v12, s[12:15], s35 offen lds
    s_add_u32 s35, s35, 32768
    s_mov_b32 m0, s22
    s_add_u32 s22, s22, 4096
    buffer_load_dwordx4 v12, s[12:15], s35 offen lds
    s_add_u32 s35, s35, 32768
    s_mov_b32 m0, s22
    s_add_u32 s22, s22, 4096
    buffer_load_dwordx4 v12, s[12:15], s35 offen lds
    s_add_u32 s35, s35, 32768
    s_mov_b32 m0, s22
    s_add_u32 s22, s22, 4096
    buffer_load_dwordx4 v12, s[12:15], s35 offen lds
    s_add_u32 s34, s34, 1
    s_cmp_eq_u32 s34, 14
    s_cselect_b32 s34, 0, s34
    s_waitcnt vmcnt(20)
    s_barrier
    s_mul_i32 s35, s34, 131072
    s_add_u32 s35, s35, s20
    s_lshl_b32 s22, s3, 10
    s_add_u32 s22, s22, 81920
    s_mov_b32 m0, s22
    s_add_u32 s22, s22, 4096
    buffer_load_dwordx4 v12, s[12:15], s35 offen lds
    s_add_u32 s35, s35, 32768
    s_mov_b32 m0, s22
    s_add_u32 s22, s22, 4096
    buffer_load_dwordx4 v12, s[12:15], s35 offen lds
    s_add_u32 s35, s35, 32768
    s_mov_b32 m0, s22
    s_add_u32 s22, s22, 4096
    buffer_load_dwordx4 v12, s[12:15], s35 offen lds
    s_add_u32 s35, s35, 32768
    s_mov_b32 m0, s22
    s_add_u32 s22, s22, 4096
    buffer_load_dwordx4 v12, s[12:15], s35 offen lds
    s_add_u32 s34, s34, 1
    s_cmp_eq_u32 s34, 14
    s_cselect_b32 s34, 0, s34
    s_waitcnt vmcnt(20)
    s_barrier
    s_waitcnt vmcnt(16)
    s_barrier
    s_waitcnt vmcnt(12)
    s_barrier
    s_waitcnt vmcnt(8)
    s_barrier
    s_waitcnt vmcnt(4)
    s_barrier
    s_waitcnt vmcnt(0)
    s_barrier
K56_exit:
    s_endpgm
K_code_end:
.section .rodata,"a"
.p2align 6
.amdhsa_kernel k1_kernel
  .amdhsa_next_free_vgpr 128
  .amdhsa_next_free_sgpr 102
  .amdhsa_accum_offset 128
  .amdhsa_group_segment_fixed_size 0
  .amdhsa_kernarg_size 136
  .amdhsa_user_sgpr_count 2
  .amdhsa_user_sgpr_kernarg_segment_ptr 1
  .amdhsa_system_sgpr_workgroup_id_x 1
  .amdhsa_float_denorm_mode_32 3
  .amdhsa_float_denorm_mode_16_64 3
.end_amdhsa_kernel
.p2align 6
.amdhsa_kernel k2_kernel
  .amdhsa_next_free_vgpr 136
  .amdhsa_next_free_sgpr 102
  .amdhsa_accum_offset 136
  .amdhsa_group_segment_fixed_size 0
  .amdhsa_kernarg_size 136
  .amdhsa_user_sgpr_count 2
  .amdhsa_user_sgpr_kernarg_segment_ptr 1
  .amdhsa_system_sgpr_workgroup_id_x 1
  .amdhsa_float_denorm_mode_32 3
  .amdhsa_float_denorm_mode_16_64 3
.end_amdhsa_kernel
.p2align 6
.amdhsa_kernel k3_kernel
  .amdhsa_next_free_vgpr 168
  .amdhsa_next_free_sgpr 102
  .amdhsa_accum_offset 168
  .amdhsa_group_segment_fixed_size 0
  .amdhsa_kernarg_size 136
  .amdhsa_user_sgpr_count 2
  .amdhsa_user_sgpr_kernarg_segment_ptr 1
  .amdhsa_system_sgpr_workgroup_id_x 1
  .amdhsa_float_denorm_mode_32 3
  .amdhsa_float_denorm_mode_16_64 3
.end_amdhsa_kernel
.p2align 6
.amdhsa_kernel k4_kernel
  .amdhsa_next_free_vgpr 184
  .amdhsa_next_free_sgpr 102
  .amdhsa_accum_offset 184
  .amdhsa_group_segment_fixed_size 0
  .amdhsa_kernarg_size 136
  .amdhsa_user_sgpr_count 2
  .amdhsa_user_sgpr_kernarg_segment_ptr 1
  .amdhsa_system_sgpr_workgroup_id_x 1
  .amdhsa_float_denorm_mode_32 3
  .amdhsa_float_denorm_mode_16_64 3
.end_amdhsa_kernel
.p2align 6
.amdhsa_kernel k56_kernel
  .amdhsa_next_free_vgpr 240
  .amdhsa_next_free_sgpr 102
  .amdhsa_accum_offset 240
  .amdhsa_group_segment_fixed_size 0
  .amdhsa_kernarg_size 136
  .amdhsa_user_sgpr_count 2
  .amdhsa_user_sgpr_kernarg_segment_ptr 1
  .amdhsa_system_sgpr_workgroup_id_x 1
  .amdhsa_float_denorm_mode_32 3
  .amdhsa_float_denorm_mode_16_64 3
.end_amdhsa_kernel
```
